```python
import torch

def _softmax(x, axis=-1):
    return torch.softmax(x, dim=axis)

def _gelu(x):
    return torch.nn.functional.gelu(x, approximate='tanh')

def _silu(x):
    return torch.nn.functional.silu(x)

def _sigmoid(x):
    return torch.sigmoid(x)

def _layernorm(x, axis=-1, eps=1e-05):
    m = x.mean(dim=axis, keepdim=True)
    v = x.var(dim=axis, keepdim=True, unbiased=False)
    return (x - m) / torch.sqrt(v + eps)

def _scatter_add(tgt, idx, src, axis=0):
    return tgt.clone().index_add_(axis, idx, src)

def _segment_sum(src, seg, n):
    out = torch.zeros((n,) + src.shape[1:], dtype=src.dtype)
    return out.index_add_(0, seg, src)

def _pad(x, pw):
    flat = tuple((v for pair in reversed(pw) for v in pair))
    return torch.nn.functional.pad(x, flat)
kernel_name = 'adaLN_cond__grouped_kv_mqa__glu_gated_reglu__prompt'

def setup_inputs():

    _w = lambda a: (lambda t: t.to(torch.bfloat16) if t.is_floating_point() else t)(torch.as_tensor(a))

    def _A_setup():
        B, S, D, H = (1, 2048, 576, 32)
        Dh = D // H
        return {'x': _w((lambda *s: torch.randn(*s, dtype=torch.bfloat16) * 0.05)(B, S, D)), 'wq': _w((lambda *s: torch.randn(*s, dtype=torch.bfloat16) * 0.05)(D, H * Dh)), 'wk': _w((lambda *s: torch.randn(*s, dtype=torch.bfloat16) * 0.05)(D, Dh)), 'wv': _w((lambda *s: torch.randn(*s, dtype=torch.bfloat16) * 0.05)(D, Dh)), 'wo': _w((lambda *s: torch.randn(*s, dtype=torch.bfloat16) * 0.05)(H * Dh, D))}
    _A_in = _A_setup()

    def _B_setup():
        B, S, D, F = (1, 2048, 576, 4608)
        return {'x': _w((lambda *s: torch.randn(*s, dtype=torch.bfloat16) * 0.05)(B, S, D)), 'W_gate': _w((lambda *s: torch.randn(*s, dtype=torch.bfloat16) * 0.8)(D, F) * (2.0 / D) ** 0.5), 'W_up': _w((lambda *s: torch.randn(*s, dtype=torch.bfloat16) * 0.8)(D, F) * (2.0 / D) ** 0.5), 'W_down': _w((lambda *s: torch.randn(*s, dtype=torch.bfloat16) * 0.8)(F, D) * (1.0 / F) ** 0.5)}
    _B_in = _B_setup()
    return {'A_x': _A_in['x'], 'A_wq': _A_in['wq'], 'A_wk': _A_in['wk'], 'A_wv': _A_in['wv'], 'A_wo': _A_in['wo'], 'B_x': _B_in['x'], 'B_W_gate': _B_in['W_gate'], 'B_W_up': _B_in['W_up'], 'B_W_down': _B_in['W_down'], 'c': _w((lambda *s: torch.randn(*s, dtype=torch.bfloat16) * 0.2)(1, 576) * 8.0), 'w_mod': _w((lambda *s: torch.randn(*s, dtype=torch.bfloat16) * 0.2)(576, 6 * 576) * 576 ** (-0.5) * 8.0)}

def reference(A_x, A_wq, A_wk, A_wv, A_wo, B_x, B_W_gate, B_W_up, B_W_down, c, w_mod):

    def _A_ref(x, wq, wk, wv, wo):
        B, S, D = x.shape
        H = 32
        Dh = D // H
        q = (lambda x, *d: x.permute(*d))((x @ wq).reshape(B, S, H, Dh), 0, 2, 1, 3)
        k = x @ wk
        v = x @ wv
        scores = torch.einsum('bhqd,bkd->bhqk', q, k) * Dh ** (-0.5)
        p = _softmax(scores, axis=-1)
        o = torch.einsum('bhqk,bkd->bhqd', p, v)
        return (lambda x, *d: x.permute(*d))(o, 0, 2, 1, 3).reshape(B, S, H * Dh) @ wo

    def _B_ref(x, W_gate, W_up, W_down):
        gate = torch.einsum('bsd,df->bsf', x, W_gate)
        up = torch.einsum('bsd,df->bsf', x, W_up)
        gate = gate * (lambda x, dt: x.to(dt))(gate > 0, gate.dtype)
        h = gate * up
        return torch.einsum('bsf,fd->bsd', h, W_down)
    x = A_x
    mod = (_silu(c) @ w_mod).reshape(c.shape[0], 6, 1, -1)
    sa, ca, ga, sb, cb, gb = (mod[:, 0].clone(), mod[:, 1].clone(), mod[:, 2].clone(), mod[:, 3].clone(), mod[:, 4].clone(), mod[:, 5].clone())
    h = _layernorm(x, axis=-1) * (1 + ca) + sa
    x = x + ga * _A_ref(h, A_wq, A_wk, A_wv, A_wo)
    h = _layernorm(x, axis=-1) * (1 + cb) + sb
    x = x + gb * _B_ref(h, B_W_gate, B_W_up, B_W_down)
    return x
```

```asm
; @launch kernel=k1_prep_kernel grid=(598,1,1) block=(256,1,1) lds=2048
; @launch kernel=k2_qkv_kernel grid=(256,1,1) block=(896,1,1) lds=46080
; @launch kernel=k3_attn_kernel grid=(256,1,1) block=(512,1,1) lds=159808
; @launch kernel=k5_ffn_kernel grid=(256,1,1) block=(256,1,1) lds=147456
.amdgcn_target "amdgcn-amd-amdhsa--gfx950"
.text
.globl k1_prep_kernel
.p2align 8
.type k1_prep_kernel,@function
k1_prep_kernel:
    s_load_dwordx2 s[20:21], s[0:1], 104
    s_mov_b32 s18, 0xffff0000
    s_cmp_ge_u32 s2, 112
    s_cbranch_scc1 K1_not_mod
    s_cmp_ge_u32 s2, 108
    s_cbranch_scc1 K1_zero
    s_load_dwordx4 s[4:7], s[0:1], 72
    v_and_b32 v1, 3, v0
    v_lshrrev_b32 v2, 2, v0
    v_lshlrev_b32 v3, 1, v2
    v_mul_u32_u24 v4, 6912, v2
    v_lshl_add_u32 v4, v1, 4, v4
    s_lshl_b32 s10, s2, 6
    s_mov_b32 s14, 3981312
    s_mov_b32 s15, 0x20000
    s_mov_b32 s16, 442368
    s_waitcnt lgkmcnt(0)
    s_mov_b32 s12, s6
    s_mov_b32 s13, s7
    global_load_ushort v8, v3, s[4:5] offset:0
    global_load_ushort v10, v3, s[4:5] offset:128
    global_load_ushort v12, v3, s[4:5] offset:256
    global_load_ushort v14, v3, s[4:5] offset:384
    global_load_ushort v16, v3, s[4:5] offset:512
    global_load_ushort v18, v3, s[4:5] offset:640
    global_load_ushort v20, v3, s[4:5] offset:768
    global_load_ushort v22, v3, s[4:5] offset:896
    global_load_ushort v24, v3, s[4:5] offset:1024
    buffer_load_dwordx4 v[44:47], v4, s[12:15], s10 offen
    s_add_u32 s10, s10, s16
    buffer_load_dwordx4 v[48:51], v4, s[12:15], s10 offen
    s_add_u32 s10, s10, s16
    buffer_load_dwordx4 v[52:55], v4, s[12:15], s10 offen
    s_add_u32 s10, s10, s16
    buffer_load_dwordx4 v[56:59], v4, s[12:15], s10 offen
    s_add_u32 s10, s10, s16
    buffer_load_dwordx4 v[60:63], v4, s[12:15], s10 offen
    s_add_u32 s10, s10, s16
    buffer_load_dwordx4 v[64:67], v4, s[12:15], s10 offen
    s_add_u32 s10, s10, s16
    buffer_load_dwordx4 v[68:71], v4, s[12:15], s10 offen
    s_add_u32 s10, s10, s16
    buffer_load_dwordx4 v[72:75], v4, s[12:15], s10 offen
    s_add_u32 s10, s10, s16
    buffer_load_dwordx4 v[76:79], v4, s[12:15], s10 offen
    v_mov_b32 v80, 0
    v_mov_b32 v81, 0
    v_mov_b32 v82, 0
    v_mov_b32 v83, 0
    v_mov_b32 v84, 0
    v_mov_b32 v85, 0
    v_mov_b32 v86, 0
    v_mov_b32 v87, 0
    v_lshrrev_b32 v5, 4, v0
    v_lshlrev_b32 v5, 7, v5
    v_lshl_add_u32 v5, v1, 5, v5
    s_waitcnt vmcnt(9)
    v_lshlrev_b32 v8, 16, v8
    v_lshlrev_b32 v10, 16, v10
    v_lshlrev_b32 v12, 16, v12
    v_lshlrev_b32 v14, 16, v14
    v_lshlrev_b32 v16, 16, v16
    v_lshlrev_b32 v18, 16, v18
    v_lshlrev_b32 v20, 16, v20
    v_lshlrev_b32 v22, 16, v22
    v_lshlrev_b32 v24, 16, v24
    v_mul_f32 v9, 0xbfb8aa3b, v8
    v_mul_f32 v11, 0xbfb8aa3b, v10
    v_mul_f32 v13, 0xbfb8aa3b, v12
    v_mul_f32 v15, 0xbfb8aa3b, v14
    v_mul_f32 v17, 0xbfb8aa3b, v16
    v_mul_f32 v19, 0xbfb8aa3b, v18
    v_mul_f32 v21, 0xbfb8aa3b, v20
    v_mul_f32 v23, 0xbfb8aa3b, v22
    v_mul_f32 v25, 0xbfb8aa3b, v24
    v_exp_f32 v9, v9
    v_exp_f32 v11, v11
    v_exp_f32 v13, v13
    v_exp_f32 v15, v15
    v_exp_f32 v17, v17
    v_exp_f32 v19, v19
    v_exp_f32 v21, v21
    v_exp_f32 v23, v23
    v_exp_f32 v25, v25
    v_add_f32 v9, 1.0, v9
    v_add_f32 v11, 1.0, v11
    v_add_f32 v13, 1.0, v13
    v_add_f32 v15, 1.0, v15
    v_add_f32 v17, 1.0, v17
    v_add_f32 v19, 1.0, v19
    v_add_f32 v21, 1.0, v21
    v_add_f32 v23, 1.0, v23
    v_add_f32 v25, 1.0, v25
    v_rcp_f32 v9, v9
    v_rcp_f32 v11, v11
    v_rcp_f32 v13, v13
    v_rcp_f32 v15, v15
    v_rcp_f32 v17, v17
    v_rcp_f32 v19, v19
    v_rcp_f32 v21, v21
    v_rcp_f32 v23, v23
    v_rcp_f32 v25, v25
    v_mul_f32 v8, v9, v8
    v_mul_f32 v10, v11, v10
    v_mul_f32 v12, v13, v12
    v_mul_f32 v14, v15, v14
    v_mul_f32 v16, v17, v16
    v_mul_f32 v18, v19, v18
    v_mul_f32 v20, v21, v20
    v_mul_f32 v22, v23, v22
    v_mul_f32 v24, v25, v24
    v_cvt_pk_bf16_f32 v8, v8, v8
    v_cvt_pk_bf16_f32 v10, v10, v10
    v_cvt_pk_bf16_f32 v12, v12, v12
    v_cvt_pk_bf16_f32 v14, v14, v14
    v_cvt_pk_bf16_f32 v16, v16, v16
    v_cvt_pk_bf16_f32 v18, v18, v18
    v_cvt_pk_bf16_f32 v20, v20, v20
    v_cvt_pk_bf16_f32 v22, v22, v22
    v_cvt_pk_bf16_f32 v24, v24, v24
    v_and_b32 v8, s18, v8
    v_and_b32 v10, s18, v10
    v_and_b32 v12, s18, v12
    v_and_b32 v14, s18, v14
    v_and_b32 v16, s18, v16
    v_and_b32 v18, s18, v18
    v_and_b32 v20, s18, v20
    v_and_b32 v22, s18, v22
    v_and_b32 v24, s18, v24
    s_waitcnt vmcnt(8)
    v_lshlrev_b32 v88, 16, v44
    v_and_b32 v89, s18, v44
    v_lshlrev_b32 v90, 16, v45
    v_and_b32 v91, s18, v45
    v_lshlrev_b32 v92, 16, v46
    v_and_b32 v93, s18, v46
    v_lshlrev_b32 v94, 16, v47
    v_and_b32 v95, s18, v47
    v_pk_fma_f32 v[80:81], v[88:89], v[8:9], v[80:81] op_sel_hi:[1,0,1]
    v_pk_fma_f32 v[82:83], v[90:91], v[8:9], v[82:83] op_sel_hi:[1,0,1]
    v_pk_fma_f32 v[84:85], v[92:93], v[8:9], v[84:85] op_sel_hi:[1,0,1]
    v_pk_fma_f32 v[86:87], v[94:95], v[8:9], v[86:87] op_sel_hi:[1,0,1]
    s_waitcnt vmcnt(7)
    v_lshlrev_b32 v88, 16, v48
    v_and_b32 v89, s18, v48
    v_lshlrev_b32 v90, 16, v49
    v_and_b32 v91, s18, v49
    v_lshlrev_b32 v92, 16, v50
    v_and_b32 v93, s18, v50
    v_lshlrev_b32 v94, 16, v51
    v_and_b32 v95, s18, v51
    v_pk_fma_f32 v[80:81], v[88:89], v[10:11], v[80:81] op_sel_hi:[1,0,1]
    v_pk_fma_f32 v[82:83], v[90:91], v[10:11], v[82:83] op_sel_hi:[1,0,1]
    v_pk_fma_f32 v[84:85], v[92:93], v[10:11], v[84:85] op_sel_hi:[1,0,1]
    v_pk_fma_f32 v[86:87], v[94:95], v[10:11], v[86:87] op_sel_hi:[1,0,1]
    s_waitcnt vmcnt(6)
    v_lshlrev_b32 v88, 16, v52
    v_and_b32 v89, s18, v52
    v_lshlrev_b32 v90, 16, v53
    v_and_b32 v91, s18, v53
    v_lshlrev_b32 v92, 16, v54
    v_and_b32 v93, s18, v54
    v_lshlrev_b32 v94, 16, v55
    v_and_b32 v95, s18, v55
    v_pk_fma_f32 v[80:81], v[88:89], v[12:13], v[80:81] op_sel_hi:[1,0,1]
    v_pk_fma_f32 v[82:83], v[90:91], v[12:13], v[82:83] op_sel_hi:[1,0,1]
    v_pk_fma_f32 v[84:85], v[92:93], v[12:13], v[84:85] op_sel_hi:[1,0,1]
    v_pk_fma_f32 v[86:87], v[94:95], v[12:13], v[86:87] op_sel_hi:[1,0,1]
    s_waitcnt vmcnt(5)
    v_lshlrev_b32 v88, 16, v56
    v_and_b32 v89, s18, v56
    v_lshlrev_b32 v90, 16, v57
    v_and_b32 v91, s18, v57
    v_lshlrev_b32 v92, 16, v58
    v_and_b32 v93, s18, v58
    v_lshlrev_b32 v94, 16, v59
    v_and_b32 v95, s18, v59
    v_pk_fma_f32 v[80:81], v[88:89], v[14:15], v[80:81] op_sel_hi:[1,0,1]
    v_pk_fma_f32 v[82:83], v[90:91], v[14:15], v[82:83] op_sel_hi:[1,0,1]
    v_pk_fma_f32 v[84:85], v[92:93], v[14:15], v[84:85] op_sel_hi:[1,0,1]
    v_pk_fma_f32 v[86:87], v[94:95], v[14:15], v[86:87] op_sel_hi:[1,0,1]
    s_waitcnt vmcnt(4)
    v_lshlrev_b32 v88, 16, v60
    v_and_b32 v89, s18, v60
    v_lshlrev_b32 v90, 16, v61
    v_and_b32 v91, s18, v61
    v_lshlrev_b32 v92, 16, v62
    v_and_b32 v93, s18, v62
    v_lshlrev_b32 v94, 16, v63
    v_and_b32 v95, s18, v63
    v_pk_fma_f32 v[80:81], v[88:89], v[16:17], v[80:81] op_sel_hi:[1,0,1]
    v_pk_fma_f32 v[82:83], v[90:91], v[16:17], v[82:83] op_sel_hi:[1,0,1]
    v_pk_fma_f32 v[84:85], v[92:93], v[16:17], v[84:85] op_sel_hi:[1,0,1]
    v_pk_fma_f32 v[86:87], v[94:95], v[16:17], v[86:87] op_sel_hi:[1,0,1]
    s_waitcnt vmcnt(3)
    v_lshlrev_b32 v88, 16, v64
    v_and_b32 v89, s18, v64
    v_lshlrev_b32 v90, 16, v65
    v_and_b32 v91, s18, v65
    v_lshlrev_b32 v92, 16, v66
    v_and_b32 v93, s18, v66
    v_lshlrev_b32 v94, 16, v67
    v_and_b32 v95, s18, v67
    v_pk_fma_f32 v[80:81], v[88:89], v[18:19], v[80:81] op_sel_hi:[1,0,1]
    v_pk_fma_f32 v[82:83], v[90:91], v[18:19], v[82:83] op_sel_hi:[1,0,1]
    v_pk_fma_f32 v[84:85], v[92:93], v[18:19], v[84:85] op_sel_hi:[1,0,1]
    v_pk_fma_f32 v[86:87], v[94:95], v[18:19], v[86:87] op_sel_hi:[1,0,1]
    s_waitcnt vmcnt(2)
    v_lshlrev_b32 v88, 16, v68
    v_and_b32 v89, s18, v68
    v_lshlrev_b32 v90, 16, v69
    v_and_b32 v91, s18, v69
    v_lshlrev_b32 v92, 16, v70
    v_and_b32 v93, s18, v70
    v_lshlrev_b32 v94, 16, v71
    v_and_b32 v95, s18, v71
    v_pk_fma_f32 v[80:81], v[88:89], v[20:21], v[80:81] op_sel_hi:[1,0,1]
    v_pk_fma_f32 v[82:83], v[90:91], v[20:21], v[82:83] op_sel_hi:[1,0,1]
    v_pk_fma_f32 v[84:85], v[92:93], v[20:21], v[84:85] op_sel_hi:[1,0,1]
    v_pk_fma_f32 v[86:87], v[94:95], v[20:21], v[86:87] op_sel_hi:[1,0,1]
    s_waitcnt vmcnt(1)
    v_lshlrev_b32 v88, 16, v72
    v_and_b32 v89, s18, v72
    v_lshlrev_b32 v90, 16, v73
    v_and_b32 v91, s18, v73
    v_lshlrev_b32 v92, 16, v74
    v_and_b32 v93, s18, v74
    v_lshlrev_b32 v94, 16, v75
    v_and_b32 v95, s18, v75
    v_pk_fma_f32 v[80:81], v[88:89], v[22:23], v[80:81] op_sel_hi:[1,0,1]
    v_pk_fma_f32 v[82:83], v[90:91], v[22:23], v[82:83] op_sel_hi:[1,0,1]
    v_pk_fma_f32 v[84:85], v[92:93], v[22:23], v[84:85] op_sel_hi:[1,0,1]
    v_pk_fma_f32 v[86:87], v[94:95], v[22:23], v[86:87] op_sel_hi:[1,0,1]
    s_waitcnt vmcnt(0)
    v_lshlrev_b32 v88, 16, v76
    v_and_b32 v89, s18, v76
    v_lshlrev_b32 v90, 16, v77
    v_and_b32 v91, s18, v77
    v_lshlrev_b32 v92, 16, v78
    v_and_b32 v93, s18, v78
    v_lshlrev_b32 v94, 16, v79
    v_and_b32 v95, s18, v79
    v_pk_fma_f32 v[80:81], v[88:89], v[24:25], v[80:81] op_sel_hi:[1,0,1]
    v_pk_fma_f32 v[82:83], v[90:91], v[24:25], v[82:83] op_sel_hi:[1,0,1]
    v_pk_fma_f32 v[84:85], v[92:93], v[24:25], v[84:85] op_sel_hi:[1,0,1]
    v_pk_fma_f32 v[86:87], v[94:95], v[24:25], v[86:87] op_sel_hi:[1,0,1]
    s_nop 0
    v_add_f32_dpp v80, v80, v80 row_ror:4 row_mask:0xf bank_mask:0xf
    v_add_f32_dpp v81, v81, v81 row_ror:4 row_mask:0xf bank_mask:0xf
    v_add_f32_dpp v82, v82, v82 row_ror:4 row_mask:0xf bank_mask:0xf
    v_add_f32_dpp v83, v83, v83 row_ror:4 row_mask:0xf bank_mask:0xf
    v_add_f32_dpp v84, v84, v84 row_ror:4 row_mask:0xf bank_mask:0xf
    v_add_f32_dpp v85, v85, v85 row_ror:4 row_mask:0xf bank_mask:0xf
    v_add_f32_dpp v86, v86, v86 row_ror:4 row_mask:0xf bank_mask:0xf
    v_add_f32_dpp v87, v87, v87 row_ror:4 row_mask:0xf bank_mask:0xf
    v_add_f32_dpp v80, v80, v80 row_ror:8 row_mask:0xf bank_mask:0xf
    v_add_f32_dpp v81, v81, v81 row_ror:8 row_mask:0xf bank_mask:0xf
    v_add_f32_dpp v82, v82, v82 row_ror:8 row_mask:0xf bank_mask:0xf
    v_add_f32_dpp v83, v83, v83 row_ror:8 row_mask:0xf bank_mask:0xf
    v_add_f32_dpp v84, v84, v84 row_ror:8 row_mask:0xf bank_mask:0xf
    v_add_f32_dpp v85, v85, v85 row_ror:8 row_mask:0xf bank_mask:0xf
    v_add_f32_dpp v86, v86, v86 row_ror:8 row_mask:0xf bank_mask:0xf
    v_add_f32_dpp v87, v87, v87 row_ror:8 row_mask:0xf bank_mask:0xf
    ds_write_b128 v5, v[80:83]
    ds_write_b128 v5, v[84:87] offset:16
    v_and_b32 v6, 31, v0
    v_bfe_u32 v7, v0, 5, 1
    v_lshlrev_b32 v7, 10, v7
    v_lshl_add_u32 v7, v6, 2, v7
    s_mov_b32 s17, 0
    s_sub_u32 s3, s2, 18
    s_cmp_lt_u32 s3, 18
    s_cselect_b32 s17, 1.0, s17
    s_sub_u32 s3, s2, 72
    s_cmp_lt_u32 s3, 18
    s_cselect_b32 s17, 1.0, s17
    s_mul_hi_u32 s24, s2, 238609295
    s_mul_i32 s25, s24, 18
    s_sub_u32 s25, s2, s25
    s_mul_i32 s24, s24, 2304
    s_lshl_b32 s25, s25, 5
    s_add_u32 s24, s24, s25
    s_add_u32 s24, s24, 0x4000
    v_bfe_u32 v16, v6, 2, 2
    v_mul_u32_u24 v16, 576, v16
    v_lshrrev_b32 v17, 4, v6
    v_lshl_add_u32 v16, v17, 4, v16
    v_and_b32 v17, 3, v6
    v_lshl_add_u32 v16, v17, 2, v16
    v_add_u32 v16, s24, v16
    s_lshl_b32 s3, s2, 7
    v_lshl_add_u32 v6, v6, 2, s3
    s_waitcnt lgkmcnt(0)
    s_barrier
    ds_read2_b32 v[8:9], v7 offset0:0 offset1:32
    ds_read2_b32 v[10:11], v7 offset0:64 offset1:96
    ds_read2_b32 v[12:13], v7 offset0:128 offset1:160
    ds_read2_b32 v[14:15], v7 offset0:192 offset1:224
    v_cmp_gt_u32 vcc, 32, v0
    s_waitcnt lgkmcnt(0)
    v_pk_add_f32 v[8:9], v[8:9], v[10:11]
    v_pk_add_f32 v[12:13], v[12:13], v[14:15]
    v_pk_add_f32 v[8:9], v[8:9], v[12:13]
    v_add_f32 v8, v8, v9
    v_mov_b32 v9, v8
    s_nop 1
    v_permlane32_swap_b32 v8, v9
    v_add_f32 v8, v8, v9
    v_cvt_pk_bf16_f32 v8, v8, v8
    v_and_b32 v8, s18, v8
    v_add_f32 v8, s17, v8
    v_cvt_pk_bf16_f32 v8, v8, v8
    v_and_b32 v8, s18, v8
    s_and_saveexec_b64 s[22:23], vcc
    s_cbranch_execz K1_end
    global_store_dword v6, v8, s[20:21]
    global_store_dword v16, v8, s[20:21]
    s_endpgm
K1_not_mod:
    s_cmp_ge_u32 s2, 240
    s_cbranch_scc1 K1_pack
    s_load_dwordx2 s[4:5], s[0:1], 0
    s_sub_u32 s3, s2, 112
    s_and_b32 s6, s3, 7
    s_lshl_b32 s6, s6, 4
    s_lshr_b32 s3, s3, 3
    s_add_u32 s3, s3, s6
    v_lshrrev_b32 v1, 4, v0
    v_lshl_add_u32 v1, s3, 4, v1
    v_and_b32 v2, 15, v0
    v_mul_u32_u24 v3, 1152, v1
    v_lshl_add_u32 v3, v2, 3, v3
    v_mov_b32 v7, 0x3f803f80
    v_mov_b32 v4, 0
    s_waitcnt lgkmcnt(0)
    global_load_dwordx2 v[8:9], v3, s[4:5] offset:0
    global_load_dwordx2 v[10:11], v3, s[4:5] offset:128
    global_load_dwordx2 v[12:13], v3, s[4:5] offset:256
    global_load_dwordx2 v[14:15], v3, s[4:5] offset:384
    global_load_dwordx2 v[16:17], v3, s[4:5] offset:512
    global_load_dwordx2 v[18:19], v3, s[4:5] offset:640
    global_load_dwordx2 v[20:21], v3, s[4:5] offset:768
    global_load_dwordx2 v[22:23], v3, s[4:5] offset:896
    global_load_dwordx2 v[24:25], v3, s[4:5] offset:1024
    v_lshrrev_b32 v5, 5, v1
    v_mul_u32_u24 v5, 36864, v5
    v_and_b32 v6, 31, v1
    v_lshl_add_u32 v5, v6, 4, v5
    v_lshrrev_b32 v6, 1, v2
    v_lshl_add_u32 v5, v6, 9, v5
    v_and_b32 v6, 1, v2
    v_lshl_add_u32 v5, v6, 3, v5
    v_add_u32 v5, 0x300000, v5
    s_movk_i32 s16, 0x1000
    s_waitcnt vmcnt(0)
    v_dot2c_f32_bf16 v4, v8, v7
    v_dot2c_f32_bf16 v4, v9, v7
    v_dot2c_f32_bf16 v4, v10, v7
    v_dot2c_f32_bf16 v4, v11, v7
    v_dot2c_f32_bf16 v4, v12, v7
    v_dot2c_f32_bf16 v4, v13, v7
    v_dot2c_f32_bf16 v4, v14, v7
    v_dot2c_f32_bf16 v4, v15, v7
    v_dot2c_f32_bf16 v4, v16, v7
    v_dot2c_f32_bf16 v4, v17, v7
    v_dot2c_f32_bf16 v4, v18, v7
    v_dot2c_f32_bf16 v4, v19, v7
    v_dot2c_f32_bf16 v4, v20, v7
    v_dot2c_f32_bf16 v4, v21, v7
    v_dot2c_f32_bf16 v4, v22, v7
    v_dot2c_f32_bf16 v4, v23, v7
    v_dot2c_f32_bf16 v4, v24, v7
    v_dot2c_f32_bf16 v4, v25, v7
    v_lshlrev_b32 v28, 16, v8
    v_and_b32 v29, s18, v8
    v_lshlrev_b32 v30, 16, v9
    v_and_b32 v31, s18, v9
    v_lshlrev_b32 v32, 16, v10
    v_and_b32 v33, s18, v10
    v_lshlrev_b32 v34, 16, v11
    v_and_b32 v35, s18, v11
    v_lshlrev_b32 v36, 16, v12
    v_and_b32 v37, s18, v12
    v_lshlrev_b32 v38, 16, v13
    v_and_b32 v39, s18, v13
    v_lshlrev_b32 v40, 16, v14
    v_and_b32 v41, s18, v14
    v_lshlrev_b32 v42, 16, v15
    v_and_b32 v43, s18, v15
    v_lshlrev_b32 v44, 16, v16
    v_and_b32 v45, s18, v16
    v_lshlrev_b32 v46, 16, v17
    v_and_b32 v47, s18, v17
    v_lshlrev_b32 v48, 16, v18
    v_and_b32 v49, s18, v18
    v_lshlrev_b32 v50, 16, v19
    v_and_b32 v51, s18, v19
    v_lshlrev_b32 v52, 16, v20
    v_and_b32 v53, s18, v20
    v_lshlrev_b32 v54, 16, v21
    v_and_b32 v55, s18, v21
    v_lshlrev_b32 v56, 16, v22
    v_and_b32 v57, s18, v22
    v_lshlrev_b32 v58, 16, v23
    v_and_b32 v59, s18, v23
    v_lshlrev_b32 v60, 16, v24
    v_and_b32 v61, s18, v24
    v_lshlrev_b32 v62, 16, v25
    v_and_b32 v63, s18, v25
    v_add_f32_dpp v4, v4, v4 row_ror:1 row_mask:0xf bank_mask:0xf
    s_nop 1
    v_add_f32_dpp v4, v4, v4 row_ror:2 row_mask:0xf bank_mask:0xf
    s_nop 1
    v_add_f32_dpp v4, v4, v4 row_ror:4 row_mask:0xf bank_mask:0xf
    s_nop 1
    v_add_f32_dpp v4, v4, v4 row_ror:8 row_mask:0xf bank_mask:0xf
    s_nop 1
    v_mul_f32 v4, -0.001736111111111111, v4
    v_mov_b32 v64, 0
    v_mov_b32 v65, 0
    v_pk_add_f32 v[28:29], v[28:29], v[4:5] op_sel_hi:[1,0]
    v_pk_add_f32 v[30:31], v[30:31], v[4:5] op_sel_hi:[1,0]
    v_pk_add_f32 v[32:33], v[32:33], v[4:5] op_sel_hi:[1,0]
    v_pk_add_f32 v[34:35], v[34:35], v[4:5] op_sel_hi:[1,0]
    v_pk_add_f32 v[36:37], v[36:37], v[4:5] op_sel_hi:[1,0]
    v_pk_add_f32 v[38:39], v[38:39], v[4:5] op_sel_hi:[1,0]
    v_pk_add_f32 v[40:41], v[40:41], v[4:5] op_sel_hi:[1,0]
    v_pk_add_f32 v[42:43], v[42:43], v[4:5] op_sel_hi:[1,0]
    v_pk_add_f32 v[44:45], v[44:45], v[4:5] op_sel_hi:[1,0]
    v_pk_add_f32 v[46:47], v[46:47], v[4:5] op_sel_hi:[1,0]
    v_pk_add_f32 v[48:49], v[48:49], v[4:5] op_sel_hi:[1,0]
    v_pk_add_f32 v[50:51], v[50:51], v[4:5] op_sel_hi:[1,0]
    v_pk_add_f32 v[52:53], v[52:53], v[4:5] op_sel_hi:[1,0]
    v_pk_add_f32 v[54:55], v[54:55], v[4:5] op_sel_hi:[1,0]
    v_pk_add_f32 v[56:57], v[56:57], v[4:5] op_sel_hi:[1,0]
    v_pk_add_f32 v[58:59], v[58:59], v[4:5] op_sel_hi:[1,0]
    v_pk_add_f32 v[60:61], v[60:61], v[4:5] op_sel_hi:[1,0]
    v_pk_add_f32 v[62:63], v[62:63], v[4:5] op_sel_hi:[1,0]
    v_pk_fma_f32 v[64:65], v[28:29], v[28:29], v[64:65]
    v_pk_fma_f32 v[64:65], v[30:31], v[30:31], v[64:65]
    v_pk_fma_f32 v[64:65], v[32:33], v[32:33], v[64:65]
    v_pk_fma_f32 v[64:65], v[34:35], v[34:35], v[64:65]
    v_pk_fma_f32 v[64:65], v[36:37], v[36:37], v[64:65]
    v_pk_fma_f32 v[64:65], v[38:39], v[38:39], v[64:65]
    v_pk_fma_f32 v[64:65], v[40:41], v[40:41], v[64:65]
    v_pk_fma_f32 v[64:65], v[42:43], v[42:43], v[64:65]
    v_pk_fma_f32 v[64:65], v[44:45], v[44:45], v[64:65]
    v_pk_fma_f32 v[64:65], v[46:47], v[46:47], v[64:65]
    v_pk_fma_f32 v[64:65], v[48:49], v[48:49], v[64:65]
    v_pk_fma_f32 v[64:65], v[50:51], v[50:51], v[64:65]
    v_pk_fma_f32 v[64:65], v[52:53], v[52:53], v[64:65]
    v_pk_fma_f32 v[64:65], v[54:55], v[54:55], v[64:65]
    v_pk_fma_f32 v[64:65], v[56:57], v[56:57], v[64:65]
    v_pk_fma_f32 v[64:65], v[58:59], v[58:59], v[64:65]
    v_pk_fma_f32 v[64:65], v[60:61], v[60:61], v[64:65]
    v_pk_fma_f32 v[64:65], v[62:63], v[62:63], v[64:65]
    v_add_f32 v64, v64, v65
    s_nop 1
    v_add_f32_dpp v64, v64, v64 row_ror:1 row_mask:0xf bank_mask:0xf
    s_nop 1
    v_add_f32_dpp v64, v64, v64 row_ror:2 row_mask:0xf bank_mask:0xf
    s_nop 1
    v_add_f32_dpp v64, v64, v64 row_ror:4 row_mask:0xf bank_mask:0xf
    s_nop 1
    v_add_f32_dpp v64, v64, v64 row_ror:8 row_mask:0xf bank_mask:0xf
    s_nop 1
    v_mov_b32 v65, 0x3727c5ac
    v_fmac_f32 v65, 0.001736111111111111, v64
    v_rsq_f32 v64, v65
    s_nop 0
    v_pk_mul_f32 v[28:29], v[28:29], v[64:65] op_sel_hi:[1,0]
    v_pk_mul_f32 v[30:31], v[30:31], v[64:65] op_sel_hi:[1,0]
    v_cvt_pk_bf16_f32 v8, v28, v29
    v_cvt_pk_bf16_f32 v9, v30, v31
    global_store_dwordx2 v5, v[8:9], s[20:21]
    v_add_u32 v5, s16, v5
    v_pk_mul_f32 v[32:33], v[32:33], v[64:65] op_sel_hi:[1,0]
    v_pk_mul_f32 v[34:35], v[34:35], v[64:65] op_sel_hi:[1,0]
    v_cvt_pk_bf16_f32 v10, v32, v33
    v_cvt_pk_bf16_f32 v11, v34, v35
    global_store_dwordx2 v5, v[10:11], s[20:21]
    v_add_u32 v5, s16, v5
    v_pk_mul_f32 v[36:37], v[36:37], v[64:65] op_sel_hi:[1,0]
    v_pk_mul_f32 v[38:39], v[38:39], v[64:65] op_sel_hi:[1,0]
    v_cvt_pk_bf16_f32 v12, v36, v37
    v_cvt_pk_bf16_f32 v13, v38, v39
    global_store_dwordx2 v5, v[12:13], s[20:21]
    v_add_u32 v5, s16, v5
    v_pk_mul_f32 v[40:41], v[40:41], v[64:65] op_sel_hi:[1,0]
    v_pk_mul_f32 v[42:43], v[42:43], v[64:65] op_sel_hi:[1,0]
    v_cvt_pk_bf16_f32 v14, v40, v41
    v_cvt_pk_bf16_f32 v15, v42, v43
    global_store_dwordx2 v5, v[14:15], s[20:21]
    v_add_u32 v5, s16, v5
    v_pk_mul_f32 v[44:45], v[44:45], v[64:65] op_sel_hi:[1,0]
    v_pk_mul_f32 v[46:47], v[46:47], v[64:65] op_sel_hi:[1,0]
    v_cvt_pk_bf16_f32 v16, v44, v45
    v_cvt_pk_bf16_f32 v17, v46, v47
    global_store_dwordx2 v5, v[16:17], s[20:21]
    v_add_u32 v5, s16, v5
    v_pk_mul_f32 v[48:49], v[48:49], v[64:65] op_sel_hi:[1,0]
    v_pk_mul_f32 v[50:51], v[50:51], v[64:65] op_sel_hi:[1,0]
    v_cvt_pk_bf16_f32 v18, v48, v49
    v_cvt_pk_bf16_f32 v19, v50, v51
    global_store_dwordx2 v5, v[18:19], s[20:21]
    v_add_u32 v5, s16, v5
    v_pk_mul_f32 v[52:53], v[52:53], v[64:65] op_sel_hi:[1,0]
    v_pk_mul_f32 v[54:55], v[54:55], v[64:65] op_sel_hi:[1,0]
    v_cvt_pk_bf16_f32 v20, v52, v53
    v_cvt_pk_bf16_f32 v21, v54, v55
    global_store_dwordx2 v5, v[20:21], s[20:21]
    v_add_u32 v5, s16, v5
    v_pk_mul_f32 v[56:57], v[56:57], v[64:65] op_sel_hi:[1,0]
    v_pk_mul_f32 v[58:59], v[58:59], v[64:65] op_sel_hi:[1,0]
    v_cvt_pk_bf16_f32 v22, v56, v57
    v_cvt_pk_bf16_f32 v23, v58, v59
    global_store_dwordx2 v5, v[22:23], s[20:21]
    v_add_u32 v5, s16, v5
    v_pk_mul_f32 v[60:61], v[60:61], v[64:65] op_sel_hi:[1,0]
    v_pk_mul_f32 v[62:63], v[62:63], v[64:65] op_sel_hi:[1,0]
    v_cvt_pk_bf16_f32 v24, v60, v61
    v_cvt_pk_bf16_f32 v25, v62, v63
    global_store_dwordx2 v5, v[24:25], s[20:21]
    s_endpgm
K1_pack:
    s_cmp_ge_u32 s2, 582
    s_cbranch_scc1 K1_warm
    s_load_dwordx8 s[4:11], s[0:1], 8
    v_lshrrev_b32 v1, 6, v0
    v_and_b32 v2, 63, v0
    v_readfirstlane_b32 s3, v1
    s_sub_u32 s12, s2, 240
    s_lshl_b32 s12, s12, 2
    v_and_b32 v3, 31, v2
    v_lshrrev_b32 v4, 5, v2
    s_add_u32 s12, s12, s3
    s_mul_hi_u32 s13, s12, 119304648
    s_mul_i32 s14, s13, 36
    s_sub_u32 s14, s12, s14
    v_and_b32 v5, 0x13, v3
    v_bfe_u32 v6, v3, 2, 1
    v_lshl_add_u32 v5, v6, 3, v5
    v_bfe_u32 v6, v3, 3, 1
    v_lshl_add_u32 v5, v6, 2, v5
    s_waitcnt lgkmcnt(0)
    s_mov_b32 s24, s4
    s_mov_b32 s25, s5
    s_mov_b32 s26, 663552
    s_mov_b32 s27, 0x20000
    s_movk_i32 s28, 1152
    s_lshl_b32 s29, s14, 4
    s_mov_b32 s30, 8
    s_movk_i32 s31, 2304
    s_lshl_b32 s15, s13, 6
    s_mov_b32 s16, 32
    s_cmp_lt_u32 s13, 18
    s_cbranch_scc1 K1_pack_go
    s_cmp_ge_u32 s13, 20
    s_cbranch_scc1 K1_pack_wo
    s_cmp_eq_u32 s13, 18
    s_cselect_b32 s24, s6, s8
    s_cselect_b32 s25, s7, s9
    s_movk_i32 s26, 20736
    s_mov_b32 s28, 36
    s_movk_i32 s31, 72
    s_mov_b32 s15, 0
    s_mov_b32 s16, 18
    s_branch K1_pack_go
K1_pack_wo:
    s_mov_b32 s24, s10
    s_mov_b32 s25, s11
    s_sub_u32 s12, s12, 720
    s_mul_hi_u32 s13, s12, 238609295
    s_mul_i32 s14, s13, 18
    s_sub_u32 s14, s12, s14
    s_lshl_b32 s15, s13, 5
    v_and_b32 v5, 15, v2
    s_mul_hi_u32 s12, s13, 477218589
    s_mul_i32 s12, s12, 54
    s_mul_i32 s17, s13, 9
    s_add_u32 s12, s12, s17
    s_add_u32 s12, s12, s14
    s_mov_b32 s29, 0
    s_cmp_lt_u32 s14, 9
    s_cbranch_scc1 K1_wo_d
    s_movk_i32 s29, 288
    s_sub_u32 s14, s14, 9
    s_mul_hi_u32 s12, s13, 715827883
    s_mul_i32 s12, s12, 129
    s_mul_i32 s17, s14, 6
    s_add_u32 s12, s12, s17
    s_add_u32 s12, s12, s13
    s_add_u32 s12, s12, 81
    s_cmp_lt_u32 s13, 24
    s_cbranch_scc1 K1_wo_d
    s_mul_hi_u32 s12, s13, 1431655766
    s_mul_i32 s12, s12, 24
    s_mul_i32 s17, s14, 3
    s_add_u32 s12, s12, s17
    s_add_u32 s12, s12, s13
    s_add_u32 s12, s12, 324
K1_wo_d:
    s_add_u32 s12, s12, 720
    v_lshrrev_b32 v4, 4, v2
    s_add_u32 s29, s29, 16
    s_movk_i32 s30, 72
    s_movk_i32 s31, 20736
    s_cmp_eq_u32 s14, 8
    s_cbranch_scc1 K1_pack_go
    s_mul_i32 s17, s14, 36
    s_add_u32 s29, s29, s17
    s_sub_u32 s29, s29, 16
    s_mov_b32 s30, 2
    s_movk_i32 s31, 2304
    v_lshrrev_b32 v6, 1, v4
    v_lshl_add_u32 v4, v4, 2, v6
K1_pack_go:
    v_mov_b32 v7, s29
    v_mad_u32_u24 v7, v4, s30, v7
    v_mul_u32_u24 v7, s28, v7
    v_lshl_add_u32 v7, v5, 1, v7
    v_cmp_gt_u32 vcc, s16, v5
    v_mov_b32 v8, 0x7fffffff
    s_add_u32 s17, s15, s28
    v_cndmask_b32 v7, v8, v7, vcc
    buffer_load_ushort v10, v7, s[24:27], s15 offen
    buffer_load_ushort v11, v7, s[24:27], s17 offen
    s_add_u32 s15, s15, s31
    s_add_u32 s17, s17, s31
    buffer_load_ushort v12, v7, s[24:27], s15 offen
    buffer_load_ushort v13, v7, s[24:27], s17 offen
    s_add_u32 s15, s15, s31
    s_add_u32 s17, s17, s31
    buffer_load_ushort v14, v7, s[24:27], s15 offen
    buffer_load_ushort v15, v7, s[24:27], s17 offen
    s_add_u32 s15, s15, s31
    s_add_u32 s17, s17, s31
    buffer_load_ushort v16, v7, s[24:27], s15 offen
    buffer_load_ushort v17, v7, s[24:27], s17 offen
    s_lshl_b32 s12, s12, 10
    s_add_u32 s12, s12, 0x40000
    v_lshl_add_u32 v9, v2, 4, s12
    s_waitcnt vmcnt(0)
    v_lshl_or_b32 v20, v11, 16, v10
    v_lshl_or_b32 v21, v13, 16, v12
    v_lshl_or_b32 v22, v15, 16, v14
    v_lshl_or_b32 v23, v17, 16, v16
    global_store_dwordx4 v9, v[20:23], s[20:21]
    s_endpgm
K1_zero:
    s_sub_u32 s3, s2, 108
    s_lshl_b32 s3, s3, 15
    s_add_u32 s3, s3, 0x200000
    v_lshl_add_u32 v1, v0, 4, s3
    v_mov_b32 v4, 0
    v_mov_b32 v5, 0
    v_mov_b32 v6, 0
    v_mov_b32 v7, 0
    s_mov_b32 s4, 8
    s_waitcnt lgkmcnt(0)
K1_zloop:
    global_store_dwordx4 v1, v[4:7], s[20:21]
    v_add_u32 v1, 0x1000, v1
    s_sub_u32 s4, s4, 1
    s_cmp_lg_u32 s4, 0
    s_cbranch_scc1 K1_zloop
    s_endpgm
K1_warm:
    s_cmp_ge_u32 s2, 598
    s_cbranch_scc1 K1_end
    s_load_dwordx4 s[4:7], s[0:1], 48
    s_load_dwordx2 s[8:9], s[0:1], 64
    v_lshlrev_b32 v1, 20, v0
    s_mov_b32 s22, 0x2000000
    s_mov_b32 s23, 0x20000
    s_mov_b32 s10, 5308416
    s_mov_b32 s11, 0x20000
    s_mov_b32 s14, 5308416
    s_mov_b32 s15, 0x20000
    s_mov_b32 s18, 5308416
    s_mov_b32 s19, 0x20000
    s_getpc_b64 s[28:29]
K1_pc:
    s_add_u32 s28, s28, k2_qkv_kernel-K1_pc
    s_addc_u32 s29, s29, 0
    v_lshlrev_b32 v2, 7, v0
    v_min_u32 v2, k5_ffn_kernel-k2_qkv_kernel-4, v2
    global_load_dword v10, v2, s[28:29]
    s_waitcnt lgkmcnt(0)
    s_mov_b32 s12, s4
    s_mov_b32 s13, s5
    s_mov_b32 s16, s6
    s_mov_b32 s17, s7
    buffer_load_dword v7, v1, s[20:23], 0 offen
    buffer_load_dword v4, v1, s[8:11], 0 offen
    buffer_load_dword v5, v1, s[12:15], 0 offen
    buffer_load_dword v6, v1, s[16:19], 0 offen
    s_waitcnt vmcnt(0)
K1_end:
    s_endpgm
.globl k2_qkv_kernel
.p2align 8
.type k2_qkv_kernel,@function
k2_qkv_kernel:
    s_cmp_ge_u32 s2, 256
    s_cbranch_scc1 K2_end
    s_load_dwordx2 s[8:9], s[0:1], 104
    v_lshrrev_b32 v2, 6, v0
    v_and_b32 v3, 63, v0
    v_readfirstlane_b32 s3, v2
    v_lshlrev_b32 v1, 4, v3
    s_mov_b32 s10, 0x10000000
    s_mov_b32 s11, 0x20000
    s_and_b32 s4, s2, 7
    s_lshl_b32 s4, s4, 3
    s_lshr_b32 s5, s2, 5
    s_add_u32 s4, s4, s5
    v_lshrrev_b32 v4, 5, v3
    s_cmp_ge_u32 s3, 9
    s_cbranch_scc1 K2_gemm
    s_mov_b32 s18, 0xffff0000
    s_lshl_b32 s6, s3, 10
    s_add_u32 s6, s6, 36864
    s_mov_b32 m0, s6
    s_lshl_b32 s7, s3, 8
    v_add_u32 v5, 2048, v1
    v_cmp_gt_u32 vcc, 16, v3
    s_lshl_b32 s13, s3, 12
    s_mul_i32 s12, s4, 36864
    v_cndmask_b32 v5, v5, v1, vcc
    s_add_u32 s12, s12, s13
    s_add_u32 s12, s12, 0x300000
    s_waitcnt lgkmcnt(0)
    buffer_load_dwordx4 v5, s[8:11], s7 offen lds
    buffer_load_dwordx4 v[12:15], v1, s[8:11], s12 offen offset:0
    buffer_load_dwordx4 v[16:19], v1, s[8:11], s12 offen offset:1024
    buffer_load_dwordx4 v[20:23], v1, s[8:11], s12 offen offset:2048
    buffer_load_dwordx4 v[24:27], v1, s[8:11], s12 offen offset:3072
    v_lshl_add_u32 v5, v4, 5, s6
    v_add_u32 v6, s13, v1
    s_waitcnt vmcnt(4)
    ds_read_b128 v[28:31], v5 offset:0
    ds_read_b128 v[32:35], v5 offset:16
    ds_read_b128 v[36:39], v5 offset:256
    ds_read_b128 v[40:43], v5 offset:272
    ds_read_b128 v[44:47], v5 offset:64
    ds_read_b128 v[48:51], v5 offset:80
    ds_read_b128 v[52:55], v5 offset:320
    ds_read_b128 v[56:59], v5 offset:336
    ds_read_b128 v[60:63], v5 offset:128
    ds_read_b128 v[64:67], v5 offset:144
    ds_read_b128 v[68:71], v5 offset:384
    ds_read_b128 v[72:75], v5 offset:400
    ds_read_b128 v[76:79], v5 offset:192
    ds_read_b128 v[80:83], v5 offset:208
    ds_read_b128 v[84:87], v5 offset:448
    ds_read_b128 v[88:91], v5 offset:464
    s_waitcnt vmcnt(3)
    v_lshlrev_b32 v92, 16, v12
    v_and_b32 v93, s18, v12
    v_lshlrev_b32 v94, 16, v13
    v_and_b32 v95, s18, v13
    v_lshlrev_b32 v96, 16, v14
    v_and_b32 v97, s18, v14
    v_lshlrev_b32 v98, 16, v15
    v_and_b32 v99, s18, v15
    s_waitcnt lgkmcnt(12)
    v_pk_fma_f32 v[92:93], v[92:93], v[36:37], v[28:29]
    v_pk_fma_f32 v[94:95], v[94:95], v[38:39], v[30:31]
    v_pk_fma_f32 v[96:97], v[96:97], v[40:41], v[32:33]
    v_pk_fma_f32 v[98:99], v[98:99], v[42:43], v[34:35]
    v_cvt_pk_bf16_f32 v12, v92, v93
    v_cvt_pk_bf16_f32 v13, v94, v95
    v_cvt_pk_bf16_f32 v14, v96, v97
    v_cvt_pk_bf16_f32 v15, v98, v99
    ds_write_b128 v6, v[12:15] offset:0
    s_waitcnt vmcnt(2)
    v_lshlrev_b32 v100, 16, v16
    v_and_b32 v101, s18, v16
    v_lshlrev_b32 v102, 16, v17
    v_and_b32 v103, s18, v17
    v_lshlrev_b32 v104, 16, v18
    v_and_b32 v105, s18, v18
    v_lshlrev_b32 v106, 16, v19
    v_and_b32 v107, s18, v19
    s_waitcnt lgkmcnt(9)
    v_pk_fma_f32 v[100:101], v[100:101], v[52:53], v[44:45]
    v_pk_fma_f32 v[102:103], v[102:103], v[54:55], v[46:47]
    v_pk_fma_f32 v[104:105], v[104:105], v[56:57], v[48:49]
    v_pk_fma_f32 v[106:107], v[106:107], v[58:59], v[50:51]
    v_cvt_pk_bf16_f32 v16, v100, v101
    v_cvt_pk_bf16_f32 v17, v102, v103
    v_cvt_pk_bf16_f32 v18, v104, v105
    v_cvt_pk_bf16_f32 v19, v106, v107
    ds_write_b128 v6, v[16:19] offset:1024
    s_waitcnt vmcnt(1)
    v_lshlrev_b32 v108, 16, v20
    v_and_b32 v109, s18, v20
    v_lshlrev_b32 v110, 16, v21
    v_and_b32 v111, s18, v21
    v_lshlrev_b32 v112, 16, v22
    v_and_b32 v113, s18, v22
    v_lshlrev_b32 v114, 16, v23
    v_and_b32 v115, s18, v23
    s_waitcnt lgkmcnt(6)
    v_pk_fma_f32 v[108:109], v[108:109], v[68:69], v[60:61]
    v_pk_fma_f32 v[110:111], v[110:111], v[70:71], v[62:63]
    v_pk_fma_f32 v[112:113], v[112:113], v[72:73], v[64:65]
    v_pk_fma_f32 v[114:115], v[114:115], v[74:75], v[66:67]
    v_cvt_pk_bf16_f32 v20, v108, v109
    v_cvt_pk_bf16_f32 v21, v110, v111
    v_cvt_pk_bf16_f32 v22, v112, v113
    v_cvt_pk_bf16_f32 v23, v114, v115
    ds_write_b128 v6, v[20:23] offset:2048
    s_waitcnt vmcnt(0)
    v_lshlrev_b32 v116, 16, v24
    v_and_b32 v117, s18, v24
    v_lshlrev_b32 v118, 16, v25
    v_and_b32 v119, s18, v25
    v_lshlrev_b32 v120, 16, v26
    v_and_b32 v121, s18, v26
    v_lshlrev_b32 v122, 16, v27
    v_and_b32 v123, s18, v27
    s_waitcnt lgkmcnt(3)
    v_pk_fma_f32 v[116:117], v[116:117], v[84:85], v[76:77]
    v_pk_fma_f32 v[118:119], v[118:119], v[86:87], v[78:79]
    v_pk_fma_f32 v[120:121], v[120:121], v[88:89], v[80:81]
    v_pk_fma_f32 v[122:123], v[122:123], v[90:91], v[82:83]
    v_cvt_pk_bf16_f32 v24, v116, v117
    v_cvt_pk_bf16_f32 v25, v118, v119
    v_cvt_pk_bf16_f32 v26, v120, v121
    v_cvt_pk_bf16_f32 v27, v122, v123
    ds_write_b128 v6, v[24:27] offset:3072
    s_waitcnt lgkmcnt(0)
    s_barrier
    s_endpgm
K2_gemm:
    s_bfe_u32 s5, s2, 0x20003
    s_mul_i32 s5, s5, 5
    s_add_u32 s5, s5, s3
    s_sub_u32 s5, s5, 9
    s_mul_i32 s14, s5, 36864
    s_add_u32 s14, s14, 0x40000
    s_waitcnt lgkmcnt(0)
    buffer_load_dwordx4 v[48:51], v1, s[8:11], s14 offen offset:0
    buffer_load_dwordx4 v[52:55], v1, s[8:11], s14 offen offset:1024
    buffer_load_dwordx4 v[56:59], v1, s[8:11], s14 offen offset:2048
    buffer_load_dwordx4 v[60:63], v1, s[8:11], s14 offen offset:3072
    s_add_u32 s14, s14, 0x1000
    buffer_load_dwordx4 v[64:67], v1, s[8:11], s14 offen offset:0
    buffer_load_dwordx4 v[68:71], v1, s[8:11], s14 offen offset:1024
    buffer_load_dwordx4 v[72:75], v1, s[8:11], s14 offen offset:2048
    buffer_load_dwordx4 v[76:79], v1, s[8:11], s14 offen offset:3072
    s_add_u32 s14, s14, 0x1000
    buffer_load_dwordx4 v[80:83], v1, s[8:11], s14 offen offset:0
    buffer_load_dwordx4 v[84:87], v1, s[8:11], s14 offen offset:1024
    buffer_load_dwordx4 v[88:91], v1, s[8:11], s14 offen offset:2048
    buffer_load_dwordx4 v[92:95], v1, s[8:11], s14 offen offset:3072
    s_add_u32 s14, s14, 0x1000
    buffer_load_dwordx4 v[96:99], v1, s[8:11], s14 offen offset:0
    buffer_load_dwordx4 v[100:103], v1, s[8:11], s14 offen offset:1024
    buffer_load_dwordx4 v[104:107], v1, s[8:11], s14 offen offset:2048
    buffer_load_dwordx4 v[108:111], v1, s[8:11], s14 offen offset:3072
    s_add_u32 s14, s14, 0x1000
    buffer_load_dwordx4 v[112:115], v1, s[8:11], s14 offen offset:0
    buffer_load_dwordx4 v[116:119], v1, s[8:11], s14 offen offset:1024
    buffer_load_dwordx4 v[120:123], v1, s[8:11], s14 offen offset:2048
    buffer_load_dwordx4 v[124:127], v1, s[8:11], s14 offen offset:3072
    s_add_u32 s14, s14, 0x1000
    s_cmp_eq_u32 s5, 19
    s_cbranch_scc1 K2_v
    s_barrier
    ds_read_b128 v[28:31], v1 offset:0
    ds_read_b128 v[32:35], v1 offset:1024
    ds_read_b128 v[36:39], v1 offset:2048
    ds_read_b128 v[40:43], v1 offset:3072
    ds_read_b128 v[44:47], v1 offset:4096
    s_waitcnt vmcnt(19) lgkmcnt(4)
    v_mfma_f32_32x32x16_bf16 v[12:27], v[48:51], v[28:31], 0
    ds_read_b128 v[28:31], v1 offset:5120
    buffer_load_dwordx4 v[48:51], v1, s[8:11], s14 offen offset:0
    s_waitcnt vmcnt(19) lgkmcnt(4)
    v_mfma_f32_32x32x16_bf16 v[12:27], v[52:55], v[32:35], v[12:27]
    ds_read_b128 v[32:35], v1 offset:6144
    buffer_load_dwordx4 v[52:55], v1, s[8:11], s14 offen offset:1024
    s_waitcnt vmcnt(19) lgkmcnt(4)
    v_mfma_f32_32x32x16_bf16 v[12:27], v[56:59], v[36:39], v[12:27]
    ds_read_b128 v[36:39], v1 offset:7168
    buffer_load_dwordx4 v[56:59], v1, s[8:11], s14 offen offset:2048
    s_waitcnt vmcnt(19) lgkmcnt(4)
    v_mfma_f32_32x32x16_bf16 v[12:27], v[60:63], v[40:43], v[12:27]
    ds_read_b128 v[40:43], v1 offset:8192
    buffer_load_dwordx4 v[60:63], v1, s[8:11], s14 offen offset:3072
    s_add_u32 s14, s14, 0x1000
    s_waitcnt vmcnt(19) lgkmcnt(4)
    v_mfma_f32_32x32x16_bf16 v[12:27], v[64:67], v[44:47], v[12:27]
    ds_read_b128 v[44:47], v1 offset:9216
    buffer_load_dwordx4 v[64:67], v1, s[8:11], s14 offen offset:0
    s_waitcnt vmcnt(19) lgkmcnt(4)
    v_mfma_f32_32x32x16_bf16 v[12:27], v[68:71], v[28:31], v[12:27]
    ds_read_b128 v[28:31], v1 offset:10240
    buffer_load_dwordx4 v[68:71], v1, s[8:11], s14 offen offset:1024
    s_waitcnt vmcnt(19) lgkmcnt(4)
    v_mfma_f32_32x32x16_bf16 v[12:27], v[72:75], v[32:35], v[12:27]
    ds_read_b128 v[32:35], v1 offset:11264
    buffer_load_dwordx4 v[72:75], v1, s[8:11], s14 offen offset:2048
    s_waitcnt vmcnt(19) lgkmcnt(4)
    v_mfma_f32_32x32x16_bf16 v[12:27], v[76:79], v[36:39], v[12:27]
    ds_read_b128 v[36:39], v1 offset:12288
    buffer_load_dwordx4 v[76:79], v1, s[8:11], s14 offen offset:3072
    s_add_u32 s14, s14, 0x1000
    s_waitcnt vmcnt(19) lgkmcnt(4)
    v_mfma_f32_32x32x16_bf16 v[12:27], v[80:83], v[40:43], v[12:27]
    ds_read_b128 v[40:43], v1 offset:13312
    buffer_load_dwordx4 v[80:83], v1, s[8:11], s14 offen offset:0
    s_waitcnt vmcnt(19) lgkmcnt(4)
    v_mfma_f32_32x32x16_bf16 v[12:27], v[84:87], v[44:47], v[12:27]
    ds_read_b128 v[44:47], v1 offset:14336
    buffer_load_dwordx4 v[84:87], v1, s[8:11], s14 offen offset:1024
    s_waitcnt vmcnt(19) lgkmcnt(4)
    v_mfma_f32_32x32x16_bf16 v[12:27], v[88:91], v[28:31], v[12:27]
    ds_read_b128 v[28:31], v1 offset:15360
    buffer_load_dwordx4 v[88:91], v1, s[8:11], s14 offen offset:2048
    s_waitcnt vmcnt(19) lgkmcnt(4)
    v_mfma_f32_32x32x16_bf16 v[12:27], v[92:95], v[32:35], v[12:27]
    ds_read_b128 v[32:35], v1 offset:16384
    buffer_load_dwordx4 v[92:95], v1, s[8:11], s14 offen offset:3072
    s_add_u32 s14, s14, 0x1000
    s_waitcnt vmcnt(19) lgkmcnt(4)
    v_mfma_f32_32x32x16_bf16 v[12:27], v[96:99], v[36:39], v[12:27]
    ds_read_b128 v[36:39], v1 offset:17408
    buffer_load_dwordx4 v[96:99], v1, s[8:11], s14 offen offset:0
    s_waitcnt vmcnt(19) lgkmcnt(4)
    v_mfma_f32_32x32x16_bf16 v[12:27], v[100:103], v[40:43], v[12:27]
    ds_read_b128 v[40:43], v1 offset:18432
    buffer_load_dwordx4 v[100:103], v1, s[8:11], s14 offen offset:1024
    s_waitcnt vmcnt(19) lgkmcnt(4)
    v_mfma_f32_32x32x16_bf16 v[12:27], v[104:107], v[44:47], v[12:27]
    ds_read_b128 v[44:47], v1 offset:19456
    buffer_load_dwordx4 v[104:107], v1, s[8:11], s14 offen offset:2048
    s_waitcnt vmcnt(19) lgkmcnt(4)
    v_mfma_f32_32x32x16_bf16 v[12:27], v[108:111], v[28:31], v[12:27]
    ds_read_b128 v[28:31], v1 offset:20480
    buffer_load_dwordx4 v[108:111], v1, s[8:11], s14 offen offset:3072
    s_waitcnt vmcnt(19) lgkmcnt(4)
    v_mfma_f32_32x32x16_bf16 v[12:27], v[112:115], v[32:35], v[12:27]
    ds_read_b128 v[32:35], v1 offset:21504
    s_waitcnt vmcnt(18) lgkmcnt(4)
    v_mfma_f32_32x32x16_bf16 v[12:27], v[116:119], v[36:39], v[12:27]
    ds_read_b128 v[36:39], v1 offset:22528
    s_waitcnt vmcnt(17) lgkmcnt(4)
    v_mfma_f32_32x32x16_bf16 v[12:27], v[120:123], v[40:43], v[12:27]
    ds_read_b128 v[40:43], v1 offset:23552
    s_waitcnt vmcnt(16) lgkmcnt(4)
    v_mfma_f32_32x32x16_bf16 v[12:27], v[124:127], v[44:47], v[12:27]
    ds_read_b128 v[44:47], v1 offset:24576
    s_waitcnt vmcnt(15) lgkmcnt(4)
    v_mfma_f32_32x32x16_bf16 v[12:27], v[48:51], v[28:31], v[12:27]
    ds_read_b128 v[28:31], v1 offset:25600
    s_waitcnt vmcnt(14) lgkmcnt(4)
    v_mfma_f32_32x32x16_bf16 v[12:27], v[52:55], v[32:35], v[12:27]
    ds_read_b128 v[32:35], v1 offset:26624
    s_waitcnt vmcnt(13) lgkmcnt(4)
    v_mfma_f32_32x32x16_bf16 v[12:27], v[56:59], v[36:39], v[12:27]
    ds_read_b128 v[36:39], v1 offset:27648
    s_waitcnt vmcnt(12) lgkmcnt(4)
    v_mfma_f32_32x32x16_bf16 v[12:27], v[60:63], v[40:43], v[12:27]
    ds_read_b128 v[40:43], v1 offset:28672
    s_waitcnt vmcnt(11) lgkmcnt(4)
    v_mfma_f32_32x32x16_bf16 v[12:27], v[64:67], v[44:47], v[12:27]
    ds_read_b128 v[44:47], v1 offset:29696
    s_waitcnt vmcnt(10) lgkmcnt(4)
    v_mfma_f32_32x32x16_bf16 v[12:27], v[68:71], v[28:31], v[12:27]
    ds_read_b128 v[28:31], v1 offset:30720
    s_waitcnt vmcnt(9) lgkmcnt(4)
    v_mfma_f32_32x32x16_bf16 v[12:27], v[72:75], v[32:35], v[12:27]
    ds_read_b128 v[32:35], v1 offset:31744
    s_waitcnt vmcnt(8) lgkmcnt(4)
    v_mfma_f32_32x32x16_bf16 v[12:27], v[76:79], v[36:39], v[12:27]
    ds_read_b128 v[36:39], v1 offset:32768
    s_waitcnt vmcnt(7) lgkmcnt(4)
    v_mfma_f32_32x32x16_bf16 v[12:27], v[80:83], v[40:43], v[12:27]
    ds_read_b128 v[40:43], v1 offset:33792
    s_waitcnt vmcnt(6) lgkmcnt(4)
    v_mfma_f32_32x32x16_bf16 v[12:27], v[84:87], v[44:47], v[12:27]
    ds_read_b128 v[44:47], v1 offset:34816
    s_waitcnt vmcnt(5) lgkmcnt(4)
    v_mfma_f32_32x32x16_bf16 v[12:27], v[88:91], v[28:31], v[12:27]
    ds_read_b128 v[28:31], v1 offset:35840
    s_waitcnt vmcnt(4) lgkmcnt(4)
    v_mfma_f32_32x32x16_bf16 v[12:27], v[92:95], v[32:35], v[12:27]
    s_waitcnt vmcnt(3) lgkmcnt(3)
    v_mfma_f32_32x32x16_bf16 v[12:27], v[96:99], v[36:39], v[12:27]
    s_waitcnt vmcnt(2) lgkmcnt(2)
    v_mfma_f32_32x32x16_bf16 v[12:27], v[100:103], v[40:43], v[12:27]
    s_waitcnt vmcnt(1) lgkmcnt(1)
    v_mfma_f32_32x32x16_bf16 v[12:27], v[104:107], v[44:47], v[12:27]
    s_waitcnt vmcnt(0) lgkmcnt(0)
    v_mfma_f32_32x32x16_bf16 v[12:27], v[108:111], v[28:31], v[12:27]
    v_and_b32 v7, 31, v3
    s_cmp_eq_u32 s5, 18
    s_cbranch_scc1 K2_k
    s_lshl_b32 s6, s4, 5
    v_add_u32 v7, s6, v7
    v_mul_u32_u24 v7, 1152, v7
    v_lshl_add_u32 v7, v4, 4, v7
    s_lshl_b32 s6, s5, 6
    s_add_u32 s6, s6, 0x600000
    s_mov_b32 s20, 0.3400464821989298
    s_nop 3
    v_mul_f32 v12, s20, v12
    v_mul_f32 v13, s20, v13
    v_mul_f32 v14, s20, v14
    v_mul_f32 v15, s20, v15
    v_mul_f32 v16, s20, v16
    v_mul_f32 v17, s20, v17
    v_mul_f32 v18, s20, v18
    v_mul_f32 v19, s20, v19
    v_mul_f32 v20, s20, v20
    v_mul_f32 v21, s20, v21
    v_mul_f32 v22, s20, v22
    v_mul_f32 v23, s20, v23
    v_mul_f32 v24, s20, v24
    v_mul_f32 v25, s20, v25
    v_mul_f32 v26, s20, v26
    v_mul_f32 v27, s20, v27
    v_cvt_pk_bf16_f32 v28, v12, v13
    v_cvt_pk_bf16_f32 v29, v14, v15
    v_cvt_pk_bf16_f32 v30, v16, v17
    v_cvt_pk_bf16_f32 v31, v18, v19
    v_cvt_pk_bf16_f32 v32, v20, v21
    v_cvt_pk_bf16_f32 v33, v22, v23
    v_cvt_pk_bf16_f32 v34, v24, v25
    v_cvt_pk_bf16_f32 v35, v26, v27
    buffer_store_dwordx4 v[28:31], v7, s[8:11], s6 offen
    buffer_store_dwordx4 v[32:35], v7, s[8:11], s6 offen offset:32
    s_endpgm
K2_k:
    s_mul_i32 s6, s4, 2368
    s_add_u32 s6, s6, 0x10000
    v_lshlrev_b32 v7, 2, v3
    v_cmp_gt_u32 vcc, 32, v3
    v_mov_b32 v8, 0x7fffffff
    s_nop 4
    v_cndmask_b32 v7, v8, v7, vcc
    v_cvt_pk_bf16_f32 v28, v12, v13
    v_cvt_pk_bf16_f32 v29, v14, v15
    v_cvt_pk_bf16_f32 v30, v16, v17
    v_cvt_pk_bf16_f32 v31, v18, v19
    v_cvt_pk_bf16_f32 v32, v20, v21
    buffer_store_dwordx4 v[28:31], v1, s[8:11], s6 offen
    buffer_store_dword v32, v7, s[8:11], s6 offen offset:2240
    s_endpgm
K2_v:
    s_barrier
    ds_read_b128 v[28:31], v1 offset:0
    ds_read_b128 v[32:35], v1 offset:1024
    ds_read_b128 v[36:39], v1 offset:2048
    ds_read_b128 v[40:43], v1 offset:3072
    ds_read_b128 v[44:47], v1 offset:4096
    s_waitcnt vmcnt(19) lgkmcnt(4)
    v_mfma_f32_32x32x16_bf16 v[12:27], v[28:31], v[48:51], 0
    ds_read_b128 v[28:31], v1 offset:5120
    buffer_load_dwordx4 v[48:51], v1, s[8:11], s14 offen offset:0
    s_waitcnt vmcnt(19) lgkmcnt(4)
    v_mfma_f32_32x32x16_bf16 v[12:27], v[32:35], v[52:55], v[12:27]
    ds_read_b128 v[32:35], v1 offset:6144
    buffer_load_dwordx4 v[52:55], v1, s[8:11], s14 offen offset:1024
    s_waitcnt vmcnt(19) lgkmcnt(4)
    v_mfma_f32_32x32x16_bf16 v[12:27], v[36:39], v[56:59], v[12:27]
    ds_read_b128 v[36:39], v1 offset:7168
    buffer_load_dwordx4 v[56:59], v1, s[8:11], s14 offen offset:2048
    s_waitcnt vmcnt(19) lgkmcnt(4)
    v_mfma_f32_32x32x16_bf16 v[12:27], v[40:43], v[60:63], v[12:27]
    ds_read_b128 v[40:43], v1 offset:8192
    buffer_load_dwordx4 v[60:63], v1, s[8:11], s14 offen offset:3072
    s_add_u32 s14, s14, 0x1000
    s_waitcnt vmcnt(19) lgkmcnt(4)
    v_mfma_f32_32x32x16_bf16 v[12:27], v[44:47], v[64:67], v[12:27]
    ds_read_b128 v[44:47], v1 offset:9216
    buffer_load_dwordx4 v[64:67], v1, s[8:11], s14 offen offset:0
    s_waitcnt vmcnt(19) lgkmcnt(4)
    v_mfma_f32_32x32x16_bf16 v[12:27], v[28:31], v[68:71], v[12:27]
    ds_read_b128 v[28:31], v1 offset:10240
    buffer_load_dwordx4 v[68:71], v1, s[8:11], s14 offen offset:1024
    s_waitcnt vmcnt(19) lgkmcnt(4)
    v_mfma_f32_32x32x16_bf16 v[12:27], v[32:35], v[72:75], v[12:27]
    ds_read_b128 v[32:35], v1 offset:11264
    buffer_load_dwordx4 v[72:75], v1, s[8:11], s14 offen offset:2048
    s_waitcnt vmcnt(19) lgkmcnt(4)
    v_mfma_f32_32x32x16_bf16 v[12:27], v[36:39], v[76:79], v[12:27]
    ds_read_b128 v[36:39], v1 offset:12288
    buffer_load_dwordx4 v[76:79], v1, s[8:11], s14 offen offset:3072
    s_add_u32 s14, s14, 0x1000
    s_waitcnt vmcnt(19) lgkmcnt(4)
    v_mfma_f32_32x32x16_bf16 v[12:27], v[40:43], v[80:83], v[12:27]
    ds_read_b128 v[40:43], v1 offset:13312
    buffer_load_dwordx4 v[80:83], v1, s[8:11], s14 offen offset:0
    s_waitcnt vmcnt(19) lgkmcnt(4)
    v_mfma_f32_32x32x16_bf16 v[12:27], v[44:47], v[84:87], v[12:27]
    ds_read_b128 v[44:47], v1 offset:14336
    buffer_load_dwordx4 v[84:87], v1, s[8:11], s14 offen offset:1024
    s_waitcnt vmcnt(19) lgkmcnt(4)
    v_mfma_f32_32x32x16_bf16 v[12:27], v[28:31], v[88:91], v[12:27]
    ds_read_b128 v[28:31], v1 offset:15360
    buffer_load_dwordx4 v[88:91], v1, s[8:11], s14 offen offset:2048
    s_waitcnt vmcnt(19) lgkmcnt(4)
    v_mfma_f32_32x32x16_bf16 v[12:27], v[32:35], v[92:95], v[12:27]
    ds_read_b128 v[32:35], v1 offset:16384
    buffer_load_dwordx4 v[92:95], v1, s[8:11], s14 offen offset:3072
    s_add_u32 s14, s14, 0x1000
    s_waitcnt vmcnt(19) lgkmcnt(4)
    v_mfma_f32_32x32x16_bf16 v[12:27], v[36:39], v[96:99], v[12:27]
    ds_read_b128 v[36:39], v1 offset:17408
    buffer_load_dwordx4 v[96:99], v1, s[8:11], s14 offen offset:0
    s_waitcnt vmcnt(19) lgkmcnt(4)
    v_mfma_f32_32x32x16_bf16 v[12:27], v[40:43], v[100:103], v[12:27]
    ds_read_b128 v[40:43], v1 offset:18432
    buffer_load_dwordx4 v[100:103], v1, s[8:11], s14 offen offset:1024
    s_waitcnt vmcnt(19) lgkmcnt(4)
    v_mfma_f32_32x32x16_bf16 v[12:27], v[44:47], v[104:107], v[12:27]
    ds_read_b128 v[44:47], v1 offset:19456
    buffer_load_dwordx4 v[104:107], v1, s[8:11], s14 offen offset:2048
    s_waitcnt vmcnt(19) lgkmcnt(4)
    v_mfma_f32_32x32x16_bf16 v[12:27], v[28:31], v[108:111], v[12:27]
    ds_read_b128 v[28:31], v1 offset:20480
    buffer_load_dwordx4 v[108:111], v1, s[8:11], s14 offen offset:3072
    s_waitcnt vmcnt(19) lgkmcnt(4)
    v_mfma_f32_32x32x16_bf16 v[12:27], v[32:35], v[112:115], v[12:27]
    ds_read_b128 v[32:35], v1 offset:21504
    s_waitcnt vmcnt(18) lgkmcnt(4)
    v_mfma_f32_32x32x16_bf16 v[12:27], v[36:39], v[116:119], v[12:27]
    ds_read_b128 v[36:39], v1 offset:22528
    s_waitcnt vmcnt(17) lgkmcnt(4)
    v_mfma_f32_32x32x16_bf16 v[12:27], v[40:43], v[120:123], v[12:27]
    ds_read_b128 v[40:43], v1 offset:23552
    s_waitcnt vmcnt(16) lgkmcnt(4)
    v_mfma_f32_32x32x16_bf16 v[12:27], v[44:47], v[124:127], v[12:27]
    ds_read_b128 v[44:47], v1 offset:24576
    s_waitcnt vmcnt(15) lgkmcnt(4)
    v_mfma_f32_32x32x16_bf16 v[12:27], v[28:31], v[48:51], v[12:27]
    ds_read_b128 v[28:31], v1 offset:25600
    s_waitcnt vmcnt(14) lgkmcnt(4)
    v_mfma_f32_32x32x16_bf16 v[12:27], v[32:35], v[52:55], v[12:27]
    ds_read_b128 v[32:35], v1 offset:26624
    s_waitcnt vmcnt(13) lgkmcnt(4)
    v_mfma_f32_32x32x16_bf16 v[12:27], v[36:39], v[56:59], v[12:27]
    ds_read_b128 v[36:39], v1 offset:27648
    s_waitcnt vmcnt(12) lgkmcnt(4)
    v_mfma_f32_32x32x16_bf16 v[12:27], v[40:43], v[60:63], v[12:27]
    ds_read_b128 v[40:43], v1 offset:28672
    s_waitcnt vmcnt(11) lgkmcnt(4)
    v_mfma_f32_32x32x16_bf16 v[12:27], v[44:47], v[64:67], v[12:27]
    ds_read_b128 v[44:47], v1 offset:29696
    s_waitcnt vmcnt(10) lgkmcnt(4)
    v_mfma_f32_32x32x16_bf16 v[12:27], v[28:31], v[68:71], v[12:27]
    ds_read_b128 v[28:31], v1 offset:30720
    s_waitcnt vmcnt(9) lgkmcnt(4)
    v_mfma_f32_32x32x16_bf16 v[12:27], v[32:35], v[72:75], v[12:27]
    ds_read_b128 v[32:35], v1 offset:31744
    s_waitcnt vmcnt(8) lgkmcnt(4)
    v_mfma_f32_32x32x16_bf16 v[12:27], v[36:39], v[76:79], v[12:27]
    ds_read_b128 v[36:39], v1 offset:32768
    s_waitcnt vmcnt(7) lgkmcnt(4)
    v_mfma_f32_32x32x16_bf16 v[12:27], v[40:43], v[80:83], v[12:27]
    ds_read_b128 v[40:43], v1 offset:33792
    s_waitcnt vmcnt(6) lgkmcnt(4)
    v_mfma_f32_32x32x16_bf16 v[12:27], v[44:47], v[84:87], v[12:27]
    ds_read_b128 v[44:47], v1 offset:34816
    s_waitcnt vmcnt(5) lgkmcnt(4)
    v_mfma_f32_32x32x16_bf16 v[12:27], v[28:31], v[88:91], v[12:27]
    ds_read_b128 v[28:31], v1 offset:35840
    s_waitcnt vmcnt(4) lgkmcnt(4)
    v_mfma_f32_32x32x16_bf16 v[12:27], v[32:35], v[92:95], v[12:27]
    s_waitcnt vmcnt(3) lgkmcnt(3)
    v_mfma_f32_32x32x16_bf16 v[12:27], v[36:39], v[96:99], v[12:27]
    s_waitcnt vmcnt(2) lgkmcnt(2)
    v_mfma_f32_32x32x16_bf16 v[12:27], v[40:43], v[100:103], v[12:27]
    s_waitcnt vmcnt(1) lgkmcnt(1)
    v_mfma_f32_32x32x16_bf16 v[12:27], v[44:47], v[104:107], v[12:27]
    s_waitcnt vmcnt(0) lgkmcnt(0)
    v_mfma_f32_32x32x16_bf16 v[12:27], v[28:31], v[108:111], v[12:27]
    v_and_b32 v7, 31, v3
    s_mul_i32 s6, s4, 2368
    s_add_u32 s6, s6, 0x10000
    v_mul_u32_u24 v9, 19, v4
    v_add_lshl_u32 v9, v9, v7, 4
    v_cmp_gt_u32 vcc, 19, v7
    v_mov_b32 v8, 0x7fffffff
    v_cmp_eq_u32 s[20:21], 18, v7
    v_mov_b32 v10, 0x3f803f80
    v_cndmask_b32 v9, v8, v9, vcc
    s_nop 1
    v_cvt_pk_bf16_f32 v28, v12, v13
    v_cvt_pk_bf16_f32 v29, v14, v15
    v_cvt_pk_bf16_f32 v30, v16, v17
    v_cvt_pk_bf16_f32 v31, v18, v19
    v_cvt_pk_bf16_f32 v32, v20, v21
    v_cvt_pk_bf16_f32 v33, v22, v23
    v_cvt_pk_bf16_f32 v34, v24, v25
    v_cvt_pk_bf16_f32 v35, v26, v27
    v_cndmask_b32 v28, v28, v10, s[20:21]
    v_cndmask_b32 v29, v29, v10, s[20:21]
    v_cndmask_b32 v30, v30, v10, s[20:21]
    v_cndmask_b32 v31, v31, v10, s[20:21]
    v_cndmask_b32 v32, v32, v10, s[20:21]
    v_cndmask_b32 v33, v33, v10, s[20:21]
    v_cndmask_b32 v34, v34, v10, s[20:21]
    v_cndmask_b32 v35, v35, v10, s[20:21]
    buffer_store_dwordx4 v[28:31], v9, s[8:11], s6 offen offset:1024
    buffer_store_dwordx4 v[32:35], v9, s[8:11], s6 offen offset:1632
K2_end:
    s_endpgm
.globl k3_attn_kernel
.p2align 8
.type k3_attn_kernel,@function
k3_attn_kernel:
    s_cmp_ge_u32 s2, 256
    s_cbranch_scc1 K3_end
    s_load_dwordx2 s[8:9], s[0:1], 104
    s_load_dwordx4 s[24:27], s[0:1], 48
    s_load_dwordx2 s[28:29], s[0:1], 64
    s_load_dwordx2 s[48:49], s[0:1], 0
    v_lshrrev_b32 v2, 6, v0
    v_and_b32 v0, 63, v0
    v_readfirstlane_b32 s3, v2
    v_lshlrev_b32 v7, 4, v0
    s_mov_b32 s10, 0x10000000
    s_mov_b32 s11, 0x20000
    s_mov_b32 s14, 151552
    s_mov_b32 s15, 0x20000
    s_mov_b32 s18, 5308416
    s_mov_b32 s19, 0x20000
    s_mov_b32 s22, 15925248
    s_mov_b32 s23, 0x20000
    s_mov_b32 s50, 2359296
    s_mov_b32 s51, 0x20000
    s_and_b32 s4, s2, 7
    s_lshl_b32 s4, s4, 8
    s_and_b32 s5, s2, 0xf8
    s_add_u32 s4, s4, s5
    s_add_u32 s4, s4, s3
    s_lshl_b32 s5, s3, 10
    s_sub_u32 s43, s4, s3
    s_mul_i32 s43, s43, 1152
    s_mul_i32 s6, s3, 144
    s_add_u32 s43, s43, s6
    s_add_u32 s43, s43, 0x600000
    s_mov_b32 s31, 0
    s_mov_b32 s40, 1
K3_restart:
    s_setprio 1
    s_cmp_ge_u32 s3, 4
    s_cbranch_scc1 K3_pr
    s_setprio 2
K3_pr:
    v_lshrrev_b32 v122, 5, v0
    v_and_b32 v123, 31, v0
    v_and_b32 v5, 7, v0
    v_mul_u32_u24 v5, 1152, v5
    v_lshrrev_b32 v6, 3, v123
    v_mul_u32_u24 v6, 36, v6
    v_add_u32 v5, v5, v6
    v_lshl_add_u32 v6, v122, 4, v5
    v_lshl_add_u32 v5, v122, 30, v5
    s_waitcnt lgkmcnt(0)
    s_add_u32 s12, s8, 0x10000
    s_addc_u32 s13, s9, 0
    s_add_u32 s20, s8, 0x1000000
    s_addc_u32 s21, s9, 0
    buffer_load_dwordx4 v[8:11], v6, s[8:11], s43 offen
    buffer_load_dword v12, v5, s[8:11], s43 offen offset:32
    v_lshlrev_b32 v2, 2, v123
    buffer_load_dwordx4 v[72:75], v7, s[12:15], 0 offen
    buffer_load_dword v76, v2, s[12:15], 0 offen offset:2240
    s_mov_b32 m0, s5
    s_nop 0
    buffer_load_dwordx4 v7, s[12:15], m0 offen lds
    s_add_u32 m0, m0, 0x2000
    s_nop 0
    buffer_load_dwordx4 v7, s[12:15], m0 offen lds
    s_add_u32 m0, m0, 0x2000
    s_nop 0
    buffer_load_dwordx4 v7, s[12:15], m0 offen lds
    s_add_u32 m0, m0, 0x2000
    s_nop 0
    s_cmp_ge_u32 s3, 4
    s_cbranch_scc1 K3_noprep
    s_add_u32 s39, s4, s3
    s_lshl_b32 s33, s39, 2
    v_bfe_u32 v104, v0, 2, 2
    v_lshrrev_b32 v105, 4, v0
    s_cmp_ge_u32 s33, 5184
    s_cbranch_scc1 K3_pi0_down
    s_cmp_ge_u32 s33, 2592
    s_cselect_b32 s16, s26, s24
    s_cselect_b32 s17, s27, s25
    s_cselect_b32 s35, 2592, 0
    s_cselect_b32 s37, 2048, 0
    s_sub_u32 s33, s33, s35
    s_mul_hi_u32 s34, s33, 29826162
    s_mul_i32 s35, s34, 144
    s_sub_u32 s33, s33, s35
    s_lshl_b32 s35, s34, 12
    s_add_u32 s37, s37, s35
    s_mul_i32 s34, s34, 294912
    s_lshl_b32 s35, s33, 6
    s_add_u32 s34, s34, s35
    s_mov_b32 s36, 36864
    v_and_b32 v4, 15, v0
    v_lshlrev_b32 v4, 4, v4
    v_mul_u32_u24 v106, 9216, v105
    v_add_u32 v4, v4, v106
    v_add_u32 v105, s33, v105
    s_mov_b32 s35, 477218589
    v_mul_hi_u32 v106, v105, s35
    v_mul_u32_u24 v107, 9, v106
    v_sub_u32 v105, v105, v107
    s_mov_b32 s35, 995328
    v_mul_lo_u32 v106, v106, s35
    v_mul_u32_u24 v105, 73728, v105
    s_branch K3_pi0_end
K3_pi0_down:
    s_sub_u32 s33, s33, 5184
    s_mov_b32 s16, s28
    s_mov_b32 s17, s29
    s_mov_b32 s34, 0
    s_mov_b32 s37, 663552
    s_movk_i32 s36, 4608
    s_mov_b32 s35, 238609295
    v_add_u32 v104, s33, v104
    v_mul_hi_u32 v106, v104, s35
    v_mul_u32_u24 v107, 18, v106
    v_sub_u32 v104, v104, v107
    v_lshl_add_u32 v106, v106, 5, v105
    v_mul_u32_u24 v106, 1152, v106
    v_lshl_add_u32 v106, v104, 6, v106
    v_and_b32 v4, 3, v0
    v_lshl_add_u32 v4, v4, 4, v106
    v_add_u32 v105, s33, v105
    v_mul_hi_u32 v106, v105, s35
    v_mul_u32_u24 v107, 18, v106
    v_sub_u32 v105, v105, v107
    s_mov_b32 s35, 477218589
    v_mul_hi_u32 v107, v106, s35
    v_mul_u32_u24 v104, 9, v107
    v_sub_u32 v104, v106, v104
    v_cmp_le_u32 vcc, 9, v105
    v_subrev_u32 v108, 9, v105
    v_mov_b32 v109, 0
    v_cndmask_b32 v105, v105, v108, vcc
    v_cndmask_b32 v109, v109, 2, vcc
    s_mov_b32 s35, 995328
    v_and_b32 v120, 15, v0
    v_lshlrev_b32 v120, 4, v120
    v_mov_b32 v119, 253
    v_lshl_add_u32 v110, v105, 1, 1
    v_cmp_le_u32 vcc, 9, v110
    v_subrev_u32 v111, 10, v110
    v_min_u32 v111, 8, v111
    v_addc_co_u32 v112, s[44:45], 0, v109, vcc
    v_cndmask_b32 v110, v110, v111, vcc
    v_sub_u32 v113, v107, v112
    v_and_b32 v113, 3, v113
    v_mul_u32_u24 v114, 3, v104
    v_add3_u32 v114, v114, v113, 8
    v_cmp_eq_u32 vcc, 0, v113
    v_and_b32 v115, 0xfc, v107
    v_add_u32 v115, v115, v112
    v_cndmask_b32 v114, v114, v104, vcc
    v_lshrrev_b32 v116, 2, v107
    v_lshrrev_b32 v117, 1, v110
    v_sub_u32 v116, v117, v116
    v_subrev_u32 v116, 1, v116
    v_and_b32 v116, 3, v116
    v_lshl_add_u32 v117, v116, 1, 1
    v_cmp_eq_u32 vcc, 8, v110
    v_mul_u32_u24 v118, 7, v114
    v_lshl_add_u32 v114, v114, 1, v119
    v_cndmask_b32 v117, v117, 6, vcc
    v_cndmask_b32 v116, v116, 0, vcc
    v_add_u32 v118, v118, v117
    v_cmp_eq_u32 vcc, 3, v116
    s_nop 1
    v_cndmask_b32 v114, v118, v114, vcc
    v_lshlrev_b32 v114, 10, v114
    v_mul_lo_u32 v115, v115, s35
    v_add3_u32 v129, v120, v114, v115
    v_mov_b32 v119, 252
    v_lshl_add_u32 v110, v105, 1, 0
    v_cmp_le_u32 vcc, 9, v110
    v_subrev_u32 v111, 10, v110
    v_min_u32 v111, 8, v111
    v_addc_co_u32 v112, s[44:45], 0, v109, vcc
    v_cndmask_b32 v110, v110, v111, vcc
    v_sub_u32 v113, v107, v112
    v_and_b32 v113, 3, v113
    v_mul_u32_u24 v114, 3, v104
    v_add3_u32 v114, v114, v113, 8
    v_cmp_eq_u32 vcc, 0, v113
    v_and_b32 v115, 0xfc, v107
    v_add_u32 v115, v115, v112
    v_cndmask_b32 v114, v114, v104, vcc
    v_lshrrev_b32 v116, 2, v107
    v_lshrrev_b32 v117, 1, v110
    v_sub_u32 v116, v117, v116
    v_subrev_u32 v116, 1, v116
    v_and_b32 v116, 3, v116
    v_lshl_add_u32 v117, v116, 1, 0
    v_cmp_eq_u32 vcc, 8, v110
    v_mul_u32_u24 v118, 7, v114
    v_lshl_add_u32 v114, v114, 1, v119
    v_cndmask_b32 v117, v117, 6, vcc
    v_cndmask_b32 v116, v116, 0, vcc
    v_add_u32 v118, v118, v117
    v_cmp_eq_u32 vcc, 3, v116
    s_nop 1
    v_cndmask_b32 v114, v118, v114, vcc
    v_lshlrev_b32 v114, 10, v114
    v_mul_lo_u32 v115, v115, s35
    v_add3_u32 v120, v120, v114, v115
    s_branch K3_pi0_done
K3_pi0_end:
    v_and_b32 v120, 15, v0
    v_lshlrev_b32 v120, 4, v120
    v_add3_u32 v120, v120, v105, v106
    v_add_u32 v129, 0x400, v120
K3_pi0_done:
    v_mov_b32 v14, v4
    v_mov_b32 v130, v120
    v_mov_b32 v131, v129
    s_mov_b32 s52, s34
    s_mov_b32 s53, s37
    s_add_u32 s39, s39, 1
    s_lshl_b32 s33, s39, 2
    v_bfe_u32 v104, v0, 2, 2
    v_lshrrev_b32 v105, 4, v0
    s_cmp_ge_u32 s33, 5184
    s_cbranch_scc1 K3_pi1_down
    s_cmp_ge_u32 s33, 2592
    s_cselect_b32 s16, s26, s24
    s_cselect_b32 s17, s27, s25
    s_cselect_b32 s35, 2592, 0
    s_cselect_b32 s37, 2048, 0
    s_sub_u32 s33, s33, s35
    s_mul_hi_u32 s34, s33, 29826162
    s_mul_i32 s35, s34, 144
    s_sub_u32 s33, s33, s35
    s_lshl_b32 s35, s34, 12
    s_add_u32 s37, s37, s35
    s_mul_i32 s34, s34, 294912
    s_lshl_b32 s35, s33, 6
    s_add_u32 s34, s34, s35
    s_mov_b32 s36, 36864
    v_and_b32 v4, 15, v0
    v_lshlrev_b32 v4, 4, v4
    v_mul_u32_u24 v106, 9216, v105
    v_add_u32 v4, v4, v106
    v_add_u32 v105, s33, v105
    s_mov_b32 s35, 477218589
    v_mul_hi_u32 v106, v105, s35
    v_mul_u32_u24 v107, 9, v106
    v_sub_u32 v105, v105, v107
    s_mov_b32 s35, 995328
    v_mul_lo_u32 v106, v106, s35
    v_mul_u32_u24 v105, 73728, v105
    s_branch K3_pi1_end
K3_pi1_down:
    s_sub_u32 s33, s33, 5184
    s_mov_b32 s16, s28
    s_mov_b32 s17, s29
    s_mov_b32 s34, 0
    s_mov_b32 s37, 663552
    s_movk_i32 s36, 4608
    s_mov_b32 s35, 238609295
    v_add_u32 v104, s33, v104
    v_mul_hi_u32 v106, v104, s35
    v_mul_u32_u24 v107, 18, v106
    v_sub_u32 v104, v104, v107
    v_lshl_add_u32 v106, v106, 5, v105
    v_mul_u32_u24 v106, 1152, v106
    v_lshl_add_u32 v106, v104, 6, v106
    v_and_b32 v4, 3, v0
    v_lshl_add_u32 v4, v4, 4, v106
    v_add_u32 v105, s33, v105
    v_mul_hi_u32 v106, v105, s35
    v_mul_u32_u24 v107, 18, v106
    v_sub_u32 v105, v105, v107
    s_mov_b32 s35, 477218589
    v_mul_hi_u32 v107, v106, s35
    v_mul_u32_u24 v104, 9, v107
    v_sub_u32 v104, v106, v104
    v_cmp_le_u32 vcc, 9, v105
    v_subrev_u32 v108, 9, v105
    v_mov_b32 v109, 0
    v_cndmask_b32 v105, v105, v108, vcc
    v_cndmask_b32 v109, v109, 2, vcc
    s_mov_b32 s35, 995328
    v_and_b32 v120, 15, v0
    v_lshlrev_b32 v120, 4, v120
    v_mov_b32 v119, 253
    v_lshl_add_u32 v110, v105, 1, 1
    v_cmp_le_u32 vcc, 9, v110
    v_subrev_u32 v111, 10, v110
    v_min_u32 v111, 8, v111
    v_addc_co_u32 v112, s[44:45], 0, v109, vcc
    v_cndmask_b32 v110, v110, v111, vcc
    v_sub_u32 v113, v107, v112
    v_and_b32 v113, 3, v113
    v_mul_u32_u24 v114, 3, v104
    v_add3_u32 v114, v114, v113, 8
    v_cmp_eq_u32 vcc, 0, v113
    v_and_b32 v115, 0xfc, v107
    v_add_u32 v115, v115, v112
    v_cndmask_b32 v114, v114, v104, vcc
    v_lshrrev_b32 v116, 2, v107
    v_lshrrev_b32 v117, 1, v110
    v_sub_u32 v116, v117, v116
    v_subrev_u32 v116, 1, v116
    v_and_b32 v116, 3, v116
    v_lshl_add_u32 v117, v116, 1, 1
    v_cmp_eq_u32 vcc, 8, v110
    v_mul_u32_u24 v118, 7, v114
    v_lshl_add_u32 v114, v114, 1, v119
    v_cndmask_b32 v117, v117, 6, vcc
    v_cndmask_b32 v116, v116, 0, vcc
    v_add_u32 v118, v118, v117
    v_cmp_eq_u32 vcc, 3, v116
    s_nop 1
    v_cndmask_b32 v114, v118, v114, vcc
    v_lshlrev_b32 v114, 10, v114
    v_mul_lo_u32 v115, v115, s35
    v_add3_u32 v129, v120, v114, v115
    v_mov_b32 v119, 252
    v_lshl_add_u32 v110, v105, 1, 0
    v_cmp_le_u32 vcc, 9, v110
    v_subrev_u32 v111, 10, v110
    v_min_u32 v111, 8, v111
    v_addc_co_u32 v112, s[44:45], 0, v109, vcc
    v_cndmask_b32 v110, v110, v111, vcc
    v_sub_u32 v113, v107, v112
    v_and_b32 v113, 3, v113
    v_mul_u32_u24 v114, 3, v104
    v_add3_u32 v114, v114, v113, 8
    v_cmp_eq_u32 vcc, 0, v113
    v_and_b32 v115, 0xfc, v107
    v_add_u32 v115, v115, v112
    v_cndmask_b32 v114, v114, v104, vcc
    v_lshrrev_b32 v116, 2, v107
    v_lshrrev_b32 v117, 1, v110
    v_sub_u32 v116, v117, v116
    v_subrev_u32 v116, 1, v116
    v_and_b32 v116, 3, v116
    v_lshl_add_u32 v117, v116, 1, 0
    v_cmp_eq_u32 vcc, 8, v110
    v_mul_u32_u24 v118, 7, v114
    v_lshl_add_u32 v114, v114, 1, v119
    v_cndmask_b32 v117, v117, 6, vcc
    v_cndmask_b32 v116, v116, 0, vcc
    v_add_u32 v118, v118, v117
    v_cmp_eq_u32 vcc, 3, v116
    s_nop 1
    v_cndmask_b32 v114, v118, v114, vcc
    v_lshlrev_b32 v114, 10, v114
    v_mul_lo_u32 v115, v115, s35
    v_add3_u32 v120, v120, v114, v115
    s_branch K3_pi1_done
K3_pi1_end:
    v_and_b32 v120, 15, v0
    v_lshlrev_b32 v120, 4, v120
    v_add3_u32 v120, v120, v105, v106
    v_add_u32 v129, 0x400, v120
K3_pi1_done:
K3_noprep:
    s_add_u32 s7, s5, 151552
    v_add_u32 v5, s7, v7
    v_bfe_u32 v6, v0, 2, 2
    v_lshlrev_b32 v6, 8, v6
    v_lshrrev_b32 v121, 4, v0
    v_lshl_add_u32 v6, v121, 6, v6
    v_and_b32 v121, 3, v0
    v_lshl_add_u32 v6, v121, 4, v6
    v_add_u32 v6, s7, v6
    s_add_u32 s41, s5, 147456
    s_cmp_ge_u32 s3, 4
    s_cselect_b32 s41, 0x30000, s41
    v_mov_b32 v77, 0x3f803f80
    v_mov_b32 v85, 0x3f803f80
    v_mov_b32 v128, 0x71800000
    v_mul_u32_u24 v124, 19, v122
    v_add_lshl_u32 v124, v124, v123, 4
    v_add_u32 v125, 0x30000, v124
    v_cmp_gt_u32 vcc, 19, v123
    s_lshl_b32 s33, s3, 2
    s_add_u32 s33, s33, 159744
    v_cndmask_b32 v124, v125, v124, vcc
    v_mov_b32 v121, s33
    v_mov_b32 v127, 0
    ds_write_b32 v121, v127
    ds_write_b32 v121, v127 offset:32
    s_mul_i32 s42, s3, 138240
    s_mul_i32 s33, s3, 27648
    s_add_u32 s33, s33, 442368
    s_cmp_ge_u32 s3, 4
    s_cselect_b32 s42, s33, s42
    s_add_u32 s42, s42, 0xf4000
    s_cmp_eq_u32 s31, 0
    s_cbranch_scc1 K3_go
    s_mov_b32 s37, 0x7fff0000
    s_mov_b32 s53, 0x7fff0000
    s_mov_b32 s33, 15
K3_refill:
    buffer_load_dwordx4 v7, s[12:15], m0 offen lds
    s_add_u32 m0, m0, 0x2000
    s_sub_u32 s33, s33, 1
    s_cmp_lg_u32 s33, 0
    s_cbranch_scc1 K3_refill
    s_mov_b32 m0, s41
    s_nop 0
    buffer_load_dwordx4 v7, s[12:15], m0 offen lds
    s_waitcnt vmcnt(0) lgkmcnt(0)
    s_barrier
K3_go:
    v_mov_b32 v1, v7
    v_lshlrev_b32 v2, 2, v123
    v_mov_b32 v13, 0
    v_mov_b32 v126, 0xff800000
    s_cmp_lg_u32 s31, 0
    s_cbranch_scc1 K3_maxloop
    s_waitcnt vmcnt(3)
    s_branch K3_max1
K3_maxloop:
    ds_read_b128 v[72:75], v1 offset:0
    ds_read_b32 v76, v2 offset:2240
    v_add_u32 v1, 2368, v1
    v_add_u32 v2, 2368, v2
    s_sub_u32 s40, s40, 1
    s_cmp_lg_u32 s40, 0
    s_waitcnt lgkmcnt(0)
K3_max1:
    v_mfma_f32_32x32x16_bf16 v[16:31], v[72:75], v[8:11], 0
    v_mfma_f32_32x32x8_bf16 v[16:31], v[76:77], v[12:13], v[16:31]
    s_nop 11
    v_max3_f32 v126, v16, v17, v126
    v_max3_f32 v126, v18, v19, v126
    v_max3_f32 v126, v20, v21, v126
    v_max3_f32 v126, v22, v23, v126
    v_max3_f32 v126, v24, v25, v126
    v_max3_f32 v126, v26, v27, v126
    v_max3_f32 v126, v28, v29, v126
    v_max3_f32 v126, v30, v31, v126
    s_cbranch_scc1 K3_maxloop
    v_mov_b32 v127, v126
    v_mov_b32 v1, v7
    v_lshlrev_b32 v2, 2, v123
    v_permlane32_swap_b32 v126, v127
    v_mov_b32 v3, v124
    v_max_f32 v126, v126, v127
    v_sub_f32 v126, 0, v126
    v_cvt_pk_bf16_f32 v127, v126, v126
    v_and_b32 v127, 0xffff0000, v127
    v_sub_f32 v126, v126, v127
    v_cvt_pk_bf16_f32 v125, v127, v126
    v_and_b32 v127, 0xffff0000, v125
    v_sub_f32 v126, v126, v127
    v_cvt_pk_bf16_f32 v126, v126, 0
    v_cmp_gt_u32 vcc, 32, v0
    v_mov_b32 v56, 0
    v_mov_b32 v57, 0
    v_mov_b32 v58, 0
    v_mov_b32 v59, 0
    v_mov_b32 v60, 0
    v_mov_b32 v61, 0
    v_mov_b32 v62, 0
    v_mov_b32 v63, 0
    v_mov_b32 v64, 0
    v_mov_b32 v65, 0
    v_mov_b32 v66, 0
    v_mov_b32 v67, 0
    v_mov_b32 v68, 0
    v_mov_b32 v69, 0
    v_mov_b32 v70, 0
    v_mov_b32 v71, 0
    v_cndmask_b32 v13, v126, v125, vcc
    v_mov_b32 v52, 0
    v_mov_b32 v100, 0
    v_mov_b32 v53, 0
    v_mov_b32 v101, 0
    v_mov_b32 v54, 0
    v_mov_b32 v102, 0
    v_mov_b32 v55, 0
    v_mov_b32 v103, 0
    s_waitcnt vmcnt(0) lgkmcnt(0)
    s_barrier
    ds_read_b128 v[72:75], v1 offset:0
    ds_read_b32 v76, v2 offset:2240
    ds_read_b128 v[80:83], v1 offset:2368
    ds_read_b32 v84, v2 offset:4608
    ds_read_b128 v[88:91], v3 offset:1024
    ds_read_b128 v[92:95], v3 offset:1632
    s_add_u32 s30, s31, 3
    s_cmp_lg_u32 s31, 0
    s_waitcnt lgkmcnt(0)
    v_mfma_f32_32x32x16_bf16 v[16:31], v[72:75], v[8:11], 0
    v_mfma_f32_32x32x8_bf16 v[16:31], v[76:77], v[12:13], v[16:31]
    s_nop 8
    s_cbranch_scc0 K3_it0
    s_cmp_lt_u32 s3, 4
    s_cbranch_scc1 K3_loopO
    s_branch K3_loopY
K3_it0:
    v_mfma_f32_32x32x16_bf16 v[32:47], v[80:83], v[8:11], 0
    buffer_load_dwordx4 v7, s[12:15], m0 offen lds
    s_add_u32 m0, m0, 0x2000
    s_nop 0
    buffer_load_dwordx4 v7, s[12:15], m0 offen lds
    s_add_u32 m0, m0, 0x2000
    s_nop 0
    ds_read_b128 v[72:75], v1 offset:4736
    ds_read_b32 v76, v2 offset:6976
    v_exp_f32 v16, v16
    v_exp_f32 v17, v17
    v_exp_f32 v18, v18
    v_exp_f32 v19, v19
    v_mfma_f32_32x32x16_bf16 v[56:71], v[100:103], v[52:55], v[56:71]
    ds_read_b128 v[96:99], v3 offset:3392
    ds_read_b128 v[100:103], v3 offset:4000
    v_exp_f32 v20, v20
    v_exp_f32 v21, v21
    v_exp_f32 v22, v22
    v_exp_f32 v23, v23
    v_cvt_pk_bf16_f32 v48, v16, v17
    v_cvt_pk_bf16_f32 v49, v18, v19
    v_mfma_f32_32x32x8_bf16 v[32:47], v[84:85], v[12:13], v[32:47]
    v_cvt_pk_bf16_f32 v50, v20, v21
    v_cvt_pk_bf16_f32 v51, v22, v23
    v_exp_f32 v24, v24
    v_exp_f32 v25, v25
    v_exp_f32 v26, v26
    v_exp_f32 v27, v27
    v_mfma_f32_32x32x16_bf16 v[56:71], v[88:91], v[48:51], v[56:71]
    s_waitcnt lgkmcnt(0)
    v_exp_f32 v28, v28
    v_exp_f32 v29, v29
    v_exp_f32 v30, v30
    v_exp_f32 v31, v31
    v_cvt_pk_bf16_f32 v52, v24, v25
    v_cvt_pk_bf16_f32 v53, v26, v27
    v_cvt_pk_bf16_f32 v54, v28, v29
    v_cvt_pk_bf16_f32 v55, v30, v31
    v_mfma_f32_32x32x16_bf16 v[16:31], v[72:75], v[8:11], 0
    buffer_load_dwordx4 v7, s[12:15], m0 offen lds
    s_add_u32 m0, m0, 0x2000
    s_nop 0
    ds_read_b128 v[80:83], v1 offset:7104
    ds_read_b32 v84, v2 offset:9344
    v_exp_f32 v32, v32
    v_exp_f32 v33, v33
    v_exp_f32 v34, v34
    v_exp_f32 v35, v35
    v_mfma_f32_32x32x16_bf16 v[56:71], v[92:95], v[52:55], v[56:71]
    ds_read_b128 v[88:91], v3 offset:5760
    ds_read_b128 v[92:95], v3 offset:6368
    v_exp_f32 v36, v36
    v_exp_f32 v37, v37
    v_exp_f32 v38, v38
    v_exp_f32 v39, v39
    v_cvt_pk_bf16_f32 v48, v32, v33
    v_cvt_pk_bf16_f32 v49, v34, v35
    v_mfma_f32_32x32x8_bf16 v[16:31], v[76:77], v[12:13], v[16:31]
    v_cvt_pk_bf16_f32 v50, v36, v37
    v_cvt_pk_bf16_f32 v51, v38, v39
    v_exp_f32 v40, v40
    v_exp_f32 v41, v41
    v_exp_f32 v42, v42
    v_exp_f32 v43, v43
    v_mfma_f32_32x32x16_bf16 v[56:71], v[96:99], v[48:51], v[56:71]
    s_waitcnt lgkmcnt(0)
    v_exp_f32 v44, v44
    v_exp_f32 v45, v45
    v_exp_f32 v46, v46
    v_exp_f32 v47, v47
    v_cvt_pk_bf16_f32 v52, v40, v41
    v_cvt_pk_bf16_f32 v53, v42, v43
    v_cvt_pk_bf16_f32 v54, v44, v45
    v_cvt_pk_bf16_f32 v55, v46, v47
    v_mfma_f32_32x32x16_bf16 v[32:47], v[80:83], v[8:11], 0
    buffer_load_dwordx4 v7, s[12:15], m0 offen lds
    s_add_u32 m0, m0, 0x2000
    s_nop 0
    ds_read_b128 v[72:75], v1 offset:9472
    ds_read_b32 v76, v2 offset:11712
    v_exp_f32 v16, v16
    v_exp_f32 v17, v17
    v_exp_f32 v18, v18
    v_exp_f32 v19, v19
    v_mfma_f32_32x32x16_bf16 v[56:71], v[100:103], v[52:55], v[56:71]
    ds_read_b128 v[96:99], v3 offset:8128
    ds_read_b128 v[100:103], v3 offset:8736
    v_exp_f32 v20, v20
    v_exp_f32 v21, v21
    v_exp_f32 v22, v22
    v_exp_f32 v23, v23
    v_cvt_pk_bf16_f32 v48, v16, v17
    v_cvt_pk_bf16_f32 v49, v18, v19
    v_mfma_f32_32x32x8_bf16 v[32:47], v[84:85], v[12:13], v[32:47]
    v_cvt_pk_bf16_f32 v50, v20, v21
    v_cvt_pk_bf16_f32 v51, v22, v23
    v_exp_f32 v24, v24
    v_exp_f32 v25, v25
    v_exp_f32 v26, v26
    v_exp_f32 v27, v27
    v_mfma_f32_32x32x16_bf16 v[56:71], v[88:91], v[48:51], v[56:71]
    s_waitcnt lgkmcnt(0)
    v_exp_f32 v28, v28
    v_exp_f32 v29, v29
    v_exp_f32 v30, v30
    v_exp_f32 v31, v31
    v_cvt_pk_bf16_f32 v52, v24, v25
    v_cvt_pk_bf16_f32 v53, v26, v27
    v_cvt_pk_bf16_f32 v54, v28, v29
    v_cvt_pk_bf16_f32 v55, v30, v31
    v_mfma_f32_32x32x16_bf16 v[16:31], v[72:75], v[8:11], 0
    buffer_load_dwordx4 v7, s[12:15], m0 offen lds
    s_add_u32 m0, m0, 0x2000
    s_nop 0
    buffer_load_dwordx4 v7, s[12:15], m0 offen lds
    s_add_u32 m0, m0, 0x2000
    s_nop 0
    ds_read_b128 v[80:83], v1 offset:11840
    ds_read_b32 v84, v2 offset:14080
    v_exp_f32 v32, v32
    v_exp_f32 v33, v33
    v_exp_f32 v34, v34
    v_exp_f32 v35, v35
    v_mfma_f32_32x32x16_bf16 v[56:71], v[92:95], v[52:55], v[56:71]
    ds_read_b128 v[88:91], v3 offset:10496
    ds_read_b128 v[92:95], v3 offset:11104
    v_exp_f32 v36, v36
    v_exp_f32 v37, v37
    v_exp_f32 v38, v38
    v_exp_f32 v39, v39
    v_cvt_pk_bf16_f32 v48, v32, v33
    v_cvt_pk_bf16_f32 v49, v34, v35
    v_mfma_f32_32x32x8_bf16 v[16:31], v[76:77], v[12:13], v[16:31]
    v_cvt_pk_bf16_f32 v50, v36, v37
    v_cvt_pk_bf16_f32 v51, v38, v39
    v_exp_f32 v40, v40
    v_exp_f32 v41, v41
    v_exp_f32 v42, v42
    v_exp_f32 v43, v43
    v_mfma_f32_32x32x16_bf16 v[56:71], v[96:99], v[48:51], v[56:71]
    s_waitcnt lgkmcnt(0)
    v_exp_f32 v44, v44
    v_exp_f32 v45, v45
    v_exp_f32 v46, v46
    v_exp_f32 v47, v47
    v_cvt_pk_bf16_f32 v52, v40, v41
    v_cvt_pk_bf16_f32 v53, v42, v43
    v_cvt_pk_bf16_f32 v54, v44, v45
    v_cvt_pk_bf16_f32 v55, v46, v47
    v_mfma_f32_32x32x16_bf16 v[32:47], v[80:83], v[8:11], 0
    buffer_load_dwordx4 v7, s[12:15], m0 offen lds
    s_add_u32 m0, m0, 0x2000
    s_nop 0
    ds_read_b128 v[72:75], v1 offset:14208
    ds_read_b32 v76, v2 offset:16448
    v_exp_f32 v16, v16
    v_exp_f32 v17, v17
    v_exp_f32 v18, v18
    v_exp_f32 v19, v19
    v_mfma_f32_32x32x16_bf16 v[56:71], v[100:103], v[52:55], v[56:71]
    ds_read_b128 v[96:99], v3 offset:12864
    ds_read_b128 v[100:103], v3 offset:13472
    v_exp_f32 v20, v20
    v_exp_f32 v21, v21
    v_exp_f32 v22, v22
    v_exp_f32 v23, v23
    v_cvt_pk_bf16_f32 v48, v16, v17
    v_cvt_pk_bf16_f32 v49, v18, v19
    v_mfma_f32_32x32x8_bf16 v[32:47], v[84:85], v[12:13], v[32:47]
    v_cvt_pk_bf16_f32 v50, v20, v21
    v_cvt_pk_bf16_f32 v51, v22, v23
    v_exp_f32 v24, v24
    v_exp_f32 v25, v25
    v_exp_f32 v26, v26
    v_exp_f32 v27, v27
    v_mfma_f32_32x32x16_bf16 v[56:71], v[88:91], v[48:51], v[56:71]
    s_waitcnt lgkmcnt(0)
    v_exp_f32 v28, v28
    v_exp_f32 v29, v29
    v_exp_f32 v30, v30
    v_exp_f32 v31, v31
    v_cvt_pk_bf16_f32 v52, v24, v25
    v_cvt_pk_bf16_f32 v53, v26, v27
    v_cvt_pk_bf16_f32 v54, v28, v29
    v_cvt_pk_bf16_f32 v55, v30, v31
    v_mfma_f32_32x32x16_bf16 v[16:31], v[72:75], v[8:11], 0
    buffer_load_dwordx4 v7, s[12:15], m0 offen lds
    s_add_u32 m0, m0, 0x2000
    s_nop 0
    ds_read_b128 v[80:83], v1 offset:16576
    ds_read_b32 v84, v2 offset:18816
    v_exp_f32 v32, v32
    v_exp_f32 v33, v33
    v_exp_f32 v34, v34
    v_exp_f32 v35, v35
    v_mfma_f32_32x32x16_bf16 v[56:71], v[92:95], v[52:55], v[56:71]
    ds_read_b128 v[88:91], v3 offset:15232
    ds_read_b128 v[92:95], v3 offset:15840
    v_exp_f32 v36, v36
    v_exp_f32 v37, v37
    v_exp_f32 v38, v38
    v_exp_f32 v39, v39
    v_cvt_pk_bf16_f32 v48, v32, v33
    v_cvt_pk_bf16_f32 v49, v34, v35
    v_mfma_f32_32x32x8_bf16 v[16:31], v[76:77], v[12:13], v[16:31]
    v_cvt_pk_bf16_f32 v50, v36, v37
    v_cvt_pk_bf16_f32 v51, v38, v39
    v_exp_f32 v40, v40
    v_exp_f32 v41, v41
    v_exp_f32 v42, v42
    v_exp_f32 v43, v43
    v_mfma_f32_32x32x16_bf16 v[56:71], v[96:99], v[48:51], v[56:71]
    s_waitcnt lgkmcnt(0)
    v_exp_f32 v44, v44
    v_exp_f32 v45, v45
    v_exp_f32 v46, v46
    v_exp_f32 v47, v47
    v_cvt_pk_bf16_f32 v52, v40, v41
    v_cvt_pk_bf16_f32 v53, v42, v43
    v_cvt_pk_bf16_f32 v54, v44, v45
    v_cvt_pk_bf16_f32 v55, v46, v47
    v_mfma_f32_32x32x16_bf16 v[32:47], v[80:83], v[8:11], 0
    buffer_load_dwordx4 v7, s[12:15], m0 offen lds
    s_add_u32 m0, m0, 0x2000
    s_nop 0
    buffer_load_dwordx4 v7, s[12:15], m0 offen lds
    s_add_u32 m0, m0, 0x2000
    s_nop 0
    ds_read_b128 v[72:75], v1 offset:18944
    ds_read_b32 v76, v2 offset:21184
    v_exp_f32 v16, v16
    v_exp_f32 v17, v17
    v_exp_f32 v18, v18
    v_exp_f32 v19, v19
    v_mfma_f32_32x32x16_bf16 v[56:71], v[100:103], v[52:55], v[56:71]
    ds_read_b128 v[96:99], v3 offset:17600
    ds_read_b128 v[100:103], v3 offset:18208
    v_exp_f32 v20, v20
    v_exp_f32 v21, v21
    v_exp_f32 v22, v22
    v_exp_f32 v23, v23
    v_cvt_pk_bf16_f32 v48, v16, v17
    v_cvt_pk_bf16_f32 v49, v18, v19
    v_mfma_f32_32x32x8_bf16 v[32:47], v[84:85], v[12:13], v[32:47]
    v_cvt_pk_bf16_f32 v50, v20, v21
    v_cvt_pk_bf16_f32 v51, v22, v23
    v_exp_f32 v24, v24
    v_exp_f32 v25, v25
    v_exp_f32 v26, v26
    v_exp_f32 v27, v27
    v_mfma_f32_32x32x16_bf16 v[56:71], v[88:91], v[48:51], v[56:71]
    s_waitcnt lgkmcnt(0)
    v_exp_f32 v28, v28
    v_exp_f32 v29, v29
    v_exp_f32 v30, v30
    v_exp_f32 v31, v31
    v_cvt_pk_bf16_f32 v52, v24, v25
    v_cvt_pk_bf16_f32 v53, v26, v27
    v_cvt_pk_bf16_f32 v54, v28, v29
    v_cvt_pk_bf16_f32 v55, v30, v31
    v_mfma_f32_32x32x16_bf16 v[16:31], v[72:75], v[8:11], 0
    buffer_load_dwordx4 v7, s[12:15], m0 offen lds
    s_add_u32 m0, m0, 0x2000
    s_nop 0
    s_waitcnt vmcnt(8)
    s_barrier
    ds_read_b128 v[80:83], v1 offset:21312
    ds_read_b32 v84, v2 offset:23552
    v_exp_f32 v32, v32
    v_exp_f32 v33, v33
    v_exp_f32 v34, v34
    v_exp_f32 v35, v35
    v_mfma_f32_32x32x16_bf16 v[56:71], v[92:95], v[52:55], v[56:71]
    ds_read_b128 v[88:91], v3 offset:19968
    ds_read_b128 v[92:95], v3 offset:20576
    v_exp_f32 v36, v36
    v_exp_f32 v37, v37
    v_exp_f32 v38, v38
    v_exp_f32 v39, v39
    v_cvt_pk_bf16_f32 v48, v32, v33
    v_cvt_pk_bf16_f32 v49, v34, v35
    v_mfma_f32_32x32x8_bf16 v[16:31], v[76:77], v[12:13], v[16:31]
    v_cvt_pk_bf16_f32 v50, v36, v37
    v_cvt_pk_bf16_f32 v51, v38, v39
    v_exp_f32 v40, v40
    v_exp_f32 v41, v41
    v_exp_f32 v42, v42
    v_exp_f32 v43, v43
    v_mfma_f32_32x32x16_bf16 v[56:71], v[96:99], v[48:51], v[56:71]
    s_waitcnt lgkmcnt(0)
    v_exp_f32 v44, v44
    v_exp_f32 v45, v45
    v_exp_f32 v46, v46
    v_exp_f32 v47, v47
    v_cvt_pk_bf16_f32 v52, v40, v41
    v_cvt_pk_bf16_f32 v53, v42, v43
    v_cvt_pk_bf16_f32 v54, v44, v45
    v_cvt_pk_bf16_f32 v55, v46, v47
    v_mfma_f32_32x32x16_bf16 v[32:47], v[80:83], v[8:11], 0
    buffer_load_dwordx4 v7, s[12:15], m0 offen lds
    s_add_u32 m0, m0, 0x2000
    s_nop 0
    s_cmp_ge_u32 s3, 4
    s_cbranch_scc1 K3_oo1
    buffer_load_dwordx4 v[104:107], v4, s[16:19], s34 offen
    s_add_u32 s34, s34, s36
    buffer_load_dwordx4 v[108:111], v4, s[16:19], s34 offen
    s_add_u32 s34, s34, s36
K3_oo1:
    ds_read_b128 v[72:75], v1 offset:23680
    ds_read_b32 v76, v2 offset:25920
    v_exp_f32 v16, v16
    v_exp_f32 v17, v17
    v_exp_f32 v18, v18
    v_exp_f32 v19, v19
    v_mfma_f32_32x32x16_bf16 v[56:71], v[100:103], v[52:55], v[56:71]
    ds_read_b128 v[96:99], v3 offset:22336
    ds_read_b128 v[100:103], v3 offset:22944
    v_exp_f32 v20, v20
    v_exp_f32 v21, v21
    v_exp_f32 v22, v22
    v_exp_f32 v23, v23
    v_cvt_pk_bf16_f32 v48, v16, v17
    v_cvt_pk_bf16_f32 v49, v18, v19
    v_mfma_f32_32x32x8_bf16 v[32:47], v[84:85], v[12:13], v[32:47]
    v_cvt_pk_bf16_f32 v50, v20, v21
    v_cvt_pk_bf16_f32 v51, v22, v23
    v_exp_f32 v24, v24
    v_exp_f32 v25, v25
    v_exp_f32 v26, v26
    v_exp_f32 v27, v27
    v_mfma_f32_32x32x16_bf16 v[56:71], v[88:91], v[48:51], v[56:71]
    s_waitcnt lgkmcnt(0)
    v_exp_f32 v28, v28
    v_exp_f32 v29, v29
    v_exp_f32 v30, v30
    v_exp_f32 v31, v31
    v_cvt_pk_bf16_f32 v52, v24, v25
    v_cvt_pk_bf16_f32 v53, v26, v27
    v_cvt_pk_bf16_f32 v54, v28, v29
    v_cvt_pk_bf16_f32 v55, v30, v31
    v_mfma_f32_32x32x16_bf16 v[16:31], v[72:75], v[8:11], 0
    buffer_load_dwordx4 v7, s[12:15], m0 offen lds
    s_add_u32 m0, m0, 0x2000
    s_nop 0
    buffer_load_dwordx4 v7, s[12:15], m0 offen lds
    s_add_u32 m0, m0, 0x2000
    s_nop 0
    ds_read_b128 v[80:83], v1 offset:26048
    ds_read_b32 v84, v2 offset:28288
    v_exp_f32 v32, v32
    v_exp_f32 v33, v33
    v_exp_f32 v34, v34
    v_exp_f32 v35, v35
    v_mfma_f32_32x32x16_bf16 v[56:71], v[92:95], v[52:55], v[56:71]
    ds_read_b128 v[88:91], v3 offset:24704
    ds_read_b128 v[92:95], v3 offset:25312
    v_exp_f32 v36, v36
    v_exp_f32 v37, v37
    v_exp_f32 v38, v38
    v_exp_f32 v39, v39
    v_cvt_pk_bf16_f32 v48, v32, v33
    v_cvt_pk_bf16_f32 v49, v34, v35
    v_mfma_f32_32x32x8_bf16 v[16:31], v[76:77], v[12:13], v[16:31]
    v_cvt_pk_bf16_f32 v50, v36, v37
    v_cvt_pk_bf16_f32 v51, v38, v39
    v_exp_f32 v40, v40
    v_exp_f32 v41, v41
    v_exp_f32 v42, v42
    v_exp_f32 v43, v43
    v_mfma_f32_32x32x16_bf16 v[56:71], v[96:99], v[48:51], v[56:71]
    s_waitcnt lgkmcnt(0)
    v_exp_f32 v44, v44
    v_exp_f32 v45, v45
    v_exp_f32 v46, v46
    v_exp_f32 v47, v47
    v_cvt_pk_bf16_f32 v52, v40, v41
    v_cvt_pk_bf16_f32 v53, v42, v43
    v_cvt_pk_bf16_f32 v54, v44, v45
    v_cvt_pk_bf16_f32 v55, v46, v47
    v_mfma_f32_32x32x16_bf16 v[32:47], v[80:83], v[8:11], 0
    buffer_load_dwordx4 v7, s[12:15], m0 offen lds
    ds_read_b128 v[72:75], v1 offset:28416
    ds_read_b32 v76, v2 offset:30656
    v_exp_f32 v16, v16
    v_exp_f32 v17, v17
    v_exp_f32 v18, v18
    v_exp_f32 v19, v19
    v_mfma_f32_32x32x16_bf16 v[56:71], v[100:103], v[52:55], v[56:71]
    ds_read_b128 v[96:99], v3 offset:27072
    ds_read_b128 v[100:103], v3 offset:27680
    v_exp_f32 v20, v20
    v_exp_f32 v21, v21
    v_exp_f32 v22, v22
    v_exp_f32 v23, v23
    v_cvt_pk_bf16_f32 v48, v16, v17
    v_cvt_pk_bf16_f32 v49, v18, v19
    v_mfma_f32_32x32x8_bf16 v[32:47], v[84:85], v[12:13], v[32:47]
    v_cvt_pk_bf16_f32 v50, v20, v21
    v_cvt_pk_bf16_f32 v51, v22, v23
    v_exp_f32 v24, v24
    v_exp_f32 v25, v25
    v_exp_f32 v26, v26
    v_exp_f32 v27, v27
    v_mfma_f32_32x32x16_bf16 v[56:71], v[88:91], v[48:51], v[56:71]
    s_waitcnt lgkmcnt(0)
    v_exp_f32 v28, v28
    v_exp_f32 v29, v29
    v_exp_f32 v30, v30
    v_exp_f32 v31, v31
    v_cvt_pk_bf16_f32 v52, v24, v25
    v_cvt_pk_bf16_f32 v53, v26, v27
    v_cvt_pk_bf16_f32 v54, v28, v29
    v_cvt_pk_bf16_f32 v55, v30, v31
    v_mfma_f32_32x32x16_bf16 v[16:31], v[72:75], v[8:11], 0
    s_mov_b32 m0, s41
    s_nop 0
    buffer_load_dwordx4 v7, s[12:15], m0 offen lds
    ds_read_b128 v[80:83], v1 offset:30784
    ds_read_b32 v84, v2 offset:33024
    v_exp_f32 v32, v32
    v_exp_f32 v33, v33
    v_exp_f32 v34, v34
    v_exp_f32 v35, v35
    v_mfma_f32_32x32x16_bf16 v[56:71], v[92:95], v[52:55], v[56:71]
    ds_read_b128 v[88:91], v3 offset:29440
    ds_read_b128 v[92:95], v3 offset:30048
    v_exp_f32 v36, v36
    v_exp_f32 v37, v37
    v_exp_f32 v38, v38
    v_exp_f32 v39, v39
    v_cvt_pk_bf16_f32 v48, v32, v33
    v_cvt_pk_bf16_f32 v49, v34, v35
    v_mfma_f32_32x32x8_bf16 v[16:31], v[76:77], v[12:13], v[16:31]
    v_cvt_pk_bf16_f32 v50, v36, v37
    v_cvt_pk_bf16_f32 v51, v38, v39
    v_exp_f32 v40, v40
    v_exp_f32 v41, v41
    v_exp_f32 v42, v42
    v_exp_f32 v43, v43
    v_mfma_f32_32x32x16_bf16 v[56:71], v[96:99], v[48:51], v[56:71]
    s_waitcnt lgkmcnt(0)
    v_exp_f32 v44, v44
    v_exp_f32 v45, v45
    v_exp_f32 v46, v46
    v_exp_f32 v47, v47
    v_cvt_pk_bf16_f32 v52, v40, v41
    v_cvt_pk_bf16_f32 v53, v42, v43
    v_cvt_pk_bf16_f32 v54, v44, v45
    v_cvt_pk_bf16_f32 v55, v46, v47
    v_mfma_f32_32x32x16_bf16 v[32:47], v[80:83], v[8:11], 0
    s_cmp_ge_u32 s3, 4
    s_cbranch_scc1 K3_oo2
    buffer_load_dwordx4 v[248:251], v14, s[16:19], s52 offen
    s_add_u32 s52, s52, s36
    buffer_load_dwordx4 v[252:255], v14, s[16:19], s52 offen
    s_add_u32 s52, s52, s36
K3_oo2:
    ds_read_b128 v[72:75], v1 offset:33152
    ds_read_b32 v76, v2 offset:35392
    v_exp_f32 v16, v16
    v_exp_f32 v17, v17
    v_exp_f32 v18, v18
    v_exp_f32 v19, v19
    v_mfma_f32_32x32x16_bf16 v[56:71], v[100:103], v[52:55], v[56:71]
    ds_read_b128 v[96:99], v3 offset:31808
    ds_read_b128 v[100:103], v3 offset:32416
    v_exp_f32 v20, v20
    v_exp_f32 v21, v21
    v_exp_f32 v22, v22
    v_exp_f32 v23, v23
    v_cvt_pk_bf16_f32 v48, v16, v17
    v_cvt_pk_bf16_f32 v49, v18, v19
    v_mfma_f32_32x32x8_bf16 v[32:47], v[84:85], v[12:13], v[32:47]
    v_cvt_pk_bf16_f32 v50, v20, v21
    v_cvt_pk_bf16_f32 v51, v22, v23
    v_exp_f32 v24, v24
    v_exp_f32 v25, v25
    v_exp_f32 v26, v26
    v_exp_f32 v27, v27
    v_mfma_f32_32x32x16_bf16 v[56:71], v[88:91], v[48:51], v[56:71]
    s_waitcnt lgkmcnt(0)
    v_exp_f32 v28, v28
    v_exp_f32 v29, v29
    v_exp_f32 v30, v30
    v_exp_f32 v31, v31
    v_cvt_pk_bf16_f32 v52, v24, v25
    v_cvt_pk_bf16_f32 v53, v26, v27
    v_cvt_pk_bf16_f32 v54, v28, v29
    v_cvt_pk_bf16_f32 v55, v30, v31
    v_mfma_f32_32x32x16_bf16 v[16:31], v[72:75], v[8:11], 0
    ds_read_b128 v[80:83], v1 offset:35520
    ds_read_b32 v84, v2 offset:37760
    v_exp_f32 v32, v32
    v_exp_f32 v33, v33
    v_exp_f32 v34, v34
    v_exp_f32 v35, v35
    v_mfma_f32_32x32x16_bf16 v[56:71], v[92:95], v[52:55], v[56:71]
    ds_read_b128 v[88:91], v3 offset:34176
    ds_read_b128 v[92:95], v3 offset:34784
    v_exp_f32 v36, v36
    v_exp_f32 v37, v37
    v_exp_f32 v38, v38
    v_exp_f32 v39, v39
    v_cvt_pk_bf16_f32 v48, v32, v33
    v_cvt_pk_bf16_f32 v49, v34, v35
    v_mfma_f32_32x32x8_bf16 v[16:31], v[76:77], v[12:13], v[16:31]
    v_cvt_pk_bf16_f32 v50, v36, v37
    v_cvt_pk_bf16_f32 v51, v38, v39
    v_exp_f32 v40, v40
    v_exp_f32 v41, v41
    v_exp_f32 v42, v42
    v_exp_f32 v43, v43
    v_mfma_f32_32x32x16_bf16 v[56:71], v[96:99], v[48:51], v[56:71]
    s_waitcnt lgkmcnt(0)
    v_exp_f32 v44, v44
    v_exp_f32 v45, v45
    v_exp_f32 v46, v46
    v_exp_f32 v47, v47
    v_cvt_pk_bf16_f32 v52, v40, v41
    v_cvt_pk_bf16_f32 v53, v42, v43
    v_cvt_pk_bf16_f32 v54, v44, v45
    v_cvt_pk_bf16_f32 v55, v46, v47
    v_mfma_f32_32x32x16_bf16 v[32:47], v[80:83], v[8:11], 0
    s_cmp_ge_u32 s3, 4
    s_cbranch_scc1 K3_oo3
    s_waitcnt vmcnt(2)
    ds_write_b128 v5, v[104:107]
    ds_read_b64_tr_b16 v[112:113], v6
    ds_read_b64_tr_b16 v[116:117], v6 offset:8
    ds_write_b128 v5, v[108:111]
    ds_read_b64_tr_b16 v[114:115], v6
    ds_read_b64_tr_b16 v[118:119], v6 offset:8
K3_oo3:
    ds_read_b128 v[72:75], v1 offset:37888
    ds_read_b32 v76, v2 offset:40128
    v_exp_f32 v16, v16
    v_exp_f32 v17, v17
    v_exp_f32 v18, v18
    v_exp_f32 v19, v19
    v_mfma_f32_32x32x16_bf16 v[56:71], v[100:103], v[52:55], v[56:71]
    ds_read_b128 v[96:99], v3 offset:36544
    ds_read_b128 v[100:103], v3 offset:37152
    v_exp_f32 v20, v20
    v_exp_f32 v21, v21
    v_exp_f32 v22, v22
    v_exp_f32 v23, v23
    v_cvt_pk_bf16_f32 v48, v16, v17
    v_cvt_pk_bf16_f32 v49, v18, v19
    v_mfma_f32_32x32x8_bf16 v[32:47], v[84:85], v[12:13], v[32:47]
    v_cvt_pk_bf16_f32 v50, v20, v21
    v_cvt_pk_bf16_f32 v51, v22, v23
    v_exp_f32 v24, v24
    v_exp_f32 v25, v25
    v_exp_f32 v26, v26
    v_exp_f32 v27, v27
    v_mfma_f32_32x32x16_bf16 v[56:71], v[88:91], v[48:51], v[56:71]
    s_waitcnt lgkmcnt(0)
    v_exp_f32 v28, v28
    v_exp_f32 v29, v29
    v_exp_f32 v30, v30
    v_exp_f32 v31, v31
    v_cvt_pk_bf16_f32 v52, v24, v25
    v_cvt_pk_bf16_f32 v53, v26, v27
    v_cvt_pk_bf16_f32 v54, v28, v29
    v_cvt_pk_bf16_f32 v55, v30, v31
    v_mfma_f32_32x32x16_bf16 v[16:31], v[72:75], v[8:11], 0
    s_cmp_ge_u32 s3, 4
    s_cbranch_scc1 K3_oo4
    buffer_store_dwordx4 v[112:115], v120, s[20:23], s37 offen sc1
    buffer_store_dwordx4 v[116:119], v129, s[20:23], s37 offen sc1
    s_add_u32 s37, s37, 256
    buffer_load_dwordx4 v[104:107], v4, s[16:19], s34 offen
    s_add_u32 s34, s34, s36
    buffer_load_dwordx4 v[108:111], v4, s[16:19], s34 offen
    s_add_u32 s34, s34, s36
K3_oo4:
    ds_read_b128 v[80:83], v1 offset:40256
    ds_read_b32 v84, v2 offset:42496
    v_exp_f32 v32, v32
    v_exp_f32 v33, v33
    v_exp_f32 v34, v34
    v_exp_f32 v35, v35
    v_mfma_f32_32x32x16_bf16 v[56:71], v[92:95], v[52:55], v[56:71]
    ds_read_b128 v[88:91], v3 offset:38912
    ds_read_b128 v[92:95], v3 offset:39520
    v_exp_f32 v36, v36
    v_exp_f32 v37, v37
    v_exp_f32 v38, v38
    v_exp_f32 v39, v39
    v_cvt_pk_bf16_f32 v48, v32, v33
    v_cvt_pk_bf16_f32 v49, v34, v35
    v_mfma_f32_32x32x8_bf16 v[16:31], v[76:77], v[12:13], v[16:31]
    v_cvt_pk_bf16_f32 v50, v36, v37
    v_cvt_pk_bf16_f32 v51, v38, v39
    v_exp_f32 v40, v40
    v_exp_f32 v41, v41
    v_exp_f32 v42, v42
    v_exp_f32 v43, v43
    v_mfma_f32_32x32x16_bf16 v[56:71], v[96:99], v[48:51], v[56:71]
    s_waitcnt lgkmcnt(0)
    v_exp_f32 v44, v44
    v_exp_f32 v45, v45
    v_exp_f32 v46, v46
    v_exp_f32 v47, v47
    v_cvt_pk_bf16_f32 v52, v40, v41
    v_cvt_pk_bf16_f32 v53, v42, v43
    v_cvt_pk_bf16_f32 v54, v44, v45
    v_cvt_pk_bf16_f32 v55, v46, v47
    v_add_u32 v1, 37888, v1
    v_add_u32 v2, 37888, v2
    v_add_u32 v3, 37888, v3
K3_barB:
    s_cmp_lt_u32 s3, 4
    s_cbranch_scc1 K3_bw
    s_waitcnt vmcnt(0)
K3_bw:
    s_barrier
    s_cmp_lt_u32 s3, 4
    s_cbranch_scc1 K3_loopO
    s_lshl_b32 s33, s3, 11
    s_sub_u32 s33, s33, -1152
    s_mov_b32 m0, s33
    s_add_u32 s33, s33, 11648
    buffer_load_dwordx4 v7, s[8:11], s33 offen lds
    buffer_load_dwordx4 v7, s[8:11], s33 offen offset:1024 lds
    s_cmp_lg_u32 s31, 0
    s_cbranch_scc1 K3_loopY
    buffer_load_dwordx4 v[132:135], v7, s[8:11], s42 offen offset:0
    buffer_load_dwordx4 v[136:139], v7, s[8:11], s42 offen offset:1024
    buffer_load_dwordx4 v[140:143], v7, s[8:11], s42 offen offset:2048
    buffer_load_dwordx4 v[144:147], v7, s[8:11], s42 offen offset:3072
    s_add_u32 s42, s42, 0x1000
    buffer_load_dwordx4 v[148:151], v7, s[8:11], s42 offen offset:0
    buffer_load_dwordx4 v[152:155], v7, s[8:11], s42 offen offset:1024
    buffer_load_dwordx4 v[156:159], v7, s[8:11], s42 offen offset:2048
    buffer_load_dwordx4 v[160:163], v7, s[8:11], s42 offen offset:3072
    s_add_u32 s42, s42, 0x1000
    buffer_load_dwordx4 v[164:167], v7, s[8:11], s42 offen offset:0
    buffer_load_dwordx4 v[168:171], v7, s[8:11], s42 offen offset:1024
    buffer_load_dwordx4 v[172:175], v7, s[8:11], s42 offen offset:2048
    buffer_load_dwordx4 v[176:179], v7, s[8:11], s42 offen offset:3072
    s_add_u32 s42, s42, 0x1000
    buffer_load_dwordx4 v[180:183], v7, s[8:11], s42 offen offset:0
    buffer_load_dwordx4 v[184:187], v7, s[8:11], s42 offen offset:1024
    buffer_load_dwordx4 v[188:191], v7, s[8:11], s42 offen offset:2048
    buffer_load_dwordx4 v[192:195], v7, s[8:11], s42 offen offset:3072
    s_add_u32 s42, s42, 0x1000
    buffer_load_dwordx4 v[196:199], v7, s[8:11], s42 offen offset:0
    buffer_load_dwordx4 v[200:203], v7, s[8:11], s42 offen offset:1024
    buffer_load_dwordx4 v[204:207], v7, s[8:11], s42 offen offset:2048
    buffer_load_dwordx4 v[208:211], v7, s[8:11], s42 offen offset:3072
    s_add_u32 s42, s42, 0x1000
    buffer_load_dwordx4 v[212:215], v7, s[8:11], s42 offen offset:0
    buffer_load_dwordx4 v[216:219], v7, s[8:11], s42 offen offset:1024
    buffer_load_dwordx4 v[220:223], v7, s[8:11], s42 offen offset:2048
    buffer_load_dwordx4 v[224:227], v7, s[8:11], s42 offen offset:3072
    s_add_u32 s42, s42, 0x1000
    buffer_load_dwordx4 v[228:231], v7, s[8:11], s42 offen offset:0
    buffer_load_dwordx4 v[232:235], v7, s[8:11], s42 offen offset:1024
    buffer_load_dwordx4 v[236:239], v7, s[8:11], s42 offen offset:2048
    v_lshlrev_b32 v4, 5, v0
    s_mul_i32 s6, s4, 1152
    buffer_load_dwordx4 v[240:243], v4, s[48:51], s6 offen
    buffer_load_dwordx4 v[244:247], v4, s[48:51], s6 offen offset:16
    s_cmp_ge_u32 s2, 16
    s_cbranch_scc1 K3_nowarm
    s_load_dwordx2 s[56:57], s[0:1], 88
    s_mov_b32 s58, 2359296
    s_mov_b32 s59, 0x20000
    s_getpc_b64 s[60:61]
K3_pc:
    s_add_u32 s60, s60, k5_ffn_kernel-K3_pc
    s_addc_u32 s61, s61, 0
    s_sub_u32 s33, s3, 4
    s_lshl_b32 s33, s33, 6
    v_add_u32 v4, s33, v0
    v_lshlrev_b32 v104, 7, v4
    v_min_u32 v104, CODE_END-k5_ffn_kernel-4, v104
    global_load_dword v105, v104, s[60:61]
    v_lshlrev_b32 v104, 18, v4
    v_min_u32 v104, 0x2500000, v104
    s_mov_b32 s33, 0x2000000
    buffer_load_dword v106, v104, s[8:11], s33 offen
    s_waitcnt lgkmcnt(0)
    buffer_load_dword v107, v104, s[56:59], 0 offen
K3_nowarm:
.p2align 3
K3_loopY:
    v_mfma_f32_32x32x16_bf16 v[32:47], v[80:83], v[8:11], 0
    ds_read_b128 v[72:75], v1 offset:4736
    ds_read_b32 v76, v2 offset:6976
    v_exp_f32 v16, v16
    v_exp_f32 v17, v17
    v_exp_f32 v18, v18
    v_exp_f32 v19, v19
    v_mfma_f32_32x32x16_bf16 v[56:71], v[100:103], v[52:55], v[56:71]
    ds_read_b128 v[96:99], v3 offset:3392
    ds_read_b128 v[100:103], v3 offset:4000
    v_exp_f32 v20, v20
    v_exp_f32 v21, v21
    v_exp_f32 v22, v22
    v_exp_f32 v23, v23
    v_cvt_pk_bf16_f32 v48, v16, v17
    v_cvt_pk_bf16_f32 v49, v18, v19
    v_mfma_f32_32x32x8_bf16 v[32:47], v[84:85], v[12:13], v[32:47]
    v_cvt_pk_bf16_f32 v50, v20, v21
    v_cvt_pk_bf16_f32 v51, v22, v23
    v_exp_f32 v24, v24
    v_exp_f32 v25, v25
    v_exp_f32 v26, v26
    v_exp_f32 v27, v27
    v_mfma_f32_32x32x16_bf16 v[56:71], v[88:91], v[48:51], v[56:71]
    s_waitcnt lgkmcnt(0)
    v_exp_f32 v28, v28
    v_exp_f32 v29, v29
    v_exp_f32 v30, v30
    v_exp_f32 v31, v31
    v_cvt_pk_bf16_f32 v52, v24, v25
    v_cvt_pk_bf16_f32 v53, v26, v27
    v_cvt_pk_bf16_f32 v54, v28, v29
    v_cvt_pk_bf16_f32 v55, v30, v31
    v_mfma_f32_32x32x16_bf16 v[16:31], v[72:75], v[8:11], 0
    ds_read_b128 v[80:83], v1 offset:7104
    ds_read_b32 v84, v2 offset:9344
    v_exp_f32 v32, v32
    v_exp_f32 v33, v33
    v_exp_f32 v34, v34
    v_exp_f32 v35, v35
    v_mfma_f32_32x32x16_bf16 v[56:71], v[92:95], v[52:55], v[56:71]
    ds_read_b128 v[88:91], v3 offset:5760
    ds_read_b128 v[92:95], v3 offset:6368
    v_exp_f32 v36, v36
    v_exp_f32 v37, v37
    v_exp_f32 v38, v38
    v_exp_f32 v39, v39
    v_cvt_pk_bf16_f32 v48, v32, v33
    v_cvt_pk_bf16_f32 v49, v34, v35
    v_mfma_f32_32x32x8_bf16 v[16:31], v[76:77], v[12:13], v[16:31]
    v_cvt_pk_bf16_f32 v50, v36, v37
    v_cvt_pk_bf16_f32 v51, v38, v39
    v_exp_f32 v40, v40
    v_exp_f32 v41, v41
    v_exp_f32 v42, v42
    v_exp_f32 v43, v43
    v_mfma_f32_32x32x16_bf16 v[56:71], v[96:99], v[48:51], v[56:71]
    s_waitcnt lgkmcnt(0)
    v_exp_f32 v44, v44
    v_exp_f32 v45, v45
    v_exp_f32 v46, v46
    v_exp_f32 v47, v47
    v_cvt_pk_bf16_f32 v52, v40, v41
    v_cvt_pk_bf16_f32 v53, v42, v43
    v_cvt_pk_bf16_f32 v54, v44, v45
    v_cvt_pk_bf16_f32 v55, v46, v47
    v_mfma_f32_32x32x16_bf16 v[32:47], v[80:83], v[8:11], 0
    ds_read_b128 v[72:75], v1 offset:9472
    ds_read_b32 v76, v2 offset:11712
    v_exp_f32 v16, v16
    v_exp_f32 v17, v17
    v_exp_f32 v18, v18
    v_exp_f32 v19, v19
    v_mfma_f32_32x32x16_bf16 v[56:71], v[100:103], v[52:55], v[56:71]
    ds_read_b128 v[96:99], v3 offset:8128
    ds_read_b128 v[100:103], v3 offset:8736
    v_exp_f32 v20, v20
    v_exp_f32 v21, v21
    v_exp_f32 v22, v22
    v_exp_f32 v23, v23
    v_cvt_pk_bf16_f32 v48, v16, v17
    v_cvt_pk_bf16_f32 v49, v18, v19
    v_mfma_f32_32x32x8_bf16 v[32:47], v[84:85], v[12:13], v[32:47]
    v_cvt_pk_bf16_f32 v50, v20, v21
    v_cvt_pk_bf16_f32 v51, v22, v23
    v_exp_f32 v24, v24
    v_exp_f32 v25, v25
    v_exp_f32 v26, v26
    v_exp_f32 v27, v27
    v_mfma_f32_32x32x16_bf16 v[56:71], v[88:91], v[48:51], v[56:71]
    s_waitcnt lgkmcnt(0)
    v_exp_f32 v28, v28
    v_exp_f32 v29, v29
    v_exp_f32 v30, v30
    v_exp_f32 v31, v31
    v_cvt_pk_bf16_f32 v52, v24, v25
    v_cvt_pk_bf16_f32 v53, v26, v27
    v_cvt_pk_bf16_f32 v54, v28, v29
    v_cvt_pk_bf16_f32 v55, v30, v31
    v_mfma_f32_32x32x16_bf16 v[16:31], v[72:75], v[8:11], 0
    ds_read_b128 v[80:83], v1 offset:11840
    ds_read_b32 v84, v2 offset:14080
    v_exp_f32 v32, v32
    v_exp_f32 v33, v33
    v_exp_f32 v34, v34
    v_exp_f32 v35, v35
    v_mfma_f32_32x32x16_bf16 v[56:71], v[92:95], v[52:55], v[56:71]
    ds_read_b128 v[88:91], v3 offset:10496
    ds_read_b128 v[92:95], v3 offset:11104
    v_exp_f32 v36, v36
    v_exp_f32 v37, v37
    v_exp_f32 v38, v38
    v_exp_f32 v39, v39
    v_cvt_pk_bf16_f32 v48, v32, v33
    v_cvt_pk_bf16_f32 v49, v34, v35
    v_mfma_f32_32x32x8_bf16 v[16:31], v[76:77], v[12:13], v[16:31]
    v_cvt_pk_bf16_f32 v50, v36, v37
    v_cvt_pk_bf16_f32 v51, v38, v39
    v_exp_f32 v40, v40
    v_exp_f32 v41, v41
    v_exp_f32 v42, v42
    v_exp_f32 v43, v43
    v_mfma_f32_32x32x16_bf16 v[56:71], v[96:99], v[48:51], v[56:71]
    s_waitcnt lgkmcnt(0)
    v_exp_f32 v44, v44
    v_exp_f32 v45, v45
    v_exp_f32 v46, v46
    v_exp_f32 v47, v47
    v_cvt_pk_bf16_f32 v52, v40, v41
    v_cvt_pk_bf16_f32 v53, v42, v43
    v_cvt_pk_bf16_f32 v54, v44, v45
    v_cvt_pk_bf16_f32 v55, v46, v47
    v_mfma_f32_32x32x16_bf16 v[32:47], v[80:83], v[8:11], 0
    ds_read_b128 v[72:75], v1 offset:14208
    ds_read_b32 v76, v2 offset:16448
    v_exp_f32 v16, v16
    v_exp_f32 v17, v17
    v_exp_f32 v18, v18
    v_exp_f32 v19, v19
    v_mfma_f32_32x32x16_bf16 v[56:71], v[100:103], v[52:55], v[56:71]
    ds_read_b128 v[96:99], v3 offset:12864
    ds_read_b128 v[100:103], v3 offset:13472
    v_exp_f32 v20, v20
    v_exp_f32 v21, v21
    v_exp_f32 v22, v22
    v_exp_f32 v23, v23
    v_cvt_pk_bf16_f32 v48, v16, v17
    v_cvt_pk_bf16_f32 v49, v18, v19
    v_mfma_f32_32x32x8_bf16 v[32:47], v[84:85], v[12:13], v[32:47]
    v_cvt_pk_bf16_f32 v50, v20, v21
    v_cvt_pk_bf16_f32 v51, v22, v23
    v_exp_f32 v24, v24
    v_exp_f32 v25, v25
    v_exp_f32 v26, v26
    v_exp_f32 v27, v27
    v_mfma_f32_32x32x16_bf16 v[56:71], v[88:91], v[48:51], v[56:71]
    s_waitcnt lgkmcnt(0)
    v_exp_f32 v28, v28
    v_exp_f32 v29, v29
    v_exp_f32 v30, v30
    v_exp_f32 v31, v31
    v_cvt_pk_bf16_f32 v52, v24, v25
    v_cvt_pk_bf16_f32 v53, v26, v27
    v_cvt_pk_bf16_f32 v54, v28, v29
    v_cvt_pk_bf16_f32 v55, v30, v31
    v_mfma_f32_32x32x16_bf16 v[16:31], v[72:75], v[8:11], 0
    ds_read_b128 v[80:83], v1 offset:16576
    ds_read_b32 v84, v2 offset:18816
    v_exp_f32 v32, v32
    v_exp_f32 v33, v33
    v_exp_f32 v34, v34
    v_exp_f32 v35, v35
    v_mfma_f32_32x32x16_bf16 v[56:71], v[92:95], v[52:55], v[56:71]
    ds_read_b128 v[88:91], v3 offset:15232
    ds_read_b128 v[92:95], v3 offset:15840
    v_exp_f32 v36, v36
    v_exp_f32 v37, v37
    v_exp_f32 v38, v38
    v_exp_f32 v39, v39
    v_cvt_pk_bf16_f32 v48, v32, v33
    v_cvt_pk_bf16_f32 v49, v34, v35
    v_mfma_f32_32x32x8_bf16 v[16:31], v[76:77], v[12:13], v[16:31]
    v_cvt_pk_bf16_f32 v50, v36, v37
    v_cvt_pk_bf16_f32 v51, v38, v39
    v_exp_f32 v40, v40
    v_exp_f32 v41, v41
    v_exp_f32 v42, v42
    v_exp_f32 v43, v43
    v_mfma_f32_32x32x16_bf16 v[56:71], v[96:99], v[48:51], v[56:71]
    s_waitcnt lgkmcnt(0)
    v_exp_f32 v44, v44
    v_exp_f32 v45, v45
    v_exp_f32 v46, v46
    v_exp_f32 v47, v47
    v_cvt_pk_bf16_f32 v52, v40, v41
    v_cvt_pk_bf16_f32 v53, v42, v43
    v_cvt_pk_bf16_f32 v54, v44, v45
    v_cvt_pk_bf16_f32 v55, v46, v47
    v_mfma_f32_32x32x16_bf16 v[32:47], v[80:83], v[8:11], 0
    ds_read_b128 v[72:75], v1 offset:18944
    ds_read_b32 v76, v2 offset:21184
    v_exp_f32 v16, v16
    v_exp_f32 v17, v17
    v_exp_f32 v18, v18
    v_exp_f32 v19, v19
    v_mfma_f32_32x32x16_bf16 v[56:71], v[100:103], v[52:55], v[56:71]
    ds_read_b128 v[96:99], v3 offset:17600
    ds_read_b128 v[100:103], v3 offset:18208
    v_exp_f32 v20, v20
    v_exp_f32 v21, v21
    v_exp_f32 v22, v22
    v_exp_f32 v23, v23
    v_cvt_pk_bf16_f32 v48, v16, v17
    v_cvt_pk_bf16_f32 v49, v18, v19
    v_mfma_f32_32x32x8_bf16 v[32:47], v[84:85], v[12:13], v[32:47]
    v_cvt_pk_bf16_f32 v50, v20, v21
    v_cvt_pk_bf16_f32 v51, v22, v23
    v_exp_f32 v24, v24
    v_exp_f32 v25, v25
    v_exp_f32 v26, v26
    v_exp_f32 v27, v27
    v_mfma_f32_32x32x16_bf16 v[56:71], v[88:91], v[48:51], v[56:71]
    s_waitcnt lgkmcnt(0)
    v_exp_f32 v28, v28
    v_exp_f32 v29, v29
    v_exp_f32 v30, v30
    v_exp_f32 v31, v31
    v_cvt_pk_bf16_f32 v52, v24, v25
    v_cvt_pk_bf16_f32 v53, v26, v27
    v_cvt_pk_bf16_f32 v54, v28, v29
    v_cvt_pk_bf16_f32 v55, v30, v31
    v_mfma_f32_32x32x16_bf16 v[16:31], v[72:75], v[8:11], 0
    ds_read_b128 v[80:83], v1 offset:21312
    ds_read_b32 v84, v2 offset:23552
    v_exp_f32 v32, v32
    v_exp_f32 v33, v33
    v_exp_f32 v34, v34
    v_exp_f32 v35, v35
    v_mfma_f32_32x32x16_bf16 v[56:71], v[92:95], v[52:55], v[56:71]
    ds_read_b128 v[88:91], v3 offset:19968
    ds_read_b128 v[92:95], v3 offset:20576
    v_exp_f32 v36, v36
    v_exp_f32 v37, v37
    v_exp_f32 v38, v38
    v_exp_f32 v39, v39
    v_cvt_pk_bf16_f32 v48, v32, v33
    v_cvt_pk_bf16_f32 v49, v34, v35
    v_mfma_f32_32x32x8_bf16 v[16:31], v[76:77], v[12:13], v[16:31]
    v_cvt_pk_bf16_f32 v50, v36, v37
    v_cvt_pk_bf16_f32 v51, v38, v39
    v_exp_f32 v40, v40
    v_exp_f32 v41, v41
    v_exp_f32 v42, v42
    v_exp_f32 v43, v43
    v_mfma_f32_32x32x16_bf16 v[56:71], v[96:99], v[48:51], v[56:71]
    s_waitcnt lgkmcnt(0)
    v_exp_f32 v44, v44
    v_exp_f32 v45, v45
    v_exp_f32 v46, v46
    v_exp_f32 v47, v47
    v_cvt_pk_bf16_f32 v52, v40, v41
    v_cvt_pk_bf16_f32 v53, v42, v43
    v_cvt_pk_bf16_f32 v54, v44, v45
    v_cvt_pk_bf16_f32 v55, v46, v47
    v_mfma_f32_32x32x16_bf16 v[32:47], v[80:83], v[8:11], 0
    ds_read_b128 v[72:75], v1 offset:23680
    ds_read_b32 v76, v2 offset:25920
    v_exp_f32 v16, v16
    v_exp_f32 v17, v17
    v_exp_f32 v18, v18
    v_exp_f32 v19, v19
    v_mfma_f32_32x32x16_bf16 v[56:71], v[100:103], v[52:55], v[56:71]
    ds_read_b128 v[96:99], v3 offset:22336
    ds_read_b128 v[100:103], v3 offset:22944
    v_exp_f32 v20, v20
    v_exp_f32 v21, v21
    v_exp_f32 v22, v22
    v_exp_f32 v23, v23
    v_cvt_pk_bf16_f32 v48, v16, v17
    v_cvt_pk_bf16_f32 v49, v18, v19
    v_mfma_f32_32x32x8_bf16 v[32:47], v[84:85], v[12:13], v[32:47]
    v_cvt_pk_bf16_f32 v50, v20, v21
    v_cvt_pk_bf16_f32 v51, v22, v23
    v_exp_f32 v24, v24
    v_exp_f32 v25, v25
    v_exp_f32 v26, v26
    v_exp_f32 v27, v27
    v_mfma_f32_32x32x16_bf16 v[56:71], v[88:91], v[48:51], v[56:71]
    s_waitcnt lgkmcnt(0)
    v_exp_f32 v28, v28
    v_exp_f32 v29, v29
    v_exp_f32 v30, v30
    v_exp_f32 v31, v31
    v_cvt_pk_bf16_f32 v52, v24, v25
    v_cvt_pk_bf16_f32 v53, v26, v27
    v_cvt_pk_bf16_f32 v54, v28, v29
    v_cvt_pk_bf16_f32 v55, v30, v31
    v_mfma_f32_32x32x16_bf16 v[16:31], v[72:75], v[8:11], 0
    ds_read_b128 v[80:83], v1 offset:26048
    ds_read_b32 v84, v2 offset:28288
    v_exp_f32 v32, v32
    v_exp_f32 v33, v33
    v_exp_f32 v34, v34
    v_exp_f32 v35, v35
    v_mfma_f32_32x32x16_bf16 v[56:71], v[92:95], v[52:55], v[56:71]
    ds_read_b128 v[88:91], v3 offset:24704
    ds_read_b128 v[92:95], v3 offset:25312
    v_exp_f32 v36, v36
    v_exp_f32 v37, v37
    v_exp_f32 v38, v38
    v_exp_f32 v39, v39
    v_cvt_pk_bf16_f32 v48, v32, v33
    v_cvt_pk_bf16_f32 v49, v34, v35
    v_mfma_f32_32x32x8_bf16 v[16:31], v[76:77], v[12:13], v[16:31]
    v_cvt_pk_bf16_f32 v50, v36, v37
    v_cvt_pk_bf16_f32 v51, v38, v39
    v_exp_f32 v40, v40
    v_exp_f32 v41, v41
    v_exp_f32 v42, v42
    v_exp_f32 v43, v43
    v_mfma_f32_32x32x16_bf16 v[56:71], v[96:99], v[48:51], v[56:71]
    s_waitcnt lgkmcnt(0)
    v_exp_f32 v44, v44
    v_exp_f32 v45, v45
    v_exp_f32 v46, v46
    v_exp_f32 v47, v47
    v_cvt_pk_bf16_f32 v52, v40, v41
    v_cvt_pk_bf16_f32 v53, v42, v43
    v_cvt_pk_bf16_f32 v54, v44, v45
    v_cvt_pk_bf16_f32 v55, v46, v47
    v_mfma_f32_32x32x16_bf16 v[32:47], v[80:83], v[8:11], 0
    ds_read_b128 v[72:75], v1 offset:28416
    ds_read_b32 v76, v2 offset:30656
    v_exp_f32 v16, v16
    v_exp_f32 v17, v17
    v_exp_f32 v18, v18
    v_exp_f32 v19, v19
    v_mfma_f32_32x32x16_bf16 v[56:71], v[100:103], v[52:55], v[56:71]
    ds_read_b128 v[96:99], v3 offset:27072
    ds_read_b128 v[100:103], v3 offset:27680
    v_exp_f32 v20, v20
    v_exp_f32 v21, v21
    v_exp_f32 v22, v22
    v_exp_f32 v23, v23
    v_cvt_pk_bf16_f32 v48, v16, v17
    v_cvt_pk_bf16_f32 v49, v18, v19
    v_mfma_f32_32x32x8_bf16 v[32:47], v[84:85], v[12:13], v[32:47]
    v_cvt_pk_bf16_f32 v50, v20, v21
    v_cvt_pk_bf16_f32 v51, v22, v23
    v_exp_f32 v24, v24
    v_exp_f32 v25, v25
    v_exp_f32 v26, v26
    v_exp_f32 v27, v27
    v_mfma_f32_32x32x16_bf16 v[56:71], v[88:91], v[48:51], v[56:71]
    s_waitcnt lgkmcnt(0)
    v_exp_f32 v28, v28
    v_exp_f32 v29, v29
    v_exp_f32 v30, v30
    v_exp_f32 v31, v31
    v_cvt_pk_bf16_f32 v52, v24, v25
    v_cvt_pk_bf16_f32 v53, v26, v27
    v_cvt_pk_bf16_f32 v54, v28, v29
    v_cvt_pk_bf16_f32 v55, v30, v31
    v_mfma_f32_32x32x16_bf16 v[16:31], v[72:75], v[8:11], 0
    ds_read_b128 v[80:83], v1 offset:30784
    ds_read_b32 v84, v2 offset:33024
    v_exp_f32 v32, v32
    v_exp_f32 v33, v33
    v_exp_f32 v34, v34
    v_exp_f32 v35, v35
    v_mfma_f32_32x32x16_bf16 v[56:71], v[92:95], v[52:55], v[56:71]
    ds_read_b128 v[88:91], v3 offset:29440
    ds_read_b128 v[92:95], v3 offset:30048
    v_exp_f32 v36, v36
    v_exp_f32 v37, v37
    v_exp_f32 v38, v38
    v_exp_f32 v39, v39
    v_cvt_pk_bf16_f32 v48, v32, v33
    v_cvt_pk_bf16_f32 v49, v34, v35
    v_mfma_f32_32x32x8_bf16 v[16:31], v[76:77], v[12:13], v[16:31]
    v_cvt_pk_bf16_f32 v50, v36, v37
    v_cvt_pk_bf16_f32 v51, v38, v39
    v_exp_f32 v40, v40
    v_exp_f32 v41, v41
    v_exp_f32 v42, v42
    v_exp_f32 v43, v43
    v_mfma_f32_32x32x16_bf16 v[56:71], v[96:99], v[48:51], v[56:71]
    s_waitcnt lgkmcnt(0)
    v_exp_f32 v44, v44
    v_exp_f32 v45, v45
    v_exp_f32 v46, v46
    v_exp_f32 v47, v47
    v_cvt_pk_bf16_f32 v52, v40, v41
    v_cvt_pk_bf16_f32 v53, v42, v43
    v_cvt_pk_bf16_f32 v54, v44, v45
    v_cvt_pk_bf16_f32 v55, v46, v47
    v_mfma_f32_32x32x16_bf16 v[32:47], v[80:83], v[8:11], 0
    ds_read_b128 v[72:75], v1 offset:33152
    ds_read_b32 v76, v2 offset:35392
    v_exp_f32 v16, v16
    v_exp_f32 v17, v17
    v_exp_f32 v18, v18
    v_exp_f32 v19, v19
    v_mfma_f32_32x32x16_bf16 v[56:71], v[100:103], v[52:55], v[56:71]
    ds_read_b128 v[96:99], v3 offset:31808
    ds_read_b128 v[100:103], v3 offset:32416
    v_exp_f32 v20, v20
    v_exp_f32 v21, v21
    v_exp_f32 v22, v22
    v_exp_f32 v23, v23
    v_cvt_pk_bf16_f32 v48, v16, v17
    v_cvt_pk_bf16_f32 v49, v18, v19
    v_mfma_f32_32x32x8_bf16 v[32:47], v[84:85], v[12:13], v[32:47]
    v_cvt_pk_bf16_f32 v50, v20, v21
    v_cvt_pk_bf16_f32 v51, v22, v23
    v_exp_f32 v24, v24
    v_exp_f32 v25, v25
    v_exp_f32 v26, v26
    v_exp_f32 v27, v27
    v_mfma_f32_32x32x16_bf16 v[56:71], v[88:91], v[48:51], v[56:71]
    s_waitcnt lgkmcnt(0)
    v_exp_f32 v28, v28
    v_exp_f32 v29, v29
    v_exp_f32 v30, v30
    v_exp_f32 v31, v31
    v_cvt_pk_bf16_f32 v52, v24, v25
    v_cvt_pk_bf16_f32 v53, v26, v27
    v_cvt_pk_bf16_f32 v54, v28, v29
    v_cvt_pk_bf16_f32 v55, v30, v31
    v_mfma_f32_32x32x16_bf16 v[16:31], v[72:75], v[8:11], 0
    ds_read_b128 v[80:83], v1 offset:35520
    ds_read_b32 v84, v2 offset:37760
    v_exp_f32 v32, v32
    v_exp_f32 v33, v33
    v_exp_f32 v34, v34
    v_exp_f32 v35, v35
    v_mfma_f32_32x32x16_bf16 v[56:71], v[92:95], v[52:55], v[56:71]
    ds_read_b128 v[88:91], v3 offset:34176
    ds_read_b128 v[92:95], v3 offset:34784
    v_exp_f32 v36, v36
    v_exp_f32 v37, v37
    v_exp_f32 v38, v38
    v_exp_f32 v39, v39
    v_cvt_pk_bf16_f32 v48, v32, v33
    v_cvt_pk_bf16_f32 v49, v34, v35
    v_mfma_f32_32x32x8_bf16 v[16:31], v[76:77], v[12:13], v[16:31]
    v_cvt_pk_bf16_f32 v50, v36, v37
    v_cvt_pk_bf16_f32 v51, v38, v39
    v_exp_f32 v40, v40
    v_exp_f32 v41, v41
    v_exp_f32 v42, v42
    v_exp_f32 v43, v43
    v_mfma_f32_32x32x16_bf16 v[56:71], v[96:99], v[48:51], v[56:71]
    s_waitcnt lgkmcnt(0)
    v_exp_f32 v44, v44
    v_exp_f32 v45, v45
    v_exp_f32 v46, v46
    v_exp_f32 v47, v47
    v_cvt_pk_bf16_f32 v52, v40, v41
    v_cvt_pk_bf16_f32 v53, v42, v43
    v_cvt_pk_bf16_f32 v54, v44, v45
    v_cvt_pk_bf16_f32 v55, v46, v47
    v_mfma_f32_32x32x16_bf16 v[32:47], v[80:83], v[8:11], 0
    ds_read_b128 v[72:75], v1 offset:37888
    ds_read_b32 v76, v2 offset:40128
    v_exp_f32 v16, v16
    v_exp_f32 v17, v17
    v_exp_f32 v18, v18
    v_exp_f32 v19, v19
    v_mfma_f32_32x32x16_bf16 v[56:71], v[100:103], v[52:55], v[56:71]
    ds_read_b128 v[96:99], v3 offset:36544
    ds_read_b128 v[100:103], v3 offset:37152
    v_exp_f32 v20, v20
    v_exp_f32 v21, v21
    v_exp_f32 v22, v22
    v_exp_f32 v23, v23
    v_cvt_pk_bf16_f32 v48, v16, v17
    v_cvt_pk_bf16_f32 v49, v18, v19
    v_mfma_f32_32x32x8_bf16 v[32:47], v[84:85], v[12:13], v[32:47]
    v_cvt_pk_bf16_f32 v50, v20, v21
    v_cvt_pk_bf16_f32 v51, v22, v23
    v_exp_f32 v24, v24
    v_exp_f32 v25, v25
    v_exp_f32 v26, v26
    v_exp_f32 v27, v27
    v_mfma_f32_32x32x16_bf16 v[56:71], v[88:91], v[48:51], v[56:71]
    s_waitcnt lgkmcnt(0)
    v_exp_f32 v28, v28
    v_exp_f32 v29, v29
    v_exp_f32 v30, v30
    v_exp_f32 v31, v31
    v_cvt_pk_bf16_f32 v52, v24, v25
    v_cvt_pk_bf16_f32 v53, v26, v27
    v_cvt_pk_bf16_f32 v54, v28, v29
    v_cvt_pk_bf16_f32 v55, v30, v31
    v_mfma_f32_32x32x16_bf16 v[16:31], v[72:75], v[8:11], 0
    ds_read_b128 v[80:83], v1 offset:40256
    ds_read_b32 v84, v2 offset:42496
    v_exp_f32 v32, v32
    v_exp_f32 v33, v33
    v_exp_f32 v34, v34
    v_exp_f32 v35, v35
    v_mfma_f32_32x32x16_bf16 v[56:71], v[92:95], v[52:55], v[56:71]
    ds_read_b128 v[88:91], v3 offset:38912
    ds_read_b128 v[92:95], v3 offset:39520
    v_exp_f32 v36, v36
    v_exp_f32 v37, v37
    v_exp_f32 v38, v38
    v_exp_f32 v39, v39
    v_cvt_pk_bf16_f32 v48, v32, v33
    v_cvt_pk_bf16_f32 v49, v34, v35
    v_mfma_f32_32x32x8_bf16 v[16:31], v[76:77], v[12:13], v[16:31]
    v_cvt_pk_bf16_f32 v50, v36, v37
    v_cvt_pk_bf16_f32 v51, v38, v39
    v_exp_f32 v40, v40
    v_exp_f32 v41, v41
    v_exp_f32 v42, v42
    v_exp_f32 v43, v43
    v_mfma_f32_32x32x16_bf16 v[56:71], v[96:99], v[48:51], v[56:71]
    s_waitcnt lgkmcnt(0)
    v_exp_f32 v44, v44
    v_exp_f32 v45, v45
    v_exp_f32 v46, v46
    v_exp_f32 v47, v47
    v_cvt_pk_bf16_f32 v52, v40, v41
    v_cvt_pk_bf16_f32 v53, v42, v43
    v_cvt_pk_bf16_f32 v54, v44, v45
    v_cvt_pk_bf16_f32 v55, v46, v47
    v_add_u32 v1, 37888, v1
    v_add_u32 v2, 37888, v2
    v_add_u32 v3, 37888, v3
    s_sub_u32 s30, s30, 1
    s_cmp_eq_u32 s30, 3
    s_cbranch_scc1 K3_barB
    s_cmp_lg_u32 s30, 0
    s_cbranch_scc1 K3_loopY
    s_branch K3_done
.p2align 3
K3_loopO:
    v_mfma_f32_32x32x16_bf16 v[32:47], v[80:83], v[8:11], 0
    ds_read_b128 v[72:75], v1 offset:4736
    ds_read_b32 v76, v2 offset:6976
    v_exp_f32 v16, v16
    v_exp_f32 v17, v17
    v_exp_f32 v18, v18
    v_exp_f32 v19, v19
    v_mfma_f32_32x32x16_bf16 v[56:71], v[100:103], v[52:55], v[56:71]
    ds_read_b128 v[96:99], v3 offset:3392
    ds_read_b128 v[100:103], v3 offset:4000
    v_exp_f32 v20, v20
    v_exp_f32 v21, v21
    v_exp_f32 v22, v22
    v_exp_f32 v23, v23
    v_cvt_pk_bf16_f32 v48, v16, v17
    v_cvt_pk_bf16_f32 v49, v18, v19
    v_mfma_f32_32x32x8_bf16 v[32:47], v[84:85], v[12:13], v[32:47]
    v_cvt_pk_bf16_f32 v50, v20, v21
    v_cvt_pk_bf16_f32 v51, v22, v23
    v_exp_f32 v24, v24
    v_exp_f32 v25, v25
    v_exp_f32 v26, v26
    v_exp_f32 v27, v27
    v_mfma_f32_32x32x16_bf16 v[56:71], v[88:91], v[48:51], v[56:71]
    s_waitcnt lgkmcnt(0)
    v_exp_f32 v28, v28
    v_exp_f32 v29, v29
    v_exp_f32 v30, v30
    v_exp_f32 v31, v31
    v_cvt_pk_bf16_f32 v52, v24, v25
    v_cvt_pk_bf16_f32 v53, v26, v27
    v_cvt_pk_bf16_f32 v54, v28, v29
    v_cvt_pk_bf16_f32 v55, v30, v31
    v_mfma_f32_32x32x16_bf16 v[16:31], v[72:75], v[8:11], 0
    ds_read_b128 v[80:83], v1 offset:7104
    ds_read_b32 v84, v2 offset:9344
    v_exp_f32 v32, v32
    v_exp_f32 v33, v33
    v_exp_f32 v34, v34
    v_exp_f32 v35, v35
    v_mfma_f32_32x32x16_bf16 v[56:71], v[92:95], v[52:55], v[56:71]
    ds_read_b128 v[88:91], v3 offset:5760
    ds_read_b128 v[92:95], v3 offset:6368
    v_exp_f32 v36, v36
    v_exp_f32 v37, v37
    v_exp_f32 v38, v38
    v_exp_f32 v39, v39
    v_cvt_pk_bf16_f32 v48, v32, v33
    v_cvt_pk_bf16_f32 v49, v34, v35
    v_mfma_f32_32x32x8_bf16 v[16:31], v[76:77], v[12:13], v[16:31]
    v_cvt_pk_bf16_f32 v50, v36, v37
    v_cvt_pk_bf16_f32 v51, v38, v39
    v_exp_f32 v40, v40
    v_exp_f32 v41, v41
    v_exp_f32 v42, v42
    v_exp_f32 v43, v43
    v_mfma_f32_32x32x16_bf16 v[56:71], v[96:99], v[48:51], v[56:71]
    s_waitcnt lgkmcnt(0)
    v_exp_f32 v44, v44
    v_exp_f32 v45, v45
    v_exp_f32 v46, v46
    v_exp_f32 v47, v47
    v_cvt_pk_bf16_f32 v52, v40, v41
    v_cvt_pk_bf16_f32 v53, v42, v43
    v_cvt_pk_bf16_f32 v54, v44, v45
    v_cvt_pk_bf16_f32 v55, v46, v47
    v_mfma_f32_32x32x16_bf16 v[32:47], v[80:83], v[8:11], 0
    ds_read_b128 v[72:75], v1 offset:9472
    ds_read_b32 v76, v2 offset:11712
    v_exp_f32 v16, v16
    v_exp_f32 v17, v17
    v_exp_f32 v18, v18
    v_exp_f32 v19, v19
    v_mfma_f32_32x32x16_bf16 v[56:71], v[100:103], v[52:55], v[56:71]
    ds_read_b128 v[96:99], v3 offset:8128
    ds_read_b128 v[100:103], v3 offset:8736
    v_exp_f32 v20, v20
    v_exp_f32 v21, v21
    v_exp_f32 v22, v22
    v_exp_f32 v23, v23
    v_cvt_pk_bf16_f32 v48, v16, v17
    v_cvt_pk_bf16_f32 v49, v18, v19
    v_mfma_f32_32x32x8_bf16 v[32:47], v[84:85], v[12:13], v[32:47]
    v_cvt_pk_bf16_f32 v50, v20, v21
    v_cvt_pk_bf16_f32 v51, v22, v23
    v_exp_f32 v24, v24
    v_exp_f32 v25, v25
    v_exp_f32 v26, v26
    v_exp_f32 v27, v27
    v_mfma_f32_32x32x16_bf16 v[56:71], v[88:91], v[48:51], v[56:71]
    s_waitcnt lgkmcnt(0)
    v_exp_f32 v28, v28
    v_exp_f32 v29, v29
    v_exp_f32 v30, v30
    v_exp_f32 v31, v31
    v_cvt_pk_bf16_f32 v52, v24, v25
    v_cvt_pk_bf16_f32 v53, v26, v27
    v_cvt_pk_bf16_f32 v54, v28, v29
    v_cvt_pk_bf16_f32 v55, v30, v31
    v_mfma_f32_32x32x16_bf16 v[16:31], v[72:75], v[8:11], 0
    ds_read_b128 v[80:83], v1 offset:11840
    ds_read_b32 v84, v2 offset:14080
    v_exp_f32 v32, v32
    v_exp_f32 v33, v33
    v_exp_f32 v34, v34
    v_exp_f32 v35, v35
    v_mfma_f32_32x32x16_bf16 v[56:71], v[92:95], v[52:55], v[56:71]
    ds_read_b128 v[88:91], v3 offset:10496
    ds_read_b128 v[92:95], v3 offset:11104
    v_exp_f32 v36, v36
    v_exp_f32 v37, v37
    v_exp_f32 v38, v38
    v_exp_f32 v39, v39
    v_cvt_pk_bf16_f32 v48, v32, v33
    v_cvt_pk_bf16_f32 v49, v34, v35
    v_mfma_f32_32x32x8_bf16 v[16:31], v[76:77], v[12:13], v[16:31]
    v_cvt_pk_bf16_f32 v50, v36, v37
    v_cvt_pk_bf16_f32 v51, v38, v39
    v_exp_f32 v40, v40
    v_exp_f32 v41, v41
    v_exp_f32 v42, v42
    v_exp_f32 v43, v43
    v_mfma_f32_32x32x16_bf16 v[56:71], v[96:99], v[48:51], v[56:71]
    s_waitcnt lgkmcnt(0)
    v_exp_f32 v44, v44
    v_exp_f32 v45, v45
    v_exp_f32 v46, v46
    v_exp_f32 v47, v47
    v_cvt_pk_bf16_f32 v52, v40, v41
    v_cvt_pk_bf16_f32 v53, v42, v43
    v_cvt_pk_bf16_f32 v54, v44, v45
    v_cvt_pk_bf16_f32 v55, v46, v47
    v_mfma_f32_32x32x16_bf16 v[32:47], v[80:83], v[8:11], 0
    ds_read_b128 v[72:75], v1 offset:14208
    ds_read_b32 v76, v2 offset:16448
    v_exp_f32 v16, v16
    v_exp_f32 v17, v17
    v_exp_f32 v18, v18
    v_exp_f32 v19, v19
    v_mfma_f32_32x32x16_bf16 v[56:71], v[100:103], v[52:55], v[56:71]
    ds_read_b128 v[96:99], v3 offset:12864
    ds_read_b128 v[100:103], v3 offset:13472
    v_exp_f32 v20, v20
    v_exp_f32 v21, v21
    v_exp_f32 v22, v22
    v_exp_f32 v23, v23
    v_cvt_pk_bf16_f32 v48, v16, v17
    v_cvt_pk_bf16_f32 v49, v18, v19
    v_mfma_f32_32x32x8_bf16 v[32:47], v[84:85], v[12:13], v[32:47]
    v_cvt_pk_bf16_f32 v50, v20, v21
    v_cvt_pk_bf16_f32 v51, v22, v23
    v_exp_f32 v24, v24
    v_exp_f32 v25, v25
    v_exp_f32 v26, v26
    v_exp_f32 v27, v27
    v_mfma_f32_32x32x16_bf16 v[56:71], v[88:91], v[48:51], v[56:71]
    s_waitcnt lgkmcnt(0)
    v_exp_f32 v28, v28
    v_exp_f32 v29, v29
    v_exp_f32 v30, v30
    v_exp_f32 v31, v31
    v_cvt_pk_bf16_f32 v52, v24, v25
    v_cvt_pk_bf16_f32 v53, v26, v27
    v_cvt_pk_bf16_f32 v54, v28, v29
    v_cvt_pk_bf16_f32 v55, v30, v31
    v_mfma_f32_32x32x16_bf16 v[16:31], v[72:75], v[8:11], 0
    ds_read_b128 v[80:83], v1 offset:16576
    ds_read_b32 v84, v2 offset:18816
    v_exp_f32 v32, v32
    v_exp_f32 v33, v33
    v_exp_f32 v34, v34
    v_exp_f32 v35, v35
    v_mfma_f32_32x32x16_bf16 v[56:71], v[92:95], v[52:55], v[56:71]
    ds_read_b128 v[88:91], v3 offset:15232
    ds_read_b128 v[92:95], v3 offset:15840
    v_exp_f32 v36, v36
    v_exp_f32 v37, v37
    v_exp_f32 v38, v38
    v_exp_f32 v39, v39
    v_cvt_pk_bf16_f32 v48, v32, v33
    v_cvt_pk_bf16_f32 v49, v34, v35
    v_mfma_f32_32x32x8_bf16 v[16:31], v[76:77], v[12:13], v[16:31]
    v_cvt_pk_bf16_f32 v50, v36, v37
    v_cvt_pk_bf16_f32 v51, v38, v39
    v_exp_f32 v40, v40
    v_exp_f32 v41, v41
    v_exp_f32 v42, v42
    v_exp_f32 v43, v43
    v_mfma_f32_32x32x16_bf16 v[56:71], v[96:99], v[48:51], v[56:71]
    s_waitcnt lgkmcnt(0)
    v_exp_f32 v44, v44
    v_exp_f32 v45, v45
    v_exp_f32 v46, v46
    v_exp_f32 v47, v47
    v_cvt_pk_bf16_f32 v52, v40, v41
    v_cvt_pk_bf16_f32 v53, v42, v43
    v_cvt_pk_bf16_f32 v54, v44, v45
    v_cvt_pk_bf16_f32 v55, v46, v47
    v_mfma_f32_32x32x16_bf16 v[32:47], v[80:83], v[8:11], 0
    s_waitcnt vmcnt(4)
    ds_write_b128 v5, v[248:251]
    ds_read_b64_tr_b16 v[112:113], v6
    ds_read_b64_tr_b16 v[116:117], v6 offset:8
    ds_write_b128 v5, v[252:255]
    ds_read_b64_tr_b16 v[114:115], v6
    ds_read_b64_tr_b16 v[118:119], v6 offset:8
    ds_read_b128 v[72:75], v1 offset:18944
    ds_read_b32 v76, v2 offset:21184
    v_exp_f32 v16, v16
    v_exp_f32 v17, v17
    v_exp_f32 v18, v18
    v_exp_f32 v19, v19
    v_mfma_f32_32x32x16_bf16 v[56:71], v[100:103], v[52:55], v[56:71]
    ds_read_b128 v[96:99], v3 offset:17600
    ds_read_b128 v[100:103], v3 offset:18208
    v_exp_f32 v20, v20
    v_exp_f32 v21, v21
    v_exp_f32 v22, v22
    v_exp_f32 v23, v23
    v_cvt_pk_bf16_f32 v48, v16, v17
    v_cvt_pk_bf16_f32 v49, v18, v19
    v_mfma_f32_32x32x8_bf16 v[32:47], v[84:85], v[12:13], v[32:47]
    v_cvt_pk_bf16_f32 v50, v20, v21
    v_cvt_pk_bf16_f32 v51, v22, v23
    v_exp_f32 v24, v24
    v_exp_f32 v25, v25
    v_exp_f32 v26, v26
    v_exp_f32 v27, v27
    v_mfma_f32_32x32x16_bf16 v[56:71], v[88:91], v[48:51], v[56:71]
    s_waitcnt lgkmcnt(0)
    v_exp_f32 v28, v28
    v_exp_f32 v29, v29
    v_exp_f32 v30, v30
    v_exp_f32 v31, v31
    v_cvt_pk_bf16_f32 v52, v24, v25
    v_cvt_pk_bf16_f32 v53, v26, v27
    v_cvt_pk_bf16_f32 v54, v28, v29
    v_cvt_pk_bf16_f32 v55, v30, v31
    v_mfma_f32_32x32x16_bf16 v[16:31], v[72:75], v[8:11], 0
    buffer_store_dwordx4 v[112:115], v130, s[20:23], s53 offen sc1
    buffer_store_dwordx4 v[116:119], v131, s[20:23], s53 offen sc1
    s_add_u32 s53, s53, 256
    buffer_load_dwordx4 v[248:251], v14, s[16:19], s52 offen
    s_add_u32 s52, s52, s36
    buffer_load_dwordx4 v[252:255], v14, s[16:19], s52 offen
    s_add_u32 s52, s52, s36
    ds_read_b128 v[80:83], v1 offset:21312
    ds_read_b32 v84, v2 offset:23552
    v_exp_f32 v32, v32
    v_exp_f32 v33, v33
    v_exp_f32 v34, v34
    v_exp_f32 v35, v35
    v_mfma_f32_32x32x16_bf16 v[56:71], v[92:95], v[52:55], v[56:71]
    ds_read_b128 v[88:91], v3 offset:19968
    ds_read_b128 v[92:95], v3 offset:20576
    v_exp_f32 v36, v36
    v_exp_f32 v37, v37
    v_exp_f32 v38, v38
    v_exp_f32 v39, v39
    v_cvt_pk_bf16_f32 v48, v32, v33
    v_cvt_pk_bf16_f32 v49, v34, v35
    v_mfma_f32_32x32x8_bf16 v[16:31], v[76:77], v[12:13], v[16:31]
    v_cvt_pk_bf16_f32 v50, v36, v37
    v_cvt_pk_bf16_f32 v51, v38, v39
    v_exp_f32 v40, v40
    v_exp_f32 v41, v41
    v_exp_f32 v42, v42
    v_exp_f32 v43, v43
    v_mfma_f32_32x32x16_bf16 v[56:71], v[96:99], v[48:51], v[56:71]
    s_waitcnt lgkmcnt(0)
    v_exp_f32 v44, v44
    v_exp_f32 v45, v45
    v_exp_f32 v46, v46
    v_exp_f32 v47, v47
    v_cvt_pk_bf16_f32 v52, v40, v41
    v_cvt_pk_bf16_f32 v53, v42, v43
    v_cvt_pk_bf16_f32 v54, v44, v45
    v_cvt_pk_bf16_f32 v55, v46, v47
    v_mfma_f32_32x32x16_bf16 v[32:47], v[80:83], v[8:11], 0
    ds_read_b128 v[72:75], v1 offset:23680
    ds_read_b32 v76, v2 offset:25920
    v_exp_f32 v16, v16
    v_exp_f32 v17, v17
    v_exp_f32 v18, v18
    v_exp_f32 v19, v19
    v_mfma_f32_32x32x16_bf16 v[56:71], v[100:103], v[52:55], v[56:71]
    ds_read_b128 v[96:99], v3 offset:22336
    ds_read_b128 v[100:103], v3 offset:22944
    v_exp_f32 v20, v20
    v_exp_f32 v21, v21
    v_exp_f32 v22, v22
    v_exp_f32 v23, v23
    v_cvt_pk_bf16_f32 v48, v16, v17
    v_cvt_pk_bf16_f32 v49, v18, v19
    v_mfma_f32_32x32x8_bf16 v[32:47], v[84:85], v[12:13], v[32:47]
    v_cvt_pk_bf16_f32 v50, v20, v21
    v_cvt_pk_bf16_f32 v51, v22, v23
    v_exp_f32 v24, v24
    v_exp_f32 v25, v25
    v_exp_f32 v26, v26
    v_exp_f32 v27, v27
    v_mfma_f32_32x32x16_bf16 v[56:71], v[88:91], v[48:51], v[56:71]
    s_waitcnt lgkmcnt(0)
    v_exp_f32 v28, v28
    v_exp_f32 v29, v29
    v_exp_f32 v30, v30
    v_exp_f32 v31, v31
    v_cvt_pk_bf16_f32 v52, v24, v25
    v_cvt_pk_bf16_f32 v53, v26, v27
    v_cvt_pk_bf16_f32 v54, v28, v29
    v_cvt_pk_bf16_f32 v55, v30, v31
    v_mfma_f32_32x32x16_bf16 v[16:31], v[72:75], v[8:11], 0
    ds_read_b128 v[80:83], v1 offset:26048
    ds_read_b32 v84, v2 offset:28288
    v_exp_f32 v32, v32
    v_exp_f32 v33, v33
    v_exp_f32 v34, v34
    v_exp_f32 v35, v35
    v_mfma_f32_32x32x16_bf16 v[56:71], v[92:95], v[52:55], v[56:71]
    ds_read_b128 v[88:91], v3 offset:24704
    ds_read_b128 v[92:95], v3 offset:25312
    v_exp_f32 v36, v36
    v_exp_f32 v37, v37
    v_exp_f32 v38, v38
    v_exp_f32 v39, v39
    v_cvt_pk_bf16_f32 v48, v32, v33
    v_cvt_pk_bf16_f32 v49, v34, v35
    v_mfma_f32_32x32x8_bf16 v[16:31], v[76:77], v[12:13], v[16:31]
    v_cvt_pk_bf16_f32 v50, v36, v37
    v_cvt_pk_bf16_f32 v51, v38, v39
    v_exp_f32 v40, v40
    v_exp_f32 v41, v41
    v_exp_f32 v42, v42
    v_exp_f32 v43, v43
    v_mfma_f32_32x32x16_bf16 v[56:71], v[96:99], v[48:51], v[56:71]
    s_waitcnt lgkmcnt(0)
    v_exp_f32 v44, v44
    v_exp_f32 v45, v45
    v_exp_f32 v46, v46
    v_exp_f32 v47, v47
    v_cvt_pk_bf16_f32 v52, v40, v41
    v_cvt_pk_bf16_f32 v53, v42, v43
    v_cvt_pk_bf16_f32 v54, v44, v45
    v_cvt_pk_bf16_f32 v55, v46, v47
    v_mfma_f32_32x32x16_bf16 v[32:47], v[80:83], v[8:11], 0
    ds_read_b128 v[72:75], v1 offset:28416
    ds_read_b32 v76, v2 offset:30656
    v_exp_f32 v16, v16
    v_exp_f32 v17, v17
    v_exp_f32 v18, v18
    v_exp_f32 v19, v19
    v_mfma_f32_32x32x16_bf16 v[56:71], v[100:103], v[52:55], v[56:71]
    ds_read_b128 v[96:99], v3 offset:27072
    ds_read_b128 v[100:103], v3 offset:27680
    v_exp_f32 v20, v20
    v_exp_f32 v21, v21
    v_exp_f32 v22, v22
    v_exp_f32 v23, v23
    v_cvt_pk_bf16_f32 v48, v16, v17
    v_cvt_pk_bf16_f32 v49, v18, v19
    v_mfma_f32_32x32x8_bf16 v[32:47], v[84:85], v[12:13], v[32:47]
    v_cvt_pk_bf16_f32 v50, v20, v21
    v_cvt_pk_bf16_f32 v51, v22, v23
    v_exp_f32 v24, v24
    v_exp_f32 v25, v25
    v_exp_f32 v26, v26
    v_exp_f32 v27, v27
    v_mfma_f32_32x32x16_bf16 v[56:71], v[88:91], v[48:51], v[56:71]
    s_waitcnt lgkmcnt(0)
    v_exp_f32 v28, v28
    v_exp_f32 v29, v29
    v_exp_f32 v30, v30
    v_exp_f32 v31, v31
    v_cvt_pk_bf16_f32 v52, v24, v25
    v_cvt_pk_bf16_f32 v53, v26, v27
    v_cvt_pk_bf16_f32 v54, v28, v29
    v_cvt_pk_bf16_f32 v55, v30, v31
    v_mfma_f32_32x32x16_bf16 v[16:31], v[72:75], v[8:11], 0
    ds_read_b128 v[80:83], v1 offset:30784
    ds_read_b32 v84, v2 offset:33024
    v_exp_f32 v32, v32
    v_exp_f32 v33, v33
    v_exp_f32 v34, v34
    v_exp_f32 v35, v35
    v_mfma_f32_32x32x16_bf16 v[56:71], v[92:95], v[52:55], v[56:71]
    ds_read_b128 v[88:91], v3 offset:29440
    ds_read_b128 v[92:95], v3 offset:30048
    v_exp_f32 v36, v36
    v_exp_f32 v37, v37
    v_exp_f32 v38, v38
    v_exp_f32 v39, v39
    v_cvt_pk_bf16_f32 v48, v32, v33
    v_cvt_pk_bf16_f32 v49, v34, v35
    v_mfma_f32_32x32x8_bf16 v[16:31], v[76:77], v[12:13], v[16:31]
    v_cvt_pk_bf16_f32 v50, v36, v37
    v_cvt_pk_bf16_f32 v51, v38, v39
    v_exp_f32 v40, v40
    v_exp_f32 v41, v41
    v_exp_f32 v42, v42
    v_exp_f32 v43, v43
    v_mfma_f32_32x32x16_bf16 v[56:71], v[96:99], v[48:51], v[56:71]
    s_waitcnt lgkmcnt(0)
    v_exp_f32 v44, v44
    v_exp_f32 v45, v45
    v_exp_f32 v46, v46
    v_exp_f32 v47, v47
    v_cvt_pk_bf16_f32 v52, v40, v41
    v_cvt_pk_bf16_f32 v53, v42, v43
    v_cvt_pk_bf16_f32 v54, v44, v45
    v_cvt_pk_bf16_f32 v55, v46, v47
    v_mfma_f32_32x32x16_bf16 v[32:47], v[80:83], v[8:11], 0
    ds_read_b128 v[72:75], v1 offset:33152
    ds_read_b32 v76, v2 offset:35392
    v_exp_f32 v16, v16
    v_exp_f32 v17, v17
    v_exp_f32 v18, v18
    v_exp_f32 v19, v19
    v_mfma_f32_32x32x16_bf16 v[56:71], v[100:103], v[52:55], v[56:71]
    ds_read_b128 v[96:99], v3 offset:31808
    ds_read_b128 v[100:103], v3 offset:32416
    v_exp_f32 v20, v20
    v_exp_f32 v21, v21
    v_exp_f32 v22, v22
    v_exp_f32 v23, v23
    v_cvt_pk_bf16_f32 v48, v16, v17
    v_cvt_pk_bf16_f32 v49, v18, v19
    v_mfma_f32_32x32x8_bf16 v[32:47], v[84:85], v[12:13], v[32:47]
    v_cvt_pk_bf16_f32 v50, v20, v21
    v_cvt_pk_bf16_f32 v51, v22, v23
    v_exp_f32 v24, v24
    v_exp_f32 v25, v25
    v_exp_f32 v26, v26
    v_exp_f32 v27, v27
    v_mfma_f32_32x32x16_bf16 v[56:71], v[88:91], v[48:51], v[56:71]
    s_waitcnt lgkmcnt(0)
    v_exp_f32 v28, v28
    v_exp_f32 v29, v29
    v_exp_f32 v30, v30
    v_exp_f32 v31, v31
    v_cvt_pk_bf16_f32 v52, v24, v25
    v_cvt_pk_bf16_f32 v53, v26, v27
    v_cvt_pk_bf16_f32 v54, v28, v29
    v_cvt_pk_bf16_f32 v55, v30, v31
    v_mfma_f32_32x32x16_bf16 v[16:31], v[72:75], v[8:11], 0
    ds_read_b128 v[80:83], v1 offset:35520
    ds_read_b32 v84, v2 offset:37760
    v_exp_f32 v32, v32
    v_exp_f32 v33, v33
    v_exp_f32 v34, v34
    v_exp_f32 v35, v35
    v_mfma_f32_32x32x16_bf16 v[56:71], v[92:95], v[52:55], v[56:71]
    ds_read_b128 v[88:91], v3 offset:34176
    ds_read_b128 v[92:95], v3 offset:34784
    v_exp_f32 v36, v36
    v_exp_f32 v37, v37
    v_exp_f32 v38, v38
    v_exp_f32 v39, v39
    v_cvt_pk_bf16_f32 v48, v32, v33
    v_cvt_pk_bf16_f32 v49, v34, v35
    v_mfma_f32_32x32x8_bf16 v[16:31], v[76:77], v[12:13], v[16:31]
    v_cvt_pk_bf16_f32 v50, v36, v37
    v_cvt_pk_bf16_f32 v51, v38, v39
    v_exp_f32 v40, v40
    v_exp_f32 v41, v41
    v_exp_f32 v42, v42
    v_exp_f32 v43, v43
    v_mfma_f32_32x32x16_bf16 v[56:71], v[96:99], v[48:51], v[56:71]
    s_waitcnt lgkmcnt(0)
    v_exp_f32 v44, v44
    v_exp_f32 v45, v45
    v_exp_f32 v46, v46
    v_exp_f32 v47, v47
    v_cvt_pk_bf16_f32 v52, v40, v41
    v_cvt_pk_bf16_f32 v53, v42, v43
    v_cvt_pk_bf16_f32 v54, v44, v45
    v_cvt_pk_bf16_f32 v55, v46, v47
    v_mfma_f32_32x32x16_bf16 v[32:47], v[80:83], v[8:11], 0
    s_waitcnt vmcnt(4)
    ds_write_b128 v5, v[104:107]
    ds_read_b64_tr_b16 v[112:113], v6
    ds_read_b64_tr_b16 v[116:117], v6 offset:8
    ds_write_b128 v5, v[108:111]
    ds_read_b64_tr_b16 v[114:115], v6
    ds_read_b64_tr_b16 v[118:119], v6 offset:8
    ds_read_b128 v[72:75], v1 offset:37888
    ds_read_b32 v76, v2 offset:40128
    v_exp_f32 v16, v16
    v_exp_f32 v17, v17
    v_exp_f32 v18, v18
    v_exp_f32 v19, v19
    v_mfma_f32_32x32x16_bf16 v[56:71], v[100:103], v[52:55], v[56:71]
    ds_read_b128 v[96:99], v3 offset:36544
    ds_read_b128 v[100:103], v3 offset:37152
    v_exp_f32 v20, v20
    v_exp_f32 v21, v21
    v_exp_f32 v22, v22
    v_exp_f32 v23, v23
    v_cvt_pk_bf16_f32 v48, v16, v17
    v_cvt_pk_bf16_f32 v49, v18, v19
    v_mfma_f32_32x32x8_bf16 v[32:47], v[84:85], v[12:13], v[32:47]
    v_cvt_pk_bf16_f32 v50, v20, v21
    v_cvt_pk_bf16_f32 v51, v22, v23
    v_exp_f32 v24, v24
    v_exp_f32 v25, v25
    v_exp_f32 v26, v26
    v_exp_f32 v27, v27
    v_mfma_f32_32x32x16_bf16 v[56:71], v[88:91], v[48:51], v[56:71]
    s_waitcnt lgkmcnt(0)
    v_exp_f32 v28, v28
    v_exp_f32 v29, v29
    v_exp_f32 v30, v30
    v_exp_f32 v31, v31
    v_cvt_pk_bf16_f32 v52, v24, v25
    v_cvt_pk_bf16_f32 v53, v26, v27
    v_cvt_pk_bf16_f32 v54, v28, v29
    v_cvt_pk_bf16_f32 v55, v30, v31
    v_mfma_f32_32x32x16_bf16 v[16:31], v[72:75], v[8:11], 0
    buffer_store_dwordx4 v[112:115], v120, s[20:23], s37 offen sc1
    buffer_store_dwordx4 v[116:119], v129, s[20:23], s37 offen sc1
    s_add_u32 s37, s37, 256
    buffer_load_dwordx4 v[104:107], v4, s[16:19], s34 offen
    s_add_u32 s34, s34, s36
    buffer_load_dwordx4 v[108:111], v4, s[16:19], s34 offen
    s_add_u32 s34, s34, s36
    ds_read_b128 v[80:83], v1 offset:40256
    ds_read_b32 v84, v2 offset:42496
    v_exp_f32 v32, v32
    v_exp_f32 v33, v33
    v_exp_f32 v34, v34
    v_exp_f32 v35, v35
    v_mfma_f32_32x32x16_bf16 v[56:71], v[92:95], v[52:55], v[56:71]
    ds_read_b128 v[88:91], v3 offset:38912
    ds_read_b128 v[92:95], v3 offset:39520
    v_exp_f32 v36, v36
    v_exp_f32 v37, v37
    v_exp_f32 v38, v38
    v_exp_f32 v39, v39
    v_cvt_pk_bf16_f32 v48, v32, v33
    v_cvt_pk_bf16_f32 v49, v34, v35
    v_mfma_f32_32x32x8_bf16 v[16:31], v[76:77], v[12:13], v[16:31]
    v_cvt_pk_bf16_f32 v50, v36, v37
    v_cvt_pk_bf16_f32 v51, v38, v39
    v_exp_f32 v40, v40
    v_exp_f32 v41, v41
    v_exp_f32 v42, v42
    v_exp_f32 v43, v43
    v_mfma_f32_32x32x16_bf16 v[56:71], v[96:99], v[48:51], v[56:71]
    s_waitcnt lgkmcnt(0)
    v_exp_f32 v44, v44
    v_exp_f32 v45, v45
    v_exp_f32 v46, v46
    v_exp_f32 v47, v47
    v_cvt_pk_bf16_f32 v52, v40, v41
    v_cvt_pk_bf16_f32 v53, v42, v43
    v_cvt_pk_bf16_f32 v54, v44, v45
    v_cvt_pk_bf16_f32 v55, v46, v47
    v_add_u32 v1, 37888, v1
    v_add_u32 v2, 37888, v2
    v_add_u32 v3, 37888, v3
    s_sub_u32 s30, s30, 1
    s_cmp_eq_u32 s30, 3
    s_cbranch_scc1 K3_barB
    s_cmp_lg_u32 s30, 1
    s_cbranch_scc1 K3_loopO
    v_mfma_f32_32x32x16_bf16 v[32:47], v[80:83], v[8:11], 0
    buffer_load_dwordx4 v[132:135], v7, s[8:11], s42 offen offset:0
    buffer_load_dwordx4 v[136:139], v7, s[8:11], s42 offen offset:1024
    ds_read_b128 v[72:75], v1 offset:4736
    ds_read_b32 v76, v2 offset:6976
    v_exp_f32 v16, v16
    v_exp_f32 v17, v17
    v_exp_f32 v18, v18
    v_exp_f32 v19, v19
    v_mfma_f32_32x32x16_bf16 v[56:71], v[100:103], v[52:55], v[56:71]
    ds_read_b128 v[96:99], v3 offset:3392
    ds_read_b128 v[100:103], v3 offset:4000
    v_exp_f32 v20, v20
    v_exp_f32 v21, v21
    v_exp_f32 v22, v22
    v_exp_f32 v23, v23
    v_cvt_pk_bf16_f32 v48, v16, v17
    v_cvt_pk_bf16_f32 v49, v18, v19
    v_mfma_f32_32x32x8_bf16 v[32:47], v[84:85], v[12:13], v[32:47]
    v_cvt_pk_bf16_f32 v50, v20, v21
    v_cvt_pk_bf16_f32 v51, v22, v23
    v_exp_f32 v24, v24
    v_exp_f32 v25, v25
    v_exp_f32 v26, v26
    v_exp_f32 v27, v27
    v_mfma_f32_32x32x16_bf16 v[56:71], v[88:91], v[48:51], v[56:71]
    s_waitcnt lgkmcnt(0)
    v_exp_f32 v28, v28
    v_exp_f32 v29, v29
    v_exp_f32 v30, v30
    v_exp_f32 v31, v31
    v_cvt_pk_bf16_f32 v52, v24, v25
    v_cvt_pk_bf16_f32 v53, v26, v27
    v_cvt_pk_bf16_f32 v54, v28, v29
    v_cvt_pk_bf16_f32 v55, v30, v31
    v_mfma_f32_32x32x16_bf16 v[16:31], v[72:75], v[8:11], 0
    buffer_load_dwordx4 v[140:143], v7, s[8:11], s42 offen offset:2048
    buffer_load_dwordx4 v[144:147], v7, s[8:11], s42 offen offset:3072
    s_add_u32 s42, s42, 0x1000
    ds_read_b128 v[80:83], v1 offset:7104
    ds_read_b32 v84, v2 offset:9344
    v_exp_f32 v32, v32
    v_exp_f32 v33, v33
    v_exp_f32 v34, v34
    v_exp_f32 v35, v35
    v_mfma_f32_32x32x16_bf16 v[56:71], v[92:95], v[52:55], v[56:71]
    ds_read_b128 v[88:91], v3 offset:5760
    ds_read_b128 v[92:95], v3 offset:6368
    v_exp_f32 v36, v36
    v_exp_f32 v37, v37
    v_exp_f32 v38, v38
    v_exp_f32 v39, v39
    v_cvt_pk_bf16_f32 v48, v32, v33
    v_cvt_pk_bf16_f32 v49, v34, v35
    v_mfma_f32_32x32x8_bf16 v[16:31], v[76:77], v[12:13], v[16:31]
    v_cvt_pk_bf16_f32 v50, v36, v37
    v_cvt_pk_bf16_f32 v51, v38, v39
    v_exp_f32 v40, v40
    v_exp_f32 v41, v41
    v_exp_f32 v42, v42
    v_exp_f32 v43, v43
    v_mfma_f32_32x32x16_bf16 v[56:71], v[96:99], v[48:51], v[56:71]
    s_waitcnt lgkmcnt(0)
    v_exp_f32 v44, v44
    v_exp_f32 v45, v45
    v_exp_f32 v46, v46
    v_exp_f32 v47, v47
    v_cvt_pk_bf16_f32 v52, v40, v41
    v_cvt_pk_bf16_f32 v53, v42, v43
    v_cvt_pk_bf16_f32 v54, v44, v45
    v_cvt_pk_bf16_f32 v55, v46, v47
    v_mfma_f32_32x32x16_bf16 v[32:47], v[80:83], v[8:11], 0
    buffer_load_dwordx4 v[148:151], v7, s[8:11], s42 offen offset:0
    buffer_load_dwordx4 v[152:155], v7, s[8:11], s42 offen offset:1024
    ds_read_b128 v[72:75], v1 offset:9472
    ds_read_b32 v76, v2 offset:11712
    v_exp_f32 v16, v16
    v_exp_f32 v17, v17
    v_exp_f32 v18, v18
    v_exp_f32 v19, v19
    v_mfma_f32_32x32x16_bf16 v[56:71], v[100:103], v[52:55], v[56:71]
    ds_read_b128 v[96:99], v3 offset:8128
    ds_read_b128 v[100:103], v3 offset:8736
    v_exp_f32 v20, v20
    v_exp_f32 v21, v21
    v_exp_f32 v22, v22
    v_exp_f32 v23, v23
    v_cvt_pk_bf16_f32 v48, v16, v17
    v_cvt_pk_bf16_f32 v49, v18, v19
    v_mfma_f32_32x32x8_bf16 v[32:47], v[84:85], v[12:13], v[32:47]
    v_cvt_pk_bf16_f32 v50, v20, v21
    v_cvt_pk_bf16_f32 v51, v22, v23
    v_exp_f32 v24, v24
    v_exp_f32 v25, v25
    v_exp_f32 v26, v26
    v_exp_f32 v27, v27
    v_mfma_f32_32x32x16_bf16 v[56:71], v[88:91], v[48:51], v[56:71]
    s_waitcnt lgkmcnt(0)
    v_exp_f32 v28, v28
    v_exp_f32 v29, v29
    v_exp_f32 v30, v30
    v_exp_f32 v31, v31
    v_cvt_pk_bf16_f32 v52, v24, v25
    v_cvt_pk_bf16_f32 v53, v26, v27
    v_cvt_pk_bf16_f32 v54, v28, v29
    v_cvt_pk_bf16_f32 v55, v30, v31
    v_mfma_f32_32x32x16_bf16 v[16:31], v[72:75], v[8:11], 0
    buffer_load_dwordx4 v[156:159], v7, s[8:11], s42 offen offset:2048
    buffer_load_dwordx4 v[160:163], v7, s[8:11], s42 offen offset:3072
    s_add_u32 s42, s42, 0x1000
    ds_read_b128 v[80:83], v1 offset:11840
    ds_read_b32 v84, v2 offset:14080
    v_exp_f32 v32, v32
    v_exp_f32 v33, v33
    v_exp_f32 v34, v34
    v_exp_f32 v35, v35
    v_mfma_f32_32x32x16_bf16 v[56:71], v[92:95], v[52:55], v[56:71]
    ds_read_b128 v[88:91], v3 offset:10496
    ds_read_b128 v[92:95], v3 offset:11104
    v_exp_f32 v36, v36
    v_exp_f32 v37, v37
    v_exp_f32 v38, v38
    v_exp_f32 v39, v39
    v_cvt_pk_bf16_f32 v48, v32, v33
    v_cvt_pk_bf16_f32 v49, v34, v35
    v_mfma_f32_32x32x8_bf16 v[16:31], v[76:77], v[12:13], v[16:31]
    v_cvt_pk_bf16_f32 v50, v36, v37
    v_cvt_pk_bf16_f32 v51, v38, v39
    v_exp_f32 v40, v40
    v_exp_f32 v41, v41
    v_exp_f32 v42, v42
    v_exp_f32 v43, v43
    v_mfma_f32_32x32x16_bf16 v[56:71], v[96:99], v[48:51], v[56:71]
    s_waitcnt lgkmcnt(0)
    v_exp_f32 v44, v44
    v_exp_f32 v45, v45
    v_exp_f32 v46, v46
    v_exp_f32 v47, v47
    v_cvt_pk_bf16_f32 v52, v40, v41
    v_cvt_pk_bf16_f32 v53, v42, v43
    v_cvt_pk_bf16_f32 v54, v44, v45
    v_cvt_pk_bf16_f32 v55, v46, v47
    v_mfma_f32_32x32x16_bf16 v[32:47], v[80:83], v[8:11], 0
    buffer_load_dwordx4 v[164:167], v7, s[8:11], s42 offen offset:0
    buffer_load_dwordx4 v[168:171], v7, s[8:11], s42 offen offset:1024
    ds_read_b128 v[72:75], v1 offset:14208
    ds_read_b32 v76, v2 offset:16448
    v_exp_f32 v16, v16
    v_exp_f32 v17, v17
    v_exp_f32 v18, v18
    v_exp_f32 v19, v19
    v_mfma_f32_32x32x16_bf16 v[56:71], v[100:103], v[52:55], v[56:71]
    ds_read_b128 v[96:99], v3 offset:12864
    ds_read_b128 v[100:103], v3 offset:13472
    v_exp_f32 v20, v20
    v_exp_f32 v21, v21
    v_exp_f32 v22, v22
    v_exp_f32 v23, v23
    v_cvt_pk_bf16_f32 v48, v16, v17
    v_cvt_pk_bf16_f32 v49, v18, v19
    v_mfma_f32_32x32x8_bf16 v[32:47], v[84:85], v[12:13], v[32:47]
    v_cvt_pk_bf16_f32 v50, v20, v21
    v_cvt_pk_bf16_f32 v51, v22, v23
    v_exp_f32 v24, v24
    v_exp_f32 v25, v25
    v_exp_f32 v26, v26
    v_exp_f32 v27, v27
    v_mfma_f32_32x32x16_bf16 v[56:71], v[88:91], v[48:51], v[56:71]
    s_waitcnt lgkmcnt(0)
    v_exp_f32 v28, v28
    v_exp_f32 v29, v29
    v_exp_f32 v30, v30
    v_exp_f32 v31, v31
    v_cvt_pk_bf16_f32 v52, v24, v25
    v_cvt_pk_bf16_f32 v53, v26, v27
    v_cvt_pk_bf16_f32 v54, v28, v29
    v_cvt_pk_bf16_f32 v55, v30, v31
    v_mfma_f32_32x32x16_bf16 v[16:31], v[72:75], v[8:11], 0
    buffer_load_dwordx4 v[172:175], v7, s[8:11], s42 offen offset:2048
    buffer_load_dwordx4 v[176:179], v7, s[8:11], s42 offen offset:3072
    s_add_u32 s42, s42, 0x1000
    ds_read_b128 v[80:83], v1 offset:16576
    ds_read_b32 v84, v2 offset:18816
    v_exp_f32 v32, v32
    v_exp_f32 v33, v33
    v_exp_f32 v34, v34
    v_exp_f32 v35, v35
    v_mfma_f32_32x32x16_bf16 v[56:71], v[92:95], v[52:55], v[56:71]
    ds_read_b128 v[88:91], v3 offset:15232
    ds_read_b128 v[92:95], v3 offset:15840
    v_exp_f32 v36, v36
    v_exp_f32 v37, v37
    v_exp_f32 v38, v38
    v_exp_f32 v39, v39
    v_cvt_pk_bf16_f32 v48, v32, v33
    v_cvt_pk_bf16_f32 v49, v34, v35
    v_mfma_f32_32x32x8_bf16 v[16:31], v[76:77], v[12:13], v[16:31]
    v_cvt_pk_bf16_f32 v50, v36, v37
    v_cvt_pk_bf16_f32 v51, v38, v39
    v_exp_f32 v40, v40
    v_exp_f32 v41, v41
    v_exp_f32 v42, v42
    v_exp_f32 v43, v43
    v_mfma_f32_32x32x16_bf16 v[56:71], v[96:99], v[48:51], v[56:71]
    s_waitcnt lgkmcnt(0)
    v_exp_f32 v44, v44
    v_exp_f32 v45, v45
    v_exp_f32 v46, v46
    v_exp_f32 v47, v47
    v_cvt_pk_bf16_f32 v52, v40, v41
    v_cvt_pk_bf16_f32 v53, v42, v43
    v_cvt_pk_bf16_f32 v54, v44, v45
    v_cvt_pk_bf16_f32 v55, v46, v47
    v_mfma_f32_32x32x16_bf16 v[32:47], v[80:83], v[8:11], 0
    s_waitcnt vmcnt(16)
    ds_write_b128 v5, v[248:251]
    ds_read_b64_tr_b16 v[112:113], v6
    ds_read_b64_tr_b16 v[116:117], v6 offset:8
    ds_write_b128 v5, v[252:255]
    ds_read_b64_tr_b16 v[114:115], v6
    ds_read_b64_tr_b16 v[118:119], v6 offset:8
    buffer_load_dwordx4 v[180:183], v7, s[8:11], s42 offen offset:0
    buffer_load_dwordx4 v[184:187], v7, s[8:11], s42 offen offset:1024
    ds_read_b128 v[72:75], v1 offset:18944
    ds_read_b32 v76, v2 offset:21184
    v_exp_f32 v16, v16
    v_exp_f32 v17, v17
    v_exp_f32 v18, v18
    v_exp_f32 v19, v19
    v_mfma_f32_32x32x16_bf16 v[56:71], v[100:103], v[52:55], v[56:71]
    ds_read_b128 v[96:99], v3 offset:17600
    ds_read_b128 v[100:103], v3 offset:18208
    v_exp_f32 v20, v20
    v_exp_f32 v21, v21
    v_exp_f32 v22, v22
    v_exp_f32 v23, v23
    v_cvt_pk_bf16_f32 v48, v16, v17
    v_cvt_pk_bf16_f32 v49, v18, v19
    v_mfma_f32_32x32x8_bf16 v[32:47], v[84:85], v[12:13], v[32:47]
    v_cvt_pk_bf16_f32 v50, v20, v21
    v_cvt_pk_bf16_f32 v51, v22, v23
    v_exp_f32 v24, v24
    v_exp_f32 v25, v25
    v_exp_f32 v26, v26
    v_exp_f32 v27, v27
    v_mfma_f32_32x32x16_bf16 v[56:71], v[88:91], v[48:51], v[56:71]
    s_waitcnt lgkmcnt(0)
    v_exp_f32 v28, v28
    v_exp_f32 v29, v29
    v_exp_f32 v30, v30
    v_exp_f32 v31, v31
    v_cvt_pk_bf16_f32 v52, v24, v25
    v_cvt_pk_bf16_f32 v53, v26, v27
    v_cvt_pk_bf16_f32 v54, v28, v29
    v_cvt_pk_bf16_f32 v55, v30, v31
    v_mfma_f32_32x32x16_bf16 v[16:31], v[72:75], v[8:11], 0
    buffer_store_dwordx4 v[112:115], v130, s[20:23], s53 offen sc1
    buffer_store_dwordx4 v[116:119], v131, s[20:23], s53 offen sc1
    s_add_u32 s53, s53, 256
    buffer_load_dwordx4 v[248:251], v14, s[16:19], s52 offen
    s_add_u32 s52, s52, s36
    buffer_load_dwordx4 v[252:255], v14, s[16:19], s52 offen
    s_add_u32 s52, s52, s36
    buffer_load_dwordx4 v[188:191], v7, s[8:11], s42 offen offset:2048
    buffer_load_dwordx4 v[192:195], v7, s[8:11], s42 offen offset:3072
    s_add_u32 s42, s42, 0x1000
    ds_read_b128 v[80:83], v1 offset:21312
    ds_read_b32 v84, v2 offset:23552
    v_exp_f32 v32, v32
    v_exp_f32 v33, v33
    v_exp_f32 v34, v34
    v_exp_f32 v35, v35
    v_mfma_f32_32x32x16_bf16 v[56:71], v[92:95], v[52:55], v[56:71]
    ds_read_b128 v[88:91], v3 offset:19968
    ds_read_b128 v[92:95], v3 offset:20576
    v_exp_f32 v36, v36
    v_exp_f32 v37, v37
    v_exp_f32 v38, v38
    v_exp_f32 v39, v39
    v_cvt_pk_bf16_f32 v48, v32, v33
    v_cvt_pk_bf16_f32 v49, v34, v35
    v_mfma_f32_32x32x8_bf16 v[16:31], v[76:77], v[12:13], v[16:31]
    v_cvt_pk_bf16_f32 v50, v36, v37
    v_cvt_pk_bf16_f32 v51, v38, v39
    v_exp_f32 v40, v40
    v_exp_f32 v41, v41
    v_exp_f32 v42, v42
    v_exp_f32 v43, v43
    v_mfma_f32_32x32x16_bf16 v[56:71], v[96:99], v[48:51], v[56:71]
    s_waitcnt lgkmcnt(0)
    v_exp_f32 v44, v44
    v_exp_f32 v45, v45
    v_exp_f32 v46, v46
    v_exp_f32 v47, v47
    v_cvt_pk_bf16_f32 v52, v40, v41
    v_cvt_pk_bf16_f32 v53, v42, v43
    v_cvt_pk_bf16_f32 v54, v44, v45
    v_cvt_pk_bf16_f32 v55, v46, v47
    v_mfma_f32_32x32x16_bf16 v[32:47], v[80:83], v[8:11], 0
    buffer_load_dwordx4 v[196:199], v7, s[8:11], s42 offen offset:0
    buffer_load_dwordx4 v[200:203], v7, s[8:11], s42 offen offset:1024
    ds_read_b128 v[72:75], v1 offset:23680
    ds_read_b32 v76, v2 offset:25920
    v_exp_f32 v16, v16
    v_exp_f32 v17, v17
    v_exp_f32 v18, v18
    v_exp_f32 v19, v19
    v_mfma_f32_32x32x16_bf16 v[56:71], v[100:103], v[52:55], v[56:71]
    ds_read_b128 v[96:99], v3 offset:22336
    ds_read_b128 v[100:103], v3 offset:22944
    v_exp_f32 v20, v20
    v_exp_f32 v21, v21
    v_exp_f32 v22, v22
    v_exp_f32 v23, v23
    v_cvt_pk_bf16_f32 v48, v16, v17
    v_cvt_pk_bf16_f32 v49, v18, v19
    v_mfma_f32_32x32x8_bf16 v[32:47], v[84:85], v[12:13], v[32:47]
    v_cvt_pk_bf16_f32 v50, v20, v21
    v_cvt_pk_bf16_f32 v51, v22, v23
    v_exp_f32 v24, v24
    v_exp_f32 v25, v25
    v_exp_f32 v26, v26
    v_exp_f32 v27, v27
    v_mfma_f32_32x32x16_bf16 v[56:71], v[88:91], v[48:51], v[56:71]
    s_waitcnt lgkmcnt(0)
    v_exp_f32 v28, v28
    v_exp_f32 v29, v29
    v_exp_f32 v30, v30
    v_exp_f32 v31, v31
    v_cvt_pk_bf16_f32 v52, v24, v25
    v_cvt_pk_bf16_f32 v53, v26, v27
    v_cvt_pk_bf16_f32 v54, v28, v29
    v_cvt_pk_bf16_f32 v55, v30, v31
    v_mfma_f32_32x32x16_bf16 v[16:31], v[72:75], v[8:11], 0
    buffer_load_dwordx4 v[204:207], v7, s[8:11], s42 offen offset:2048
    buffer_load_dwordx4 v[208:211], v7, s[8:11], s42 offen offset:3072
    s_add_u32 s42, s42, 0x1000
    ds_read_b128 v[80:83], v1 offset:26048
    ds_read_b32 v84, v2 offset:28288
    v_exp_f32 v32, v32
    v_exp_f32 v33, v33
    v_exp_f32 v34, v34
    v_exp_f32 v35, v35
    v_mfma_f32_32x32x16_bf16 v[56:71], v[92:95], v[52:55], v[56:71]
    ds_read_b128 v[88:91], v3 offset:24704
    ds_read_b128 v[92:95], v3 offset:25312
    v_exp_f32 v36, v36
    v_exp_f32 v37, v37
    v_exp_f32 v38, v38
    v_exp_f32 v39, v39
    v_cvt_pk_bf16_f32 v48, v32, v33
    v_cvt_pk_bf16_f32 v49, v34, v35
    v_mfma_f32_32x32x8_bf16 v[16:31], v[76:77], v[12:13], v[16:31]
    v_cvt_pk_bf16_f32 v50, v36, v37
    v_cvt_pk_bf16_f32 v51, v38, v39
    v_exp_f32 v40, v40
    v_exp_f32 v41, v41
    v_exp_f32 v42, v42
    v_exp_f32 v43, v43
    v_mfma_f32_32x32x16_bf16 v[56:71], v[96:99], v[48:51], v[56:71]
    s_waitcnt lgkmcnt(0)
    v_exp_f32 v44, v44
    v_exp_f32 v45, v45
    v_exp_f32 v46, v46
    v_exp_f32 v47, v47
    v_cvt_pk_bf16_f32 v52, v40, v41
    v_cvt_pk_bf16_f32 v53, v42, v43
    v_cvt_pk_bf16_f32 v54, v44, v45
    v_cvt_pk_bf16_f32 v55, v46, v47
    v_mfma_f32_32x32x16_bf16 v[32:47], v[80:83], v[8:11], 0
    buffer_load_dwordx4 v[212:215], v7, s[8:11], s42 offen offset:0
    buffer_load_dwordx4 v[216:219], v7, s[8:11], s42 offen offset:1024
    ds_read_b128 v[72:75], v1 offset:28416
    ds_read_b32 v76, v2 offset:30656
    v_exp_f32 v16, v16
    v_exp_f32 v17, v17
    v_exp_f32 v18, v18
    v_exp_f32 v19, v19
    v_mfma_f32_32x32x16_bf16 v[56:71], v[100:103], v[52:55], v[56:71]
    ds_read_b128 v[96:99], v3 offset:27072
    ds_read_b128 v[100:103], v3 offset:27680
    v_exp_f32 v20, v20
    v_exp_f32 v21, v21
    v_exp_f32 v22, v22
    v_exp_f32 v23, v23
    v_cvt_pk_bf16_f32 v48, v16, v17
    v_cvt_pk_bf16_f32 v49, v18, v19
    v_mfma_f32_32x32x8_bf16 v[32:47], v[84:85], v[12:13], v[32:47]
    v_cvt_pk_bf16_f32 v50, v20, v21
    v_cvt_pk_bf16_f32 v51, v22, v23
    v_exp_f32 v24, v24
    v_exp_f32 v25, v25
    v_exp_f32 v26, v26
    v_exp_f32 v27, v27
    v_mfma_f32_32x32x16_bf16 v[56:71], v[88:91], v[48:51], v[56:71]
    s_waitcnt lgkmcnt(0)
    v_exp_f32 v28, v28
    v_exp_f32 v29, v29
    v_exp_f32 v30, v30
    v_exp_f32 v31, v31
    v_cvt_pk_bf16_f32 v52, v24, v25
    v_cvt_pk_bf16_f32 v53, v26, v27
    v_cvt_pk_bf16_f32 v54, v28, v29
    v_cvt_pk_bf16_f32 v55, v30, v31
    v_mfma_f32_32x32x16_bf16 v[16:31], v[72:75], v[8:11], 0
    buffer_load_dwordx4 v[220:223], v7, s[8:11], s42 offen offset:2048
    buffer_load_dwordx4 v[224:227], v7, s[8:11], s42 offen offset:3072
    s_add_u32 s42, s42, 0x1000
    ds_read_b128 v[80:83], v1 offset:30784
    ds_read_b32 v84, v2 offset:33024
    v_exp_f32 v32, v32
    v_exp_f32 v33, v33
    v_exp_f32 v34, v34
    v_exp_f32 v35, v35
    v_mfma_f32_32x32x16_bf16 v[56:71], v[92:95], v[52:55], v[56:71]
    ds_read_b128 v[88:91], v3 offset:29440
    ds_read_b128 v[92:95], v3 offset:30048
    v_exp_f32 v36, v36
    v_exp_f32 v37, v37
    v_exp_f32 v38, v38
    v_exp_f32 v39, v39
    v_cvt_pk_bf16_f32 v48, v32, v33
    v_cvt_pk_bf16_f32 v49, v34, v35
    v_mfma_f32_32x32x8_bf16 v[16:31], v[76:77], v[12:13], v[16:31]
    v_cvt_pk_bf16_f32 v50, v36, v37
    v_cvt_pk_bf16_f32 v51, v38, v39
    v_exp_f32 v40, v40
    v_exp_f32 v41, v41
    v_exp_f32 v42, v42
    v_exp_f32 v43, v43
    v_mfma_f32_32x32x16_bf16 v[56:71], v[96:99], v[48:51], v[56:71]
    s_waitcnt lgkmcnt(0)
    v_exp_f32 v44, v44
    v_exp_f32 v45, v45
    v_exp_f32 v46, v46
    v_exp_f32 v47, v47
    v_cvt_pk_bf16_f32 v52, v40, v41
    v_cvt_pk_bf16_f32 v53, v42, v43
    v_cvt_pk_bf16_f32 v54, v44, v45
    v_cvt_pk_bf16_f32 v55, v46, v47
    v_mfma_f32_32x32x16_bf16 v[32:47], v[80:83], v[8:11], 0
    buffer_load_dwordx4 v[228:231], v7, s[8:11], s42 offen offset:0
    buffer_load_dwordx4 v[232:235], v7, s[8:11], s42 offen offset:1024
    ds_read_b128 v[72:75], v1 offset:33152
    ds_read_b32 v76, v2 offset:35392
    v_exp_f32 v16, v16
    v_exp_f32 v17, v17
    v_exp_f32 v18, v18
    v_exp_f32 v19, v19
    v_mfma_f32_32x32x16_bf16 v[56:71], v[100:103], v[52:55], v[56:71]
    ds_read_b128 v[96:99], v3 offset:31808
    ds_read_b128 v[100:103], v3 offset:32416
    v_exp_f32 v20, v20
    v_exp_f32 v21, v21
    v_exp_f32 v22, v22
    v_exp_f32 v23, v23
    v_cvt_pk_bf16_f32 v48, v16, v17
    v_cvt_pk_bf16_f32 v49, v18, v19
    v_mfma_f32_32x32x8_bf16 v[32:47], v[84:85], v[12:13], v[32:47]
    v_cvt_pk_bf16_f32 v50, v20, v21
    v_cvt_pk_bf16_f32 v51, v22, v23
    v_exp_f32 v24, v24
    v_exp_f32 v25, v25
    v_exp_f32 v26, v26
    v_exp_f32 v27, v27
    v_mfma_f32_32x32x16_bf16 v[56:71], v[88:91], v[48:51], v[56:71]
    s_waitcnt lgkmcnt(0)
    v_exp_f32 v28, v28
    v_exp_f32 v29, v29
    v_exp_f32 v30, v30
    v_exp_f32 v31, v31
    v_cvt_pk_bf16_f32 v52, v24, v25
    v_cvt_pk_bf16_f32 v53, v26, v27
    v_cvt_pk_bf16_f32 v54, v28, v29
    v_cvt_pk_bf16_f32 v55, v30, v31
    v_mfma_f32_32x32x16_bf16 v[16:31], v[72:75], v[8:11], 0
    buffer_load_dwordx4 v[236:239], v7, s[8:11], s42 offen offset:2048
    buffer_load_dwordx4 v[240:243], v7, s[8:11], s42 offen offset:3072
    s_add_u32 s42, s42, 0x1000
    ds_read_b128 v[80:83], v1 offset:35520
    ds_read_b32 v84, v2 offset:37760
    v_exp_f32 v32, v32
    v_exp_f32 v33, v33
    v_exp_f32 v34, v34
    v_exp_f32 v35, v35
    v_mfma_f32_32x32x16_bf16 v[56:71], v[92:95], v[52:55], v[56:71]
    ds_read_b128 v[88:91], v3 offset:34176
    ds_read_b128 v[92:95], v3 offset:34784
    v_exp_f32 v36, v36
    v_exp_f32 v37, v37
    v_exp_f32 v38, v38
    v_exp_f32 v39, v39
    v_cvt_pk_bf16_f32 v48, v32, v33
    v_cvt_pk_bf16_f32 v49, v34, v35
    v_mfma_f32_32x32x8_bf16 v[16:31], v[76:77], v[12:13], v[16:31]
    v_cvt_pk_bf16_f32 v50, v36, v37
    v_cvt_pk_bf16_f32 v51, v38, v39
    v_exp_f32 v40, v40
    v_exp_f32 v41, v41
    v_exp_f32 v42, v42
    v_exp_f32 v43, v43
    v_mfma_f32_32x32x16_bf16 v[56:71], v[96:99], v[48:51], v[56:71]
    s_waitcnt lgkmcnt(0)
    v_exp_f32 v44, v44
    v_exp_f32 v45, v45
    v_exp_f32 v46, v46
    v_exp_f32 v47, v47
    v_cvt_pk_bf16_f32 v52, v40, v41
    v_cvt_pk_bf16_f32 v53, v42, v43
    v_cvt_pk_bf16_f32 v54, v44, v45
    v_cvt_pk_bf16_f32 v55, v46, v47
    v_mfma_f32_32x32x16_bf16 v[32:47], v[80:83], v[8:11], 0
    s_waitcnt vmcnt(32)
    ds_write_b128 v5, v[104:107]
    ds_read_b64_tr_b16 v[112:113], v6
    ds_read_b64_tr_b16 v[116:117], v6 offset:8
    ds_write_b128 v5, v[108:111]
    ds_read_b64_tr_b16 v[114:115], v6
    ds_read_b64_tr_b16 v[118:119], v6 offset:8
    buffer_load_dwordx4 v[244:247], v7, s[8:11], s42 offen offset:0
    ds_read_b128 v[72:75], v1 offset:37888
    ds_read_b32 v76, v2 offset:40128
    v_exp_f32 v16, v16
    v_exp_f32 v17, v17
    v_exp_f32 v18, v18
    v_exp_f32 v19, v19
    v_mfma_f32_32x32x16_bf16 v[56:71], v[100:103], v[52:55], v[56:71]
    ds_read_b128 v[96:99], v3 offset:36544
    ds_read_b128 v[100:103], v3 offset:37152
    v_exp_f32 v20, v20
    v_exp_f32 v21, v21
    v_exp_f32 v22, v22
    v_exp_f32 v23, v23
    v_cvt_pk_bf16_f32 v48, v16, v17
    v_cvt_pk_bf16_f32 v49, v18, v19
    v_mfma_f32_32x32x8_bf16 v[32:47], v[84:85], v[12:13], v[32:47]
    v_cvt_pk_bf16_f32 v50, v20, v21
    v_cvt_pk_bf16_f32 v51, v22, v23
    v_exp_f32 v24, v24
    v_exp_f32 v25, v25
    v_exp_f32 v26, v26
    v_exp_f32 v27, v27
    v_mfma_f32_32x32x16_bf16 v[56:71], v[88:91], v[48:51], v[56:71]
    s_waitcnt lgkmcnt(0)
    v_exp_f32 v28, v28
    v_exp_f32 v29, v29
    v_exp_f32 v30, v30
    v_exp_f32 v31, v31
    v_cvt_pk_bf16_f32 v52, v24, v25
    v_cvt_pk_bf16_f32 v53, v26, v27
    v_cvt_pk_bf16_f32 v54, v28, v29
    v_cvt_pk_bf16_f32 v55, v30, v31
    v_mfma_f32_32x32x16_bf16 v[16:31], v[72:75], v[8:11], 0
    buffer_store_dwordx4 v[112:115], v120, s[20:23], s37 offen sc1
    buffer_store_dwordx4 v[116:119], v129, s[20:23], s37 offen sc1
    s_add_u32 s37, s37, 256
    ds_read_b128 v[80:83], v1 offset:40256
    ds_read_b32 v84, v2 offset:42496
    v_exp_f32 v32, v32
    v_exp_f32 v33, v33
    v_exp_f32 v34, v34
    v_exp_f32 v35, v35
    v_mfma_f32_32x32x16_bf16 v[56:71], v[92:95], v[52:55], v[56:71]
    ds_read_b128 v[88:91], v3 offset:38912
    ds_read_b128 v[92:95], v3 offset:39520
    v_exp_f32 v36, v36
    v_exp_f32 v37, v37
    v_exp_f32 v38, v38
    v_exp_f32 v39, v39
    v_cvt_pk_bf16_f32 v48, v32, v33
    v_cvt_pk_bf16_f32 v49, v34, v35
    v_mfma_f32_32x32x8_bf16 v[16:31], v[76:77], v[12:13], v[16:31]
    v_cvt_pk_bf16_f32 v50, v36, v37
    v_cvt_pk_bf16_f32 v51, v38, v39
    v_exp_f32 v40, v40
    v_exp_f32 v41, v41
    v_exp_f32 v42, v42
    v_exp_f32 v43, v43
    v_mfma_f32_32x32x16_bf16 v[56:71], v[96:99], v[48:51], v[56:71]
    s_waitcnt lgkmcnt(0)
    v_exp_f32 v44, v44
    v_exp_f32 v45, v45
    v_exp_f32 v46, v46
    v_exp_f32 v47, v47
    v_cvt_pk_bf16_f32 v52, v40, v41
    v_cvt_pk_bf16_f32 v53, v42, v43
    v_cvt_pk_bf16_f32 v54, v44, v45
    v_cvt_pk_bf16_f32 v55, v46, v47
    v_add_u32 v1, 37888, v1
    v_add_u32 v2, 37888, v2
    v_add_u32 v3, 37888, v3
    s_waitcnt vmcnt(17)
    ds_write_b128 v5, v[248:251]
    ds_read_b64_tr_b16 v[112:113], v6
    ds_read_b64_tr_b16 v[116:117], v6 offset:8
    ds_write_b128 v5, v[252:255]
    ds_read_b64_tr_b16 v[114:115], v6
    ds_read_b64_tr_b16 v[118:119], v6 offset:8
    s_waitcnt lgkmcnt(0)
    buffer_store_dwordx4 v[112:115], v130, s[20:23], s53 offen sc1
    buffer_store_dwordx4 v[116:119], v131, s[20:23], s53 offen sc1
    s_add_u32 s53, s53, 256
K3_done:
    v_mfma_f32_32x32x16_bf16 v[56:71], v[100:103], v[52:55], v[56:71]
    s_nop 0
    v_and_b32 v1, 7, v0
    v_mul_u32_u24 v1, 1168, v1
    v_lshrrev_b32 v2, 3, v123
    s_lshr_b32 s33, s3, 2
    s_mul_i32 s33, s33, 576
    s_and_b32 s34, s3, 3
    s_lshl_b32 s35, s34, 7
    s_add_u32 s35, s35, s33
    v_lshl_add_u32 v16, v2, 5, v1
    v_lshl_add_u32 v16, v122, 4, v16
    v_add_u32 v16, s35, v16
    s_lshl_b32 s35, s34, 4
    s_add_u32 s35, s35, s33
    v_lshl_add_u32 v17, v2, 2, v1
    v_mul_u32_u24 v3, 0x30000, v122
    v_add3_u32 v17, v17, v3, s35
    v_and_b32 v2, 15, v0
    v_lshrrev_b32 v3, 4, v0
    v_lshl_add_u32 v1, v3, 4, v1
    v_mov_b32 v18, v66
    v_mov_b32 v19, v66
    v_mul_f32 v20, 0, v56
    v_fmac_f32 v20, 0, v57
    v_fmac_f32 v20, 0, v58
    v_fmac_f32 v20, 0, v59
    v_fmac_f32 v20, 0, v60
    v_fmac_f32 v20, 0, v61
    v_fmac_f32 v20, 0, v62
    v_fmac_f32 v20, 0, v63
    v_fmac_f32 v20, 0, v64
    v_fmac_f32 v20, 0, v65
    v_permlane32_swap_b32 v18, v19
    v_add_f32 v20, v20, v18
    v_rcp_f32 v18, v18
    v_cmp_nlt_f32 vcc, v20, v128
    s_cbranch_vccz K3_fin
    v_mov_b32 v19, 1
    ds_write_b32 v121, v19 offset:32
K3_fin:
    v_mul_f32 v56, v18, v56
    v_mul_f32 v57, v18, v57
    v_mul_f32 v58, v18, v58
    v_mul_f32 v59, v18, v59
    v_mul_f32 v60, v18, v60
    v_mul_f32 v61, v18, v61
    v_mul_f32 v62, v18, v62
    v_mul_f32 v63, v18, v63
    v_mul_f32 v64, v18, v64
    v_mul_f32 v65, v18, v65
    v_cvt_pk_bf16_f32 v24, v56, v57
    v_cvt_pk_bf16_f32 v25, v58, v59
    v_cvt_pk_bf16_f32 v26, v60, v61
    v_cvt_pk_bf16_f32 v27, v62, v63
    v_cvt_pk_bf16_f32 v28, v64, v65
    ds_write_b128 v16, v[24:27] offset:0
    ds_write_b32 v17, v28 offset:512
    v_mov_b32 v4, 159744
    v_mul_u32_u24 v5, 2320, v2
    v_mul_u32_u24 v6, 576, v3
    v_add_u32 v5, v5, v6
    v_lshrrev_b32 v6, 3, v2
    v_mul_u32_u24 v6, 0x28000, v6
    v_add_u32 v5, v5, v6
    s_mul_i32 s33, s3, 96
    s_mul_i32 s34, s3, 48
    s_add_u32 s34, s34, 192
    s_cmp_ge_u32 s3, 4
    s_cselect_b32 s33, s34, s33
    s_add_u32 s33, s33, 37888
    v_add_u32 v6, s33, v5
    v_lshlrev_b32 v2, 5, v0
    v_cmp_gt_u32 vcc, 36, v0
    v_mov_b32 v3, 0x3fff0000
    s_mul_i32 s6, s4, 1152
    v_cndmask_b32 v2, v3, v2, vcc
    s_mov_b64 s[46:47], vcc
    s_cmp_ge_u32 s3, 4
    s_cbranch_scc1 K3_join
    v_mov_b32 v3, 1
    s_mov_b64 exec, 1
    ds_add_u32 v4, v3
    s_mov_b64 exec, -1
    s_mul_i32 s33, s3, 144
    s_add_u32 s33, s33, 17536
    v_add_u32 v5, s33, v5
    buffer_load_dword v12, v2, s[48:51], s6 offen
    buffer_load_dwordx4 v[248:251], v7, s[8:11], s42 offen offset:1024
    buffer_load_dwordx4 v[252:255], v7, s[8:11], s42 offen offset:2048
    buffer_load_dwordx4 v[128:131], v7, s[8:11], s42 offen offset:3072
    s_add_u32 s42, s42, 0x1000
    buffer_load_dwordx4 v[40:43], v7, s[8:11], s42 offen offset:0
    buffer_load_dwordx4 v[44:47], v7, s[8:11], s42 offen offset:1024
    buffer_load_dwordx4 v[48:51], v7, s[8:11], s42 offen offset:2048
    buffer_load_dwordx4 v[52:55], v7, s[8:11], s42 offen offset:3072
    s_add_u32 s42, s42, 0x1000
    buffer_load_dwordx4 v[56:59], v7, s[8:11], s42 offen offset:0
    buffer_load_dwordx4 v[60:63], v7, s[8:11], s42 offen offset:1024
    buffer_load_dwordx4 v[64:67], v7, s[8:11], s42 offen offset:2048
    buffer_load_dwordx4 v[68:71], v7, s[8:11], s42 offen offset:3072
    s_add_u32 s42, s42, 0x1000
    buffer_load_dwordx4 v[72:75], v7, s[8:11], s42 offen offset:0
    buffer_load_dwordx4 v[76:79], v7, s[8:11], s42 offen offset:1024
    buffer_load_dwordx4 v[80:83], v7, s[8:11], s42 offen offset:2048
    buffer_load_dwordx4 v[84:87], v7, s[8:11], s42 offen offset:3072
    s_add_u32 s42, s42, 0x1000
    buffer_load_dwordx4 v[88:91], v7, s[8:11], s42 offen offset:0
    buffer_load_dwordx4 v[92:95], v7, s[8:11], s42 offen offset:1024
    buffer_load_dwordx4 v[96:99], v7, s[8:11], s42 offen offset:2048
    buffer_load_dwordx4 v[100:103], v7, s[8:11], s42 offen offset:3072
    s_add_u32 s42, s42, 0x1000
    buffer_load_dwordx4 v[104:107], v7, s[8:11], s42 offen offset:0
    buffer_load_dwordx4 v[108:111], v7, s[8:11], s42 offen offset:1024
    buffer_load_dwordx4 v[112:115], v7, s[8:11], s42 offen offset:2048
    buffer_load_dwordx4 v[116:119], v7, s[8:11], s42 offen offset:3072
    s_add_u32 s42, s42, 0x1000
    buffer_load_dwordx4 v[120:123], v7, s[8:11], s42 offen offset:0
    buffer_load_dwordx4 v[124:127], v7, s[8:11], s42 offen offset:1024
K3_poll:
    ds_read_b32 v8, v4
    s_waitcnt lgkmcnt(0)
    v_cmp_gt_u32 vcc, 4, v8
    s_cbranch_vccz K3_pollok
    s_sleep 2
    s_branch K3_poll
K3_pollok:
    ds_read_b128 v[8:11], v1 offset:0
    ds_read_b128 v[24:27], v1 offset:64
    ds_read_b128 v[28:31], v1 offset:128
    ds_read_b128 v[32:35], v1 offset:192
    ds_read_b128 v[36:39], v1 offset:256
    s_waitcnt vmcnt(25) lgkmcnt(4)
    v_mfma_f32_16x16x32_bf16 v[16:19], v[132:135], v[8:11], 0
    buffer_load_dwordx4 v[132:135], v7, s[8:11], s42 offen offset:2048
    ds_read_b128 v[8:11], v1 offset:320
    s_waitcnt lgkmcnt(4)
    v_mfma_f32_16x16x32_bf16 v[16:19], v[136:139], v[24:27], v[16:19]
    buffer_load_dwordx4 v[136:139], v7, s[8:11], s42 offen offset:3072
    s_add_u32 s42, s42, 0x1000
    ds_read_b128 v[24:27], v1 offset:384
    s_waitcnt lgkmcnt(4)
    v_mfma_f32_16x16x32_bf16 v[16:19], v[140:143], v[28:31], v[16:19]
    buffer_load_dwordx4 v[140:143], v7, s[8:11], s42 offen offset:0
    ds_read_b128 v[28:31], v1 offset:448
    s_waitcnt lgkmcnt(4)
    v_mfma_f32_16x16x32_bf16 v[16:19], v[144:147], v[32:35], v[16:19]
    buffer_load_dwordx4 v[144:147], v7, s[8:11], s42 offen offset:1024
    ds_read_b128 v[32:35], v1 offset:512
    s_waitcnt lgkmcnt(4)
    v_mfma_f32_16x16x32_bf16 v[16:19], v[148:151], v[36:39], v[16:19]
    buffer_load_dwordx4 v[148:151], v7, s[8:11], s42 offen offset:2048
    ds_read_b128 v[36:39], v1 offset:0
    s_waitcnt lgkmcnt(4)
    v_mfma_f32_16x16x32_bf16 v[16:19], v[152:155], v[8:11], v[16:19]
    buffer_load_dwordx4 v[152:155], v7, s[8:11], s42 offen offset:3072
    s_add_u32 s42, s42, 0x1000
    ds_read_b128 v[8:11], v1 offset:64
    s_waitcnt lgkmcnt(4)
    v_mfma_f32_16x16x32_bf16 v[16:19], v[156:159], v[24:27], v[16:19]
    buffer_load_dwordx4 v[156:159], v7, s[8:11], s42 offen offset:0
    ds_read_b128 v[24:27], v1 offset:128
    s_waitcnt lgkmcnt(4)
    v_mfma_f32_16x16x32_bf16 v[16:19], v[160:163], v[28:31], v[16:19]
    buffer_load_dwordx4 v[160:163], v7, s[8:11], s42 offen offset:1024
    ds_read_b128 v[28:31], v1 offset:192
    s_waitcnt lgkmcnt(4)
    v_mfma_f32_16x16x32_bf16 v[16:19], v[164:167], v[32:35], v[16:19]
    buffer_load_dwordx4 v[164:167], v7, s[8:11], s42 offen offset:2048
    ds_read_b128 v[32:35], v1 offset:256
    s_waitcnt lgkmcnt(4)
    v_mfma_f32_16x16x32_bf16 v[20:23], v[168:171], v[36:39], 0
    buffer_load_dwordx4 v[168:171], v7, s[8:11], s42 offen offset:3072
    s_add_u32 s42, s42, 0x1000
    ds_read_b128 v[36:39], v1 offset:320
    s_waitcnt lgkmcnt(4)
    v_mfma_f32_16x16x32_bf16 v[20:23], v[172:175], v[8:11], v[20:23]
    buffer_load_dwordx4 v[172:175], v7, s[8:11], s42 offen offset:0
    ds_read_b128 v[8:11], v1 offset:384
    s_waitcnt lgkmcnt(4)
    v_mfma_f32_16x16x32_bf16 v[20:23], v[176:179], v[24:27], v[20:23]
    buffer_load_dwordx4 v[176:179], v7, s[8:11], s42 offen offset:1024
    ds_read_b128 v[24:27], v1 offset:448
    s_waitcnt lgkmcnt(4)
    v_mfma_f32_16x16x32_bf16 v[20:23], v[180:183], v[28:31], v[20:23]
    buffer_load_dwordx4 v[180:183], v7, s[8:11], s42 offen offset:2048
    ds_read_b128 v[28:31], v1 offset:512
    s_waitcnt lgkmcnt(4)
    v_mfma_f32_16x16x32_bf16 v[20:23], v[184:187], v[32:35], v[20:23]
    buffer_load_dwordx4 v[184:187], v7, s[8:11], s42 offen offset:3072
    s_add_u32 s42, s42, 0x1000
    ds_write_b128 v5, v[16:19] offset:0
    ds_read_b128 v[32:35], v1 offset:0
    s_waitcnt lgkmcnt(5)
    v_mfma_f32_16x16x32_bf16 v[20:23], v[188:191], v[36:39], v[20:23]
    buffer_load_dwordx4 v[188:191], v7, s[8:11], s42 offen offset:0
    ds_read_b128 v[36:39], v1 offset:64
    s_waitcnt lgkmcnt(5)
    v_mfma_f32_16x16x32_bf16 v[20:23], v[192:195], v[8:11], v[20:23]
    buffer_load_dwordx4 v[192:195], v7, s[8:11], s42 offen offset:1024
    ds_read_b128 v[8:11], v1 offset:128
    s_waitcnt lgkmcnt(5)
    v_mfma_f32_16x16x32_bf16 v[20:23], v[196:199], v[24:27], v[20:23]
    buffer_load_dwordx4 v[196:199], v7, s[8:11], s42 offen offset:2048
    ds_read_b128 v[24:27], v1 offset:192
    s_waitcnt lgkmcnt(5)
    v_mfma_f32_16x16x32_bf16 v[20:23], v[200:203], v[28:31], v[20:23]
    buffer_load_dwordx4 v[200:203], v7, s[8:11], s42 offen offset:3072
    s_add_u32 s42, s42, 0x1000
    ds_read_b128 v[28:31], v1 offset:256
    s_waitcnt lgkmcnt(4)
    v_mfma_f32_16x16x32_bf16 v[16:19], v[204:207], v[32:35], 0
    buffer_load_dwordx4 v[204:207], v7, s[8:11], s42 offen offset:0
    ds_read_b128 v[32:35], v1 offset:320
    s_waitcnt lgkmcnt(4)
    v_mfma_f32_16x16x32_bf16 v[16:19], v[208:211], v[36:39], v[16:19]
    buffer_load_dwordx4 v[208:211], v7, s[8:11], s42 offen offset:1024
    ds_read_b128 v[36:39], v1 offset:384
    s_waitcnt lgkmcnt(4)
    v_mfma_f32_16x16x32_bf16 v[16:19], v[212:215], v[8:11], v[16:19]
    buffer_load_dwordx4 v[212:215], v7, s[8:11], s42 offen offset:2048
    ds_read_b128 v[8:11], v1 offset:448
    s_waitcnt lgkmcnt(4)
    v_mfma_f32_16x16x32_bf16 v[16:19], v[216:219], v[24:27], v[16:19]
    buffer_load_dwordx4 v[216:219], v7, s[8:11], s42 offen offset:3072
    s_add_u32 s42, s42, 0x1000
    ds_read_b128 v[24:27], v1 offset:512
    s_waitcnt lgkmcnt(4)
    v_mfma_f32_16x16x32_bf16 v[16:19], v[220:223], v[28:31], v[16:19]
    buffer_load_dwordx4 v[220:223], v7, s[8:11], s42 offen offset:0
    ds_write_b128 v5, v[20:23] offset:16
    ds_read_b128 v[28:31], v1 offset:0
    s_waitcnt lgkmcnt(5)
    v_mfma_f32_16x16x32_bf16 v[16:19], v[224:227], v[32:35], v[16:19]
    buffer_load_dwordx4 v[224:227], v7, s[8:11], s42 offen offset:1024
    ds_read_b128 v[32:35], v1 offset:64
    s_waitcnt lgkmcnt(5)
    v_mfma_f32_16x16x32_bf16 v[16:19], v[228:231], v[36:39], v[16:19]
    buffer_load_dwordx4 v[228:231], v7, s[8:11], s42 offen offset:2048
    ds_read_b128 v[36:39], v1 offset:128
    s_waitcnt lgkmcnt(5)
    v_mfma_f32_16x16x32_bf16 v[16:19], v[232:235], v[8:11], v[16:19]
    buffer_load_dwordx4 v[232:235], v7, s[8:11], s42 offen offset:3072
    s_add_u32 s42, s42, 0x1000
    ds_read_b128 v[8:11], v1 offset:192
    s_waitcnt lgkmcnt(5)
    v_mfma_f32_16x16x32_bf16 v[16:19], v[236:239], v[24:27], v[16:19]
    buffer_load_dwordx4 v[236:239], v7, s[8:11], s42 offen offset:0
    ds_read_b128 v[24:27], v1 offset:256
    s_waitcnt lgkmcnt(4)
    v_mfma_f32_16x16x32_bf16 v[20:23], v[240:243], v[28:31], 0
    buffer_load_dwordx4 v[240:243], v7, s[8:11], s42 offen offset:1024
    ds_read_b128 v[28:31], v1 offset:320
    s_waitcnt lgkmcnt(4)
    v_mfma_f32_16x16x32_bf16 v[20:23], v[244:247], v[32:35], v[20:23]
    buffer_load_dwordx4 v[244:247], v7, s[8:11], s42 offen offset:2048
    ds_read_b128 v[32:35], v1 offset:384
    s_waitcnt vmcnt(53) lgkmcnt(4)
    v_mfma_f32_16x16x32_bf16 v[20:23], v[248:251], v[36:39], v[20:23]
    buffer_load_dwordx4 v[248:251], v7, s[8:11], s42 offen offset:3072
    s_add_u32 s42, s42, 0x1000
    ds_read_b128 v[36:39], v1 offset:448
    s_waitcnt vmcnt(53) lgkmcnt(4)
    v_mfma_f32_16x16x32_bf16 v[20:23], v[252:255], v[8:11], v[20:23]
    buffer_load_dwordx4 v[252:255], v7, s[8:11], s42 offen offset:0
    ds_read_b128 v[8:11], v1 offset:512
    s_waitcnt vmcnt(53) lgkmcnt(4)
    v_mfma_f32_16x16x32_bf16 v[20:23], v[128:131], v[24:27], v[20:23]
    buffer_load_dwordx4 v[128:131], v7, s[8:11], s42 offen offset:1024
    ds_write_b128 v5, v[16:19] offset:32
    ds_read_b128 v[24:27], v1 offset:0
    s_waitcnt vmcnt(53) lgkmcnt(5)
    v_mfma_f32_16x16x32_bf16 v[20:23], v[40:43], v[28:31], v[20:23]
    buffer_load_dwordx4 v[40:43], v7, s[8:11], s42 offen offset:2048
    ds_read_b128 v[28:31], v1 offset:64
    s_waitcnt vmcnt(53) lgkmcnt(5)
    v_mfma_f32_16x16x32_bf16 v[20:23], v[44:47], v[32:35], v[20:23]
    buffer_load_dwordx4 v[44:47], v7, s[8:11], s42 offen offset:3072
    s_add_u32 s42, s42, 0x1000
    ds_read_b128 v[32:35], v1 offset:128
    s_waitcnt vmcnt(53) lgkmcnt(5)
    v_mfma_f32_16x16x32_bf16 v[20:23], v[48:51], v[36:39], v[20:23]
    buffer_load_dwordx4 v[48:51], v7, s[8:11], s42 offen offset:0
    ds_read_b128 v[36:39], v1 offset:192
    s_waitcnt vmcnt(53) lgkmcnt(5)
    v_mfma_f32_16x16x32_bf16 v[20:23], v[52:55], v[8:11], v[20:23]
    buffer_load_dwordx4 v[52:55], v7, s[8:11], s42 offen offset:1024
    ds_read_b128 v[8:11], v1 offset:256
    s_waitcnt vmcnt(53) lgkmcnt(4)
    v_mfma_f32_16x16x32_bf16 v[16:19], v[56:59], v[24:27], 0
    buffer_load_dwordx4 v[56:59], v7, s[8:11], s42 offen offset:2048
    ds_read_b128 v[24:27], v1 offset:320
    s_waitcnt vmcnt(53) lgkmcnt(4)
    v_mfma_f32_16x16x32_bf16 v[16:19], v[60:63], v[28:31], v[16:19]
    buffer_load_dwordx4 v[60:63], v7, s[8:11], s42 offen offset:3072
    s_add_u32 s42, s42, 0x1000
    ds_read_b128 v[28:31], v1 offset:384
    s_waitcnt vmcnt(53) lgkmcnt(4)
    v_mfma_f32_16x16x32_bf16 v[16:19], v[64:67], v[32:35], v[16:19]
    buffer_load_dwordx4 v[64:67], v7, s[8:11], s42 offen offset:0
    ds_read_b128 v[32:35], v1 offset:448
    s_waitcnt vmcnt(53) lgkmcnt(4)
    v_mfma_f32_16x16x32_bf16 v[16:19], v[68:71], v[36:39], v[16:19]
    buffer_load_dwordx4 v[68:71], v7, s[8:11], s42 offen offset:1024
    ds_read_b128 v[36:39], v1 offset:512
    s_waitcnt vmcnt(53) lgkmcnt(4)
    v_mfma_f32_16x16x32_bf16 v[16:19], v[72:75], v[8:11], v[16:19]
    buffer_load_dwordx4 v[72:75], v7, s[8:11], s42 offen offset:2048
    ds_write_b128 v5, v[20:23] offset:48
    ds_read_b128 v[8:11], v1 offset:0
    s_waitcnt vmcnt(53) lgkmcnt(5)
    v_mfma_f32_16x16x32_bf16 v[16:19], v[76:79], v[24:27], v[16:19]
    buffer_load_dwordx4 v[76:79], v7, s[8:11], s42 offen offset:3072
    s_add_u32 s42, s42, 0x1000
    ds_read_b128 v[24:27], v1 offset:64
    s_waitcnt vmcnt(53) lgkmcnt(5)
    v_mfma_f32_16x16x32_bf16 v[16:19], v[80:83], v[28:31], v[16:19]
    buffer_load_dwordx4 v[80:83], v7, s[8:11], s42 offen offset:0
    ds_read_b128 v[28:31], v1 offset:128
    s_waitcnt vmcnt(53) lgkmcnt(5)
    v_mfma_f32_16x16x32_bf16 v[16:19], v[84:87], v[32:35], v[16:19]
    buffer_load_dwordx4 v[84:87], v7, s[8:11], s42 offen offset:1024
    ds_read_b128 v[32:35], v1 offset:192
    s_waitcnt vmcnt(53) lgkmcnt(5)
    v_mfma_f32_16x16x32_bf16 v[16:19], v[88:91], v[36:39], v[16:19]
    buffer_load_dwordx4 v[88:91], v7, s[8:11], s42 offen offset:2048
    ds_read_b128 v[36:39], v1 offset:256
    s_waitcnt vmcnt(53) lgkmcnt(4)
    v_mfma_f32_16x16x32_bf16 v[20:23], v[92:95], v[8:11], 0
    buffer_load_dwordx4 v[92:95], v7, s[8:11], s42 offen offset:3072
    s_add_u32 s42, s42, 0x1000
    ds_read_b128 v[8:11], v1 offset:320
    s_waitcnt vmcnt(53) lgkmcnt(4)
    v_mfma_f32_16x16x32_bf16 v[20:23], v[96:99], v[24:27], v[20:23]
    buffer_load_dwordx4 v[96:99], v7, s[8:11], s42 offen offset:0
    ds_read_b128 v[24:27], v1 offset:384
    s_waitcnt vmcnt(53) lgkmcnt(4)
    v_mfma_f32_16x16x32_bf16 v[20:23], v[100:103], v[28:31], v[20:23]
    buffer_load_dwordx4 v[100:103], v7, s[8:11], s42 offen offset:1024
    ds_read_b128 v[28:31], v1 offset:448
    s_waitcnt vmcnt(53) lgkmcnt(4)
    v_mfma_f32_16x16x32_bf16 v[20:23], v[104:107], v[32:35], v[20:23]
    buffer_load_dwordx4 v[104:107], v7, s[8:11], s42 offen offset:2048
    ds_read_b128 v[32:35], v1 offset:512
    s_waitcnt vmcnt(53) lgkmcnt(4)
    v_mfma_f32_16x16x32_bf16 v[20:23], v[108:111], v[36:39], v[20:23]
    buffer_load_dwordx4 v[108:111], v7, s[8:11], s42 offen offset:3072
    s_add_u32 s42, s42, 0x1000
    ds_write_b128 v5, v[16:19] offset:64
    ds_read_b128 v[36:39], v1 offset:0
    s_waitcnt vmcnt(53) lgkmcnt(5)
    v_mfma_f32_16x16x32_bf16 v[20:23], v[112:115], v[8:11], v[20:23]
    buffer_load_dwordx4 v[112:115], v7, s[8:11], s42 offen offset:0
    ds_read_b128 v[8:11], v1 offset:64
    s_waitcnt vmcnt(53) lgkmcnt(5)
    v_mfma_f32_16x16x32_bf16 v[20:23], v[116:119], v[24:27], v[20:23]
    buffer_load_dwordx4 v[116:119], v7, s[8:11], s42 offen offset:1024
    ds_read_b128 v[24:27], v1 offset:128
    s_waitcnt vmcnt(53) lgkmcnt(5)
    v_mfma_f32_16x16x32_bf16 v[20:23], v[120:123], v[28:31], v[20:23]
    buffer_load_dwordx4 v[120:123], v7, s[8:11], s42 offen offset:2048
    ds_read_b128 v[28:31], v1 offset:192
    s_waitcnt vmcnt(53) lgkmcnt(5)
    v_mfma_f32_16x16x32_bf16 v[20:23], v[124:127], v[32:35], v[20:23]
    buffer_load_dwordx4 v[124:127], v7, s[8:11], s42 offen offset:3072
    s_add_u32 s42, s42, 0x1000
    ds_read_b128 v[32:35], v1 offset:256
    s_waitcnt vmcnt(53) lgkmcnt(4)
    v_mfma_f32_16x16x32_bf16 v[16:19], v[132:135], v[36:39], 0
    buffer_load_dwordx4 v[132:135], v7, s[8:11], s42 offen offset:0
    ds_read_b128 v[36:39], v1 offset:320
    s_waitcnt vmcnt(53) lgkmcnt(4)
    v_mfma_f32_16x16x32_bf16 v[16:19], v[136:139], v[8:11], v[16:19]
    buffer_load_dwordx4 v[136:139], v7, s[8:11], s42 offen offset:1024
    ds_read_b128 v[8:11], v1 offset:384
    s_waitcnt vmcnt(53) lgkmcnt(4)
    v_mfma_f32_16x16x32_bf16 v[16:19], v[140:143], v[24:27], v[16:19]
    buffer_load_dwordx4 v[140:143], v7, s[8:11], s42 offen offset:2048
    ds_read_b128 v[24:27], v1 offset:448
    s_waitcnt vmcnt(53) lgkmcnt(4)
    v_mfma_f32_16x16x32_bf16 v[16:19], v[144:147], v[28:31], v[16:19]
    buffer_load_dwordx4 v[144:147], v7, s[8:11], s42 offen offset:3072
    s_add_u32 s42, s42, 0x1000
    ds_read_b128 v[28:31], v1 offset:512
    s_waitcnt vmcnt(53) lgkmcnt(4)
    v_mfma_f32_16x16x32_bf16 v[16:19], v[148:151], v[32:35], v[16:19]
    buffer_load_dwordx4 v[148:151], v7, s[8:11], s42 offen offset:0
    ds_write_b128 v5, v[20:23] offset:80
    ds_read_b128 v[32:35], v1 offset:0
    s_waitcnt vmcnt(53) lgkmcnt(5)
    v_mfma_f32_16x16x32_bf16 v[16:19], v[152:155], v[36:39], v[16:19]
    buffer_load_dwordx4 v[152:155], v7, s[8:11], s42 offen offset:1024
    ds_read_b128 v[36:39], v1 offset:64
    s_waitcnt vmcnt(53) lgkmcnt(5)
    v_mfma_f32_16x16x32_bf16 v[16:19], v[156:159], v[8:11], v[16:19]
    buffer_load_dwordx4 v[156:159], v7, s[8:11], s42 offen offset:2048
    ds_read_b128 v[8:11], v1 offset:128
    s_waitcnt vmcnt(53) lgkmcnt(5)
    v_mfma_f32_16x16x32_bf16 v[16:19], v[160:163], v[24:27], v[16:19]
    buffer_load_dwordx4 v[160:163], v7, s[8:11], s42 offen offset:3072
    s_add_u32 s42, s42, 0x1000
    ds_read_b128 v[24:27], v1 offset:192
    s_waitcnt vmcnt(53) lgkmcnt(5)
    v_mfma_f32_16x16x32_bf16 v[16:19], v[164:167], v[28:31], v[16:19]
    buffer_load_dwordx4 v[164:167], v7, s[8:11], s42 offen offset:0
    ds_read_b128 v[28:31], v1 offset:256
    s_waitcnt vmcnt(53) lgkmcnt(4)
    v_mfma_f32_16x16x32_bf16 v[20:23], v[168:171], v[32:35], 0
    buffer_load_dwordx4 v[168:171], v7, s[8:11], s42 offen offset:1024
    ds_read_b128 v[32:35], v1 offset:320
    s_waitcnt vmcnt(53) lgkmcnt(4)
    v_mfma_f32_16x16x32_bf16 v[20:23], v[172:175], v[36:39], v[20:23]
    buffer_load_dwordx4 v[172:175], v7, s[8:11], s42 offen offset:2048
    ds_read_b128 v[36:39], v1 offset:384
    s_waitcnt vmcnt(53) lgkmcnt(4)
    v_mfma_f32_16x16x32_bf16 v[20:23], v[176:179], v[8:11], v[20:23]
    buffer_load_dwordx4 v[176:179], v7, s[8:11], s42 offen offset:3072
    s_add_u32 s42, s42, 0x1000
    ds_read_b128 v[8:11], v1 offset:448
    s_waitcnt vmcnt(53) lgkmcnt(4)
    v_mfma_f32_16x16x32_bf16 v[20:23], v[180:183], v[24:27], v[20:23]
    buffer_load_dwordx4 v[180:183], v7, s[8:11], s42 offen offset:0
    ds_read_b128 v[24:27], v1 offset:512
    s_waitcnt vmcnt(53) lgkmcnt(4)
    v_mfma_f32_16x16x32_bf16 v[20:23], v[184:187], v[28:31], v[20:23]
    buffer_load_dwordx4 v[184:187], v7, s[8:11], s42 offen offset:1024
    ds_write_b128 v5, v[16:19] offset:96
    ds_read_b128 v[28:31], v1 offset:0
    s_waitcnt vmcnt(53) lgkmcnt(5)
    v_mfma_f32_16x16x32_bf16 v[20:23], v[188:191], v[32:35], v[20:23]
    buffer_load_dwordx4 v[188:191], v7, s[8:11], s42 offen offset:2048
    ds_read_b128 v[32:35], v1 offset:64
    s_waitcnt vmcnt(53) lgkmcnt(5)
    v_mfma_f32_16x16x32_bf16 v[20:23], v[192:195], v[36:39], v[20:23]
    buffer_load_dwordx4 v[192:195], v7, s[8:11], s42 offen offset:3072
    s_add_u32 s42, s42, 0x1000
    ds_read_b128 v[36:39], v1 offset:128
    s_waitcnt vmcnt(53) lgkmcnt(5)
    v_mfma_f32_16x16x32_bf16 v[20:23], v[196:199], v[8:11], v[20:23]
    buffer_load_dwordx4 v[196:199], v7, s[8:11], s42 offen offset:0
    ds_read_b128 v[8:11], v1 offset:192
    s_waitcnt vmcnt(53) lgkmcnt(5)
    v_mfma_f32_16x16x32_bf16 v[20:23], v[200:203], v[24:27], v[20:23]
    buffer_load_dwordx4 v[200:203], v7, s[8:11], s42 offen offset:1024
    ds_read_b128 v[24:27], v1 offset:256
    s_waitcnt vmcnt(53) lgkmcnt(4)
    v_mfma_f32_16x16x32_bf16 v[16:19], v[204:207], v[28:31], 0
    buffer_load_dwordx4 v[204:207], v7, s[8:11], s42 offen offset:2048
    ds_read_b128 v[28:31], v1 offset:320
    s_waitcnt vmcnt(53) lgkmcnt(4)
    v_mfma_f32_16x16x32_bf16 v[16:19], v[208:211], v[32:35], v[16:19]
    buffer_load_dwordx4 v[208:211], v7, s[8:11], s42 offen offset:3072
    s_add_u32 s42, s42, 0x1000
    ds_read_b128 v[32:35], v1 offset:384
    s_waitcnt vmcnt(53) lgkmcnt(4)
    v_mfma_f32_16x16x32_bf16 v[16:19], v[212:215], v[36:39], v[16:19]
    buffer_load_dwordx4 v[212:215], v7, s[8:11], s42 offen offset:0
    ds_read_b128 v[36:39], v1 offset:448
    s_waitcnt vmcnt(53) lgkmcnt(4)
    v_mfma_f32_16x16x32_bf16 v[16:19], v[216:219], v[8:11], v[16:19]
    buffer_load_dwordx4 v[216:219], v7, s[8:11], s42 offen offset:1024
    ds_read_b128 v[8:11], v1 offset:512
    s_waitcnt vmcnt(53) lgkmcnt(4)
    v_mfma_f32_16x16x32_bf16 v[16:19], v[220:223], v[24:27], v[16:19]
    buffer_load_dwordx4 v[220:223], v7, s[8:11], s42 offen offset:2048
    ds_write_b128 v5, v[20:23] offset:112
    s_waitcnt vmcnt(53) lgkmcnt(4)
    v_mfma_f32_16x16x32_bf16 v[16:19], v[224:227], v[28:31], v[16:19]
    buffer_load_dwordx4 v[224:227], v7, s[8:11], s42 offen offset:3072
    s_add_u32 s42, s42, 0x1000
    s_waitcnt vmcnt(53) lgkmcnt(3)
    v_mfma_f32_16x16x32_bf16 v[16:19], v[228:231], v[32:35], v[16:19]
    buffer_load_dwordx4 v[228:231], v7, s[8:11], s42 offen offset:0
    s_waitcnt vmcnt(53) lgkmcnt(2)
    v_mfma_f32_16x16x32_bf16 v[16:19], v[232:235], v[36:39], v[16:19]
    buffer_load_dwordx4 v[232:235], v7, s[8:11], s42 offen offset:1024
    s_waitcnt vmcnt(53) lgkmcnt(1)
    v_mfma_f32_16x16x32_bf16 v[16:19], v[236:239], v[8:11], v[16:19]
    buffer_load_dwordx4 v[236:239], v7, s[8:11], s42 offen offset:2048
    s_nop 7
    ds_write_b128 v5, v[16:19] offset:128
K3_join:
    s_waitcnt vmcnt(0) lgkmcnt(0)
    s_barrier
    ds_read_b128 v[16:19], v4 offset:32
    ds_read_b128 v[20:23], v4 offset:48
    s_waitcnt lgkmcnt(0)
    v_or3_b32 v16, v16, v17, v18
    v_or3_b32 v16, v16, v19, v20
    v_or3_b32 v16, v16, v21, v22
    v_or_b32 v16, v16, v23
    v_cmp_ne_u32 vcc, 0, v16
    s_cmp_lg_u32 s31, 0
    s_cbranch_scc1 K3_proj
    s_cbranch_vccz K3_proj
    s_mov_b32 s31, 1
    s_mov_b32 s40, 64
    s_waitcnt vmcnt(0)
    s_barrier
    s_branch K3_restart
K3_proj:
    s_cmp_ge_u32 s3, 4
    s_cbranch_scc1 K3_projy
    ds_read_b128 v[8:11], v1 offset:576
    s_waitcnt lgkmcnt(0)
    v_mfma_f32_16x16x32_bf16 v[16:19], v[240:243], v[8:11], 0
    v_mfma_f32_16x16x32_bf16 v[20:23], v[244:247], v[8:11], 0
    buffer_load_dwordx4 v[240:243], v2, s[48:51], s6 offen
    buffer_load_dwordx4 v[244:247], v2, s[48:51], s6 offen offset:16
    v_mfma_f32_16x16x32_bf16 v[24:27], v[248:251], v[8:11], 0
    ds_read_b128 v[248:251], v1 offset:640
    v_mfma_f32_16x16x32_bf16 v[28:31], v[252:255], v[8:11], 0
    ds_read_b128 v[252:255], v1 offset:704
    v_mfma_f32_16x16x32_bf16 v[32:35], v[128:131], v[8:11], 0
    ds_read_b128 v[128:131], v1 offset:768
    v_mfma_f32_16x16x32_bf16 v[36:39], v[40:43], v[8:11], 0
    ds_read_b128 v[40:43], v1 offset:832
    s_waitcnt lgkmcnt(3)
    v_mfma_f32_16x16x32_bf16 v[16:19], v[44:47], v[248:251], v[16:19]
    ds_read_b128 v[44:47], v1 offset:896
    v_mfma_f32_16x16x32_bf16 v[20:23], v[48:51], v[248:251], v[20:23]
    ds_read_b128 v[48:51], v1 offset:960
    v_mfma_f32_16x16x32_bf16 v[24:27], v[52:55], v[248:251], v[24:27]
    ds_read_b128 v[52:55], v1 offset:1024
    v_mfma_f32_16x16x32_bf16 v[28:31], v[56:59], v[248:251], v[28:31]
    ds_read_b128 v[56:59], v1 offset:1088
    v_mfma_f32_16x16x32_bf16 v[32:35], v[60:63], v[248:251], v[32:35]
    v_mfma_f32_16x16x32_bf16 v[36:39], v[64:67], v[248:251], v[36:39]
    s_waitcnt lgkmcnt(6)
    v_mfma_f32_16x16x32_bf16 v[16:19], v[68:71], v[252:255], v[16:19]
    v_mfma_f32_16x16x32_bf16 v[20:23], v[72:75], v[252:255], v[20:23]
    v_mfma_f32_16x16x32_bf16 v[24:27], v[76:79], v[252:255], v[24:27]
    v_mfma_f32_16x16x32_bf16 v[28:31], v[80:83], v[252:255], v[28:31]
    v_mfma_f32_16x16x32_bf16 v[32:35], v[84:87], v[252:255], v[32:35]
    v_mfma_f32_16x16x32_bf16 v[36:39], v[88:91], v[252:255], v[36:39]
    s_waitcnt lgkmcnt(5)
    v_mfma_f32_16x16x32_bf16 v[16:19], v[92:95], v[128:131], v[16:19]
    v_mfma_f32_16x16x32_bf16 v[20:23], v[96:99], v[128:131], v[20:23]
    v_mfma_f32_16x16x32_bf16 v[24:27], v[100:103], v[128:131], v[24:27]
    v_mfma_f32_16x16x32_bf16 v[28:31], v[104:107], v[128:131], v[28:31]
    v_mfma_f32_16x16x32_bf16 v[32:35], v[108:111], v[128:131], v[32:35]
    v_mfma_f32_16x16x32_bf16 v[36:39], v[112:115], v[128:131], v[36:39]
    s_waitcnt lgkmcnt(4)
    v_mfma_f32_16x16x32_bf16 v[16:19], v[116:119], v[40:43], v[16:19]
    v_mfma_f32_16x16x32_bf16 v[20:23], v[120:123], v[40:43], v[20:23]
    v_mfma_f32_16x16x32_bf16 v[24:27], v[124:127], v[40:43], v[24:27]
    v_mfma_f32_16x16x32_bf16 v[28:31], v[132:135], v[40:43], v[28:31]
    v_mfma_f32_16x16x32_bf16 v[32:35], v[136:139], v[40:43], v[32:35]
    v_mfma_f32_16x16x32_bf16 v[36:39], v[140:143], v[40:43], v[36:39]
    s_waitcnt lgkmcnt(3)
    v_mfma_f32_16x16x32_bf16 v[16:19], v[144:147], v[44:47], v[16:19]
    v_mfma_f32_16x16x32_bf16 v[20:23], v[148:151], v[44:47], v[20:23]
    v_mfma_f32_16x16x32_bf16 v[24:27], v[152:155], v[44:47], v[24:27]
    v_mfma_f32_16x16x32_bf16 v[28:31], v[156:159], v[44:47], v[28:31]
    v_mfma_f32_16x16x32_bf16 v[32:35], v[160:163], v[44:47], v[32:35]
    v_mfma_f32_16x16x32_bf16 v[36:39], v[164:167], v[44:47], v[36:39]
    s_waitcnt lgkmcnt(2)
    v_mfma_f32_16x16x32_bf16 v[16:19], v[168:171], v[48:51], v[16:19]
    v_mfma_f32_16x16x32_bf16 v[20:23], v[172:175], v[48:51], v[20:23]
    v_mfma_f32_16x16x32_bf16 v[24:27], v[176:179], v[48:51], v[24:27]
    v_mfma_f32_16x16x32_bf16 v[28:31], v[180:183], v[48:51], v[28:31]
    v_mfma_f32_16x16x32_bf16 v[32:35], v[184:187], v[48:51], v[32:35]
    v_mfma_f32_16x16x32_bf16 v[36:39], v[188:191], v[48:51], v[36:39]
    s_waitcnt lgkmcnt(1)
    v_mfma_f32_16x16x32_bf16 v[16:19], v[192:195], v[52:55], v[16:19]
    v_mfma_f32_16x16x32_bf16 v[20:23], v[196:199], v[52:55], v[20:23]
    v_mfma_f32_16x16x32_bf16 v[24:27], v[200:203], v[52:55], v[24:27]
    v_mfma_f32_16x16x32_bf16 v[28:31], v[204:207], v[52:55], v[28:31]
    v_mfma_f32_16x16x32_bf16 v[32:35], v[208:211], v[52:55], v[32:35]
    v_mfma_f32_16x16x32_bf16 v[36:39], v[212:215], v[52:55], v[36:39]
    s_waitcnt lgkmcnt(0)
    v_mfma_f32_16x16x32_bf16 v[16:19], v[216:219], v[56:59], v[16:19]
    v_mfma_f32_16x16x32_bf16 v[20:23], v[220:223], v[56:59], v[20:23]
    v_mfma_f32_16x16x32_bf16 v[24:27], v[224:227], v[56:59], v[24:27]
    v_mfma_f32_16x16x32_bf16 v[28:31], v[228:231], v[56:59], v[28:31]
    v_mfma_f32_16x16x32_bf16 v[32:35], v[232:235], v[56:59], v[32:35]
    v_mfma_f32_16x16x32_bf16 v[36:39], v[236:239], v[56:59], v[36:39]
    s_nop 7
    ds_write_b128 v6, v[16:19] offset:0
    ds_write_b128 v6, v[20:23] offset:16
    ds_write_b128 v6, v[24:27] offset:32
    ds_write_b128 v6, v[28:31] offset:48
    ds_write_b128 v6, v[32:35] offset:64
    ds_write_b128 v6, v[36:39] offset:80
    s_mul_i32 s33, s3, 2320
    v_lshl_add_u32 v4, v0, 4, s33
    v_lshlrev_b32 v5, 4, v0
    v_mov_b32 v12, 0
    v_mov_b32 v13, 0
    v_mov_b32 v2, 0
    v_mov_b32 v3, 0
    s_mov_b64 exec, s[46:47]
    ds_read_b128 v[76:79], v5 offset:9344
    ds_read_b128 v[80:83], v5 offset:9920
    ds_read_b128 v[84:87], v5 offset:10496
    ds_read_b128 v[88:91], v5 offset:11072
    ds_read_b128 v[124:127], v4 offset:17536
    ds_read_b128 v[128:131], v4 offset:18112
    ds_read_b128 v[248:251], v4 offset:18688
    ds_read_b128 v[252:255], v4 offset:19264
    ds_read_b128 v[92:95], v5 offset:13952
    ds_read_b128 v[96:99], v5 offset:14528
    ds_read_b128 v[100:103], v5 offset:15104
    ds_read_b128 v[104:107], v5 offset:15680
    s_lshr_b32 s5, s4, 4
    s_mul_i32 s5, s5, 18432
    s_and_b32 s7, s4, 15
    s_lshl_b32 s7, s7, 4
    s_add_u32 s5, s5, s7
    s_add_u32 s7, s5, 0xc00000
    s_add_u32 s5, s5, 0x900000
    v_lshlrev_b32 v14, 9, v0
    s_mov_b32 s33, 0xffff0000
    s_waitcnt vmcnt(0)
    v_lshlrev_b32 v108, 16, v240
    v_and_b32 v109, s33, v240
    v_lshlrev_b32 v110, 16, v241
    v_and_b32 v111, s33, v241
    v_lshlrev_b32 v112, 16, v242
    v_and_b32 v113, s33, v242
    v_lshlrev_b32 v114, 16, v243
    v_and_b32 v115, s33, v243
    v_lshlrev_b32 v116, 16, v244
    v_and_b32 v117, s33, v244
    v_lshlrev_b32 v118, 16, v245
    v_and_b32 v119, s33, v245
    v_lshlrev_b32 v120, 16, v246
    v_and_b32 v121, s33, v246
    v_lshlrev_b32 v122, 16, v247
    v_and_b32 v123, s33, v247
    s_waitcnt lgkmcnt(4)
    v_pk_fma_f32 v[108:109], v[124:125], v[76:77], v[108:109]
    v_pk_fma_f32 v[110:111], v[126:127], v[78:79], v[110:111]
    v_pk_fma_f32 v[112:113], v[128:129], v[80:81], v[112:113]
    v_pk_fma_f32 v[114:115], v[130:131], v[82:83], v[114:115]
    v_pk_fma_f32 v[116:117], v[248:249], v[84:85], v[116:117]
    v_pk_fma_f32 v[118:119], v[250:251], v[86:87], v[118:119]
    v_pk_fma_f32 v[120:121], v[252:253], v[88:89], v[120:121]
    v_pk_fma_f32 v[122:123], v[254:255], v[90:91], v[122:123]
    s_mov_b64 exec, -1
    s_branch K3_ln
K3_projy:
    s_mul_i32 s33, s3, 2320
    v_lshl_add_u32 v4, v0, 4, s33
    v_lshlrev_b32 v5, 4, v0
    v_mov_b32 v12, 0
    v_mov_b32 v13, 0
    v_mov_b32 v2, 0
    v_mov_b32 v3, 0
    s_mov_b64 exec, s[46:47]
    ds_read_b128 v[76:79], v5 offset:9344
    ds_read_b128 v[80:83], v5 offset:9920
    ds_read_b128 v[84:87], v5 offset:10496
    ds_read_b128 v[88:91], v5 offset:11072
    ds_read_b128 v[124:127], v4 offset:17536
    ds_read_b128 v[128:131], v4 offset:18112
    ds_read_b128 v[248:251], v4 offset:18688
    ds_read_b128 v[252:255], v4 offset:19264
    ds_read_b128 v[92:95], v5 offset:13952
    ds_read_b128 v[96:99], v5 offset:14528
    ds_read_b128 v[100:103], v5 offset:15104
    ds_read_b128 v[104:107], v5 offset:15680
    s_lshr_b32 s5, s4, 4
    s_mul_i32 s5, s5, 18432
    s_and_b32 s7, s4, 15
    s_lshl_b32 s7, s7, 4
    s_add_u32 s5, s5, s7
    s_add_u32 s7, s5, 0xc00000
    s_add_u32 s5, s5, 0x900000
    v_lshlrev_b32 v14, 9, v0
    s_mov_b32 s33, 0xffff0000
    s_waitcnt vmcnt(0)
    v_lshlrev_b32 v108, 16, v240
    v_and_b32 v109, s33, v240
    v_lshlrev_b32 v110, 16, v241
    v_and_b32 v111, s33, v241
    v_lshlrev_b32 v112, 16, v242
    v_and_b32 v113, s33, v242
    v_lshlrev_b32 v114, 16, v243
    v_and_b32 v115, s33, v243
    v_lshlrev_b32 v116, 16, v244
    v_and_b32 v117, s33, v244
    v_lshlrev_b32 v118, 16, v245
    v_and_b32 v119, s33, v245
    v_lshlrev_b32 v120, 16, v246
    v_and_b32 v121, s33, v246
    v_lshlrev_b32 v122, 16, v247
    v_and_b32 v123, s33, v247
    s_waitcnt lgkmcnt(4)
    v_pk_fma_f32 v[108:109], v[124:125], v[76:77], v[108:109]
    v_pk_fma_f32 v[110:111], v[126:127], v[78:79], v[110:111]
    v_pk_fma_f32 v[112:113], v[128:129], v[80:81], v[112:113]
    v_pk_fma_f32 v[114:115], v[130:131], v[82:83], v[114:115]
    v_pk_fma_f32 v[116:117], v[248:249], v[84:85], v[116:117]
    v_pk_fma_f32 v[118:119], v[250:251], v[86:87], v[118:119]
    v_pk_fma_f32 v[120:121], v[252:253], v[88:89], v[120:121]
    v_pk_fma_f32 v[122:123], v[254:255], v[90:91], v[122:123]
    s_mov_b64 exec, -1
    ds_read_b128 v[40:43], v1 offset:576
    ds_read_b128 v[44:47], v1 offset:640
    ds_read_b128 v[48:51], v1 offset:704
    ds_read_b128 v[52:55], v1 offset:768
    ds_read_b128 v[56:59], v1 offset:832
    ds_read_b128 v[60:63], v1 offset:896
    ds_read_b128 v[64:67], v1 offset:960
    ds_read_b128 v[68:71], v1 offset:1024
    ds_read_b128 v[72:75], v1 offset:1088
    s_waitcnt lgkmcnt(8)
    v_mfma_f32_16x16x32_bf16 v[16:19], v[132:135], v[40:43], 0
    v_mfma_f32_16x16x32_bf16 v[20:23], v[136:139], v[40:43], 0
    v_mfma_f32_16x16x32_bf16 v[24:27], v[140:143], v[40:43], 0
    s_waitcnt lgkmcnt(7)
    v_mfma_f32_16x16x32_bf16 v[16:19], v[144:147], v[44:47], v[16:19]
    v_mfma_f32_16x16x32_bf16 v[20:23], v[148:151], v[44:47], v[20:23]
    v_mfma_f32_16x16x32_bf16 v[24:27], v[152:155], v[44:47], v[24:27]
    s_waitcnt lgkmcnt(6)
    v_mfma_f32_16x16x32_bf16 v[16:19], v[156:159], v[48:51], v[16:19]
    v_mfma_f32_16x16x32_bf16 v[20:23], v[160:163], v[48:51], v[20:23]
    v_mfma_f32_16x16x32_bf16 v[24:27], v[164:167], v[48:51], v[24:27]
    s_waitcnt lgkmcnt(5)
    v_mfma_f32_16x16x32_bf16 v[16:19], v[168:171], v[52:55], v[16:19]
    v_mfma_f32_16x16x32_bf16 v[20:23], v[172:175], v[52:55], v[20:23]
    v_mfma_f32_16x16x32_bf16 v[24:27], v[176:179], v[52:55], v[24:27]
    s_waitcnt lgkmcnt(4)
    v_mfma_f32_16x16x32_bf16 v[16:19], v[180:183], v[56:59], v[16:19]
    v_mfma_f32_16x16x32_bf16 v[20:23], v[184:187], v[56:59], v[20:23]
    v_mfma_f32_16x16x32_bf16 v[24:27], v[188:191], v[56:59], v[24:27]
    s_waitcnt lgkmcnt(3)
    v_mfma_f32_16x16x32_bf16 v[16:19], v[192:195], v[60:63], v[16:19]
    v_mfma_f32_16x16x32_bf16 v[20:23], v[196:199], v[60:63], v[20:23]
    v_mfma_f32_16x16x32_bf16 v[24:27], v[200:203], v[60:63], v[24:27]
    s_waitcnt lgkmcnt(2)
    v_mfma_f32_16x16x32_bf16 v[16:19], v[204:207], v[64:67], v[16:19]
    v_mfma_f32_16x16x32_bf16 v[20:23], v[208:211], v[64:67], v[20:23]
    v_mfma_f32_16x16x32_bf16 v[24:27], v[212:215], v[64:67], v[24:27]
    s_waitcnt lgkmcnt(1)
    v_mfma_f32_16x16x32_bf16 v[16:19], v[216:219], v[68:71], v[16:19]
    v_mfma_f32_16x16x32_bf16 v[20:23], v[220:223], v[68:71], v[20:23]
    v_mfma_f32_16x16x32_bf16 v[24:27], v[224:227], v[68:71], v[24:27]
    s_waitcnt lgkmcnt(0)
    v_mfma_f32_16x16x32_bf16 v[16:19], v[228:231], v[72:75], v[16:19]
    v_mfma_f32_16x16x32_bf16 v[20:23], v[232:235], v[72:75], v[20:23]
    v_mfma_f32_16x16x32_bf16 v[24:27], v[236:239], v[72:75], v[24:27]
    s_nop 7
    ds_write_b128 v6, v[16:19] offset:0
    ds_write_b128 v6, v[20:23] offset:16
    ds_write_b128 v6, v[24:27] offset:32
K3_ln:
    s_mov_b64 exec, s[46:47]
    s_waitcnt lgkmcnt(0)
    s_barrier
    ds_read_b128 v[168:171], v4 offset:37888
    ds_read_b128 v[172:175], v4 offset:38464
    ds_read_b128 v[176:179], v4 offset:39040
    ds_read_b128 v[180:183], v4 offset:39616
    ds_read_b128 v[136:139], v5 offset:11648
    ds_read_b128 v[140:143], v5 offset:12224
    ds_read_b128 v[144:147], v5 offset:12800
    ds_read_b128 v[148:151], v5 offset:13376
    s_waitcnt lgkmcnt(7)
    v_pk_fma_f32 v[168:169], v[168:169], v[76:77], v[108:109]
    v_pk_fma_f32 v[170:171], v[170:171], v[78:79], v[110:111]
    s_waitcnt lgkmcnt(6)
    v_pk_fma_f32 v[172:173], v[172:173], v[80:81], v[112:113]
    v_pk_fma_f32 v[174:175], v[174:175], v[82:83], v[114:115]
    s_waitcnt lgkmcnt(5)
    v_pk_fma_f32 v[176:177], v[176:177], v[84:85], v[116:117]
    v_pk_fma_f32 v[178:179], v[178:179], v[86:87], v[118:119]
    s_waitcnt lgkmcnt(4)
    v_pk_fma_f32 v[180:181], v[180:181], v[88:89], v[120:121]
    v_pk_fma_f32 v[182:183], v[182:183], v[90:91], v[122:123]
    v_readfirstlane_b32 s34, v168
    v_cvt_pk_bf16_f32 v48, v168, v169
    v_cvt_pk_bf16_f32 v49, v170, v171
    v_cvt_pk_bf16_f32 v50, v172, v173
    v_cvt_pk_bf16_f32 v51, v174, v175
    v_cvt_pk_bf16_f32 v52, v176, v177
    v_cvt_pk_bf16_f32 v53, v178, v179
    v_cvt_pk_bf16_f32 v54, v180, v181
    v_cvt_pk_bf16_f32 v55, v182, v183
    v_mov_b32 v8, s34
    buffer_store_dwordx4 v[48:51], v14, s[8:11], s7 offen
    buffer_store_dwordx4 v[52:55], v14, s[8:11], s7 offen offset:256
    v_pk_add_f32 v[168:169], v[168:169], v[8:9] op_sel_hi:[1,0] neg_lo:[0,1] neg_hi:[0,1]
    v_pk_add_f32 v[170:171], v[170:171], v[8:9] op_sel_hi:[1,0] neg_lo:[0,1] neg_hi:[0,1]
    v_pk_add_f32 v[172:173], v[172:173], v[8:9] op_sel_hi:[1,0] neg_lo:[0,1] neg_hi:[0,1]
    v_pk_add_f32 v[174:175], v[174:175], v[8:9] op_sel_hi:[1,0] neg_lo:[0,1] neg_hi:[0,1]
    v_pk_add_f32 v[176:177], v[176:177], v[8:9] op_sel_hi:[1,0] neg_lo:[0,1] neg_hi:[0,1]
    v_pk_add_f32 v[178:179], v[178:179], v[8:9] op_sel_hi:[1,0] neg_lo:[0,1] neg_hi:[0,1]
    v_pk_add_f32 v[180:181], v[180:181], v[8:9] op_sel_hi:[1,0] neg_lo:[0,1] neg_hi:[0,1]
    v_pk_add_f32 v[182:183], v[182:183], v[8:9] op_sel_hi:[1,0] neg_lo:[0,1] neg_hi:[0,1]
    v_pk_add_f32 v[12:13], v[12:13], v[168:169]
    v_pk_fma_f32 v[2:3], v[168:169], v[168:169], v[2:3]
    v_pk_add_f32 v[12:13], v[12:13], v[170:171]
    v_pk_fma_f32 v[2:3], v[170:171], v[170:171], v[2:3]
    v_pk_add_f32 v[12:13], v[12:13], v[172:173]
    v_pk_fma_f32 v[2:3], v[172:173], v[172:173], v[2:3]
    v_pk_add_f32 v[12:13], v[12:13], v[174:175]
    v_pk_fma_f32 v[2:3], v[174:175], v[174:175], v[2:3]
    v_pk_add_f32 v[12:13], v[12:13], v[176:177]
    v_pk_fma_f32 v[2:3], v[176:177], v[176:177], v[2:3]
    v_pk_add_f32 v[12:13], v[12:13], v[178:179]
    v_pk_fma_f32 v[2:3], v[178:179], v[178:179], v[2:3]
    v_pk_add_f32 v[12:13], v[12:13], v[180:181]
    v_pk_fma_f32 v[2:3], v[180:181], v[180:181], v[2:3]
    v_pk_add_f32 v[12:13], v[12:13], v[182:183]
    v_pk_fma_f32 v[2:3], v[182:183], v[182:183], v[2:3]
    v_add_f32 v12, v12, v13
    v_add_f32 v2, v2, v3
    s_mov_b64 exec, -1
    s_nop 0
    v_add_f32_dpp v12, v12, v12 row_ror:1 row_mask:0xf bank_mask:0xf
    v_add_f32_dpp v2, v2, v2 row_ror:1 row_mask:0xf bank_mask:0xf
    s_nop 0
    v_add_f32_dpp v12, v12, v12 row_ror:2 row_mask:0xf bank_mask:0xf
    v_add_f32_dpp v2, v2, v2 row_ror:2 row_mask:0xf bank_mask:0xf
    s_nop 0
    v_add_f32_dpp v12, v12, v12 row_ror:4 row_mask:0xf bank_mask:0xf
    v_add_f32_dpp v2, v2, v2 row_ror:4 row_mask:0xf bank_mask:0xf
    s_nop 0
    v_add_f32_dpp v12, v12, v12 row_ror:8 row_mask:0xf bank_mask:0xf
    v_add_f32_dpp v2, v2, v2 row_ror:8 row_mask:0xf bank_mask:0xf
    s_nop 0
    v_mov_b32 v13, v12
    v_mov_b32 v3, v2
    s_nop 0
    v_permlane16_swap_b32 v12, v13
    v_permlane16_swap_b32 v2, v3
    v_add_f32 v12, v12, v13
    v_add_f32 v2, v2, v3
    v_mov_b32 v13, v12
    v_mov_b32 v3, v2
    s_nop 0
    v_permlane32_swap_b32 v12, v13
    v_permlane32_swap_b32 v2, v3
    v_add_f32 v12, v12, v13
    v_add_f32 v2, v2, v3
    v_mul_f32 v12, -0.001736111111111111, v12
    v_mov_b32 v3, 0x3727c5ac
    v_fmac_f32 v3, 0.001736111111111111, v2
    v_fma_f32 v3, -v12, v12, v3
    v_max_f32 v3, 0x3727c5ac, v3
    v_rsq_f32 v10, v3
    s_mov_b64 exec, s[46:47]
    v_mul_f32 v11, v12, v10
    s_waitcnt lgkmcnt(0)
    v_pk_fma_f32 v[168:169], v[168:169], v[10:11], v[10:11] op_sel:[0,0,1] op_sel_hi:[1,0,1]
    v_pk_fma_f32 v[170:171], v[170:171], v[10:11], v[10:11] op_sel:[0,0,1] op_sel_hi:[1,0,1]
    v_pk_fma_f32 v[172:173], v[172:173], v[10:11], v[10:11] op_sel:[0,0,1] op_sel_hi:[1,0,1]
    v_pk_fma_f32 v[174:175], v[174:175], v[10:11], v[10:11] op_sel:[0,0,1] op_sel_hi:[1,0,1]
    v_pk_fma_f32 v[176:177], v[176:177], v[10:11], v[10:11] op_sel:[0,0,1] op_sel_hi:[1,0,1]
    v_pk_fma_f32 v[178:179], v[178:179], v[10:11], v[10:11] op_sel:[0,0,1] op_sel_hi:[1,0,1]
    v_pk_fma_f32 v[180:181], v[180:181], v[10:11], v[10:11] op_sel:[0,0,1] op_sel_hi:[1,0,1]
    v_pk_fma_f32 v[182:183], v[182:183], v[10:11], v[10:11] op_sel:[0,0,1] op_sel_hi:[1,0,1]
    v_pk_fma_f32 v[168:169], v[168:169], v[92:93], v[136:137]
    v_pk_fma_f32 v[170:171], v[170:171], v[94:95], v[138:139]
    v_pk_fma_f32 v[172:173], v[172:173], v[96:97], v[140:141]
    v_pk_fma_f32 v[174:175], v[174:175], v[98:99], v[142:143]
    v_pk_fma_f32 v[176:177], v[176:177], v[100:101], v[144:145]
    v_pk_fma_f32 v[178:179], v[178:179], v[102:103], v[146:147]
    v_pk_fma_f32 v[180:181], v[180:181], v[104:105], v[148:149]
    v_pk_fma_f32 v[182:183], v[182:183], v[106:107], v[150:151]
    v_cvt_pk_bf16_f32 v56, v168, v169
    v_cvt_pk_bf16_f32 v57, v170, v171
    v_cvt_pk_bf16_f32 v58, v172, v173
    v_cvt_pk_bf16_f32 v59, v174, v175
    v_cvt_pk_bf16_f32 v60, v176, v177
    v_cvt_pk_bf16_f32 v61, v178, v179
    v_cvt_pk_bf16_f32 v62, v180, v181
    v_cvt_pk_bf16_f32 v63, v182, v183
    buffer_store_dwordx4 v[56:59], v14, s[8:11], s5 offen
    buffer_store_dwordx4 v[60:63], v14, s[8:11], s5 offen offset:256
K3_end:
    s_endpgm
.globl k5_ffn_kernel
.p2align 8
.type k5_ffn_kernel,@function
k5_ffn_kernel:
    s_cmp_ge_u32 s2, 256
    s_cbranch_scc1 K5_end
    s_load_dwordx2 s[8:9], s[0:1], 104
    s_load_dwordx2 s[64:65], s[0:1], 88
    s_mov_b32 s66, 2359296
    s_mov_b32 s67, 0x20000
    v_lshrrev_b32 v2, 6, v0
    v_and_b32 v0, 63, v0
    v_readfirstlane_b32 s3, v2
    v_lshlrev_b32 v1, 4, v0
    s_mov_b32 s10, 0x10000000
    s_mov_b32 s11, 0x20000
    s_mov_b32 s14, 995328
    s_mov_b32 s15, 0x20000
    s_mov_b32 s18, 2359296
    s_mov_b32 s19, 0x20000
    s_mov_b32 s23, 0xffff0000
    s_and_b32 s4, s2, 3
    s_lshl_b32 s4, s4, 2
    s_bfe_u32 s5, s2, 0x20003
    s_add_u32 s4, s4, s5
    s_bfe_u32 s5, s2, 0x10002
    s_lshl_b32 s5, s5, 3
    s_lshr_b32 s6, s2, 5
    s_add_u32 s5, s5, s6
    s_lshl_b32 s5, s5, 2
    s_add_u32 s5, s5, s3
    s_mul_i32 s20, s3, 9216
    v_lshrrev_b32 v9, 4, v0
    v_lshlrev_b32 v10, 3, v0
    s_mul_i32 s6, s5, 9216
    s_add_u32 s6, s6, 0x280000
    s_add_u32 s7, s6, 4608
    s_mul_i32 s34, s4, 995328
    s_add_u32 s34, s34, 0x1000000
    s_lshr_b32 s47, s4, 2
    s_and_b32 s48, s4, 3
    s_mul_i32 s35, s47, 2359296
    s_add_u32 s35, s35, 0x2000000
    s_lshl_b32 s36, s3, 10
    s_add_u32 m0, s36, 147456
    s_add_u32 s36, s36, 6912
    s_mul_i32 s37, s5, 36864
    s_waitcnt lgkmcnt(0)
    s_add_u32 s12, s8, s34
    s_addc_u32 s13, s9, 0
    s_add_u32 s16, s8, s35
    s_addc_u32 s17, s9, 0
    s_add_u32 s36, s37, 0x900000
    s_add_u32 s38, s36, 18432
    s_mov_b32 s24, s20
    s_add_u32 s25, s20, 0x1000
    s_add_u32 s26, s20, 0x2000
    s_add_u32 m0, s20, 0
    s_nop 0
    buffer_load_dwordx4 v1, s[12:15], s24 offen offset:0 lds
    buffer_load_dwordx4 v1, s[12:15], s24 offen offset:1024 lds
    buffer_load_dwordx4 v1, s[12:15], s24 offen offset:2048 lds
    buffer_load_dwordx4 v1, s[12:15], s24 offen offset:3072 lds
    s_add_u32 m0, s20, 4096
    s_nop 0
    buffer_load_dwordx4 v1, s[12:15], s25 offen offset:0 lds
    buffer_load_dwordx4 v1, s[12:15], s25 offen offset:1024 lds
    buffer_load_dwordx4 v1, s[12:15], s25 offen offset:2048 lds
    buffer_load_dwordx4 v1, s[12:15], s25 offen offset:3072 lds
    s_add_u32 m0, s20, 8192
    s_nop 0
    buffer_load_dwordx4 v1, s[12:15], s26 offen offset:0 lds
    s_add_u32 s24, s24, 36864
    s_add_u32 s25, s25, 36864
    s_add_u32 s26, s26, 36864
    buffer_load_dwordx4 v[112:115], v1, s[8:11], s36 offen offset:0
    buffer_load_dwordx4 v[116:119], v1, s[8:11], s38 offen offset:0
    buffer_load_dwordx4 v[120:123], v1, s[8:11], s36 offen offset:1024
    buffer_load_dwordx4 v[124:127], v1, s[8:11], s38 offen offset:1024
    buffer_load_dwordx4 v[128:131], v1, s[8:11], s36 offen offset:2048
    buffer_load_dwordx4 v[132:135], v1, s[8:11], s38 offen offset:2048
    buffer_load_dwordx4 v[136:139], v1, s[8:11], s36 offen offset:3072
    buffer_load_dwordx4 v[140:143], v1, s[8:11], s38 offen offset:3072
    s_add_u32 s36, s36, 0x1000
    s_add_u32 s38, s38, 0x1000
    v_add_u32 v4, 73728, v1
    v_add_u32 v5, 110592, v1
    v_mov_b32 v6, v1
    v_add_u32 v7, 36864, v1
    v_lshlrev_b32 v12, 5, v9
    v_add_u32 v12, 147456, v12
    s_lshr_b32 s49, s5, 2
    s_lshl_b32 s50, s49, 2
    s_add_u32 s50, s50, s47
    s_lshl_b32 s45, s50, 2
    s_add_u32 s45, s45, s3
    s_lshl_b32 s45, s45, 7
    s_add_u32 s45, s45, 0x200000
    s_lshl_b32 s46, s48, 2
    s_add_u32 s46, s46, s45
    s_lshl_b32 s50, s50, 4
    s_add_u32 s50, s50, s3
    s_mul_i32 s50, s50, 20480
    s_add_u32 s50, s50, 0x3000000
    s_mul_i32 s41, s48, 81920
    s_add_u32 s41, s41, s50
    s_add_u32 s50, s50, 0x800
    s_add_u32 s42, s48, 1
    s_and_b32 s42, s42, 3
    s_mul_i32 s42, s42, 81920
    s_add_u32 s42, s42, s50
    s_add_u32 s43, s48, 2
    s_and_b32 s43, s43, 3
    s_mul_i32 s43, s43, 81920
    s_add_u32 s43, s43, s50
    s_add_u32 s44, s48, 3
    s_and_b32 s44, s44, 3
    s_mul_i32 s44, s44, 81920
    s_add_u32 s44, s44, s50
    v_cmp_eq_u32 vcc, 0, v0
    v_mov_b32 v18, 0x7fffffff
    v_mov_b32 v19, 3
    s_mov_b32 s54, 0x7fff0000
    v_mov_b32 v24, 0
    v_cndmask_b32 v18, v18, v24, vcc
    s_lshr_b32 s50, s48, 1
    s_mul_i32 s50, s50, 9
    s_and_b32 s51, s48, 1
    s_mul_i32 s62, s51, 5
    s_add_u32 s62, s62, s50
    s_add_u32 s62, s62, s47
    s_lshl_b32 s55, s62, 10
    s_add_u32 s55, s55, s37
    s_add_u32 s55, s55, 0xc00000
    s_lshl_b32 s58, s62, 7
    s_add_u32 s58, s58, 11520
    s_lshl_b32 s62, s62, 6
    s_add_u32 s50, s50, 4
    s_lshl_b32 s57, s50, 10
    s_lshl_b32 s60, s51, 3
    s_add_u32 s57, s57, s60
    s_add_u32 s57, s57, s37
    s_add_u32 s57, s57, 0xc00000
    s_lshl_b32 s63, s50, 6
    s_add_u32 s63, s63, s60
    s_lshl_b32 s59, s63, 1
    s_add_u32 s59, s59, 11520
    s_mul_i32 s60, s5, 36864
    s_add_u32 s63, s63, s60
    s_add_u32 s62, s62, s60
    v_lshlrev_b32 v26, 5, v9
    v_and_b32 v27, 15, v0
    v_mul_u32_u24 v27, 1152, v27
    v_lshl_add_u32 v27, v9, 4, v27
    s_lshl_b32 s60, s49, 2
    s_add_u32 s60, s60, s48
    s_lshl_b32 s60, s60, 2
    s_add_u32 s60, s60, s3
    s_lshl_b32 s50, s60, 15
    s_add_u32 s50, s50, 0x2000000
    s_mul_i32 s56, s47, 6144
    s_add_u32 s56, s56, s50
    s_add_u32 s32, s47, 1
    s_and_b32 s32, s32, 3
    s_mul_i32 s32, s32, 6144
    s_add_u32 s32, s32, s50
    s_add_u32 s33, s47, 2
    s_and_b32 s33, s33, 3
    s_mul_i32 s33, s33, 6144
    s_add_u32 s33, s33, s50
    s_add_u32 s33, s33, 2048
    s_add_u32 s34, s47, 3
    s_and_b32 s34, s34, 3
    s_mul_i32 s34, s34, 6144
    s_add_u32 s34, s34, s50
    s_add_u32 s34, s34, 4096
    s_add_u32 s51, s50, 24576
    s_lshl_b32 s35, s47, 10
    s_add_u32 s35, s35, s51
    s_lshl_b32 s60, s60, 7
    s_add_u32 s60, s60, 2129920
    s_lshl_b32 s61, s47, 2
    s_add_u32 s61, s61, s60
    s_cmp_eq_u32 s47, 3
    s_cselect_b32 s51, s51, s54
    s_mov_b32 s30, 8
    s_add_u32 s41, s41, 0x800
    s_waitcnt vmcnt(8)
    s_barrier
    ds_read_b128 a[80:83], v6 offset:0
    ds_read_b128 a[84:87], v6 offset:1024
    ds_read_b128 a[88:91], v6 offset:2048
    ds_read_b128 a[92:95], v6 offset:3072
    ds_read_b128 a[96:99], v6 offset:4096
    ds_read_b128 a[100:103], v6 offset:5120
    ds_read_b128 a[104:107], v6 offset:6144
    ds_read_b128 a[108:111], v6 offset:7168
    s_waitcnt lgkmcnt(4)
    s_waitcnt vmcnt(7)
    v_mfma_f32_16x16x32_bf16 v[80:83], a[80:83], v[112:115], 0
    ds_read_b128 a[112:115], v6 offset:8192
    buffer_load_dwordx4 v[144:147], v1, s[8:11], s36 offen offset:0
    s_waitcnt vmcnt(7)
    v_mfma_f32_16x16x32_bf16 v[84:87], a[80:83], v[116:119], 0
    v_mfma_f32_16x16x32_bf16 v[88:91], a[84:87], v[112:115], 0
    ds_read_b128 a[116:119], v6 offset:9216
    buffer_load_dwordx4 v[148:151], v1, s[8:11], s38 offen offset:0
    v_mfma_f32_16x16x32_bf16 v[92:95], a[84:87], v[116:119], 0
    v_mfma_f32_16x16x32_bf16 v[96:99], a[88:91], v[112:115], 0
    ds_read_b128 a[120:123], v6 offset:10240
    buffer_load_dwordx4 v[152:155], v1, s[8:11], s36 offen offset:1024
    v_mfma_f32_16x16x32_bf16 v[100:103], a[88:91], v[116:119], 0
    v_mfma_f32_16x16x32_bf16 v[104:107], a[92:95], v[112:115], 0
    ds_read_b128 a[124:127], v6 offset:11264
    buffer_load_dwordx4 v[156:159], v1, s[8:11], s38 offen offset:1024
    v_mfma_f32_16x16x32_bf16 v[108:111], a[92:95], v[116:119], 0
    s_add_u32 m0, s20, 36864
    s_waitcnt lgkmcnt(4)
    s_waitcnt vmcnt(9)
    v_mfma_f32_16x16x32_bf16 v[80:83], a[96:99], v[120:123], v[80:83]
    ds_read_b128 a[80:83], v6 offset:12288
    buffer_load_dwordx4 v1, s[12:15], s24 offen offset:0 lds
    s_waitcnt vmcnt(9)
    v_mfma_f32_16x16x32_bf16 v[84:87], a[96:99], v[124:127], v[84:87]
    buffer_load_dwordx4 v[160:163], v1, s[8:11], s36 offen offset:2048
    v_mfma_f32_16x16x32_bf16 v[88:91], a[100:103], v[120:123], v[88:91]
    ds_read_b128 a[84:87], v6 offset:13312
    buffer_load_dwordx4 v1, s[12:15], s24 offen offset:1024 lds
    v_mfma_f32_16x16x32_bf16 v[92:95], a[100:103], v[124:127], v[92:95]
    buffer_load_dwordx4 v[164:167], v1, s[8:11], s38 offen offset:2048
    v_mfma_f32_16x16x32_bf16 v[96:99], a[104:107], v[120:123], v[96:99]
    ds_read_b128 a[88:91], v6 offset:14336
    buffer_load_dwordx4 v1, s[12:15], s24 offen offset:2048 lds
    v_mfma_f32_16x16x32_bf16 v[100:103], a[104:107], v[124:127], v[100:103]
    buffer_load_dwordx4 v[168:171], v1, s[8:11], s36 offen offset:3072
    v_mfma_f32_16x16x32_bf16 v[104:107], a[108:111], v[120:123], v[104:107]
    ds_read_b128 a[92:95], v6 offset:15360
    v_mfma_f32_16x16x32_bf16 v[108:111], a[108:111], v[124:127], v[108:111]
    buffer_load_dwordx4 v[172:175], v1, s[8:11], s38 offen offset:3072
    s_waitcnt lgkmcnt(4)
    s_waitcnt vmcnt(14)
    v_mfma_f32_16x16x32_bf16 v[80:83], a[112:115], v[128:131], v[80:83]
    ds_read_b128 a[96:99], v6 offset:16384
    buffer_load_dwordx4 v1, s[12:15], s24 offen offset:3072 lds
    s_waitcnt vmcnt(14)
    v_mfma_f32_16x16x32_bf16 v[84:87], a[112:115], v[132:135], v[84:87]
    s_add_u32 m0, s20, 40960
    v_mfma_f32_16x16x32_bf16 v[88:91], a[116:119], v[128:131], v[88:91]
    ds_read_b128 a[100:103], v6 offset:17408
    s_add_u32 s36, s36, 0x1000
    v_mfma_f32_16x16x32_bf16 v[92:95], a[116:119], v[132:135], v[92:95]
    buffer_load_dwordx4 v1, s[12:15], s25 offen offset:0 lds
    v_mfma_f32_16x16x32_bf16 v[96:99], a[120:123], v[128:131], v[96:99]
    ds_read_b128 a[104:107], v6 offset:18432
    s_add_u32 s38, s38, 0x1000
    v_mfma_f32_16x16x32_bf16 v[100:103], a[120:123], v[132:135], v[100:103]
    buffer_load_dwordx4 v1, s[12:15], s25 offen offset:1024 lds
    v_mfma_f32_16x16x32_bf16 v[104:107], a[124:127], v[128:131], v[104:107]
    ds_read_b128 a[108:111], v6 offset:19456
    buffer_load_dwordx4 v[176:179], v1, s[8:11], s36 offen offset:0
    v_mfma_f32_16x16x32_bf16 v[108:111], a[124:127], v[132:135], v[108:111]
    s_waitcnt lgkmcnt(4)
    s_waitcnt vmcnt(16)
    v_mfma_f32_16x16x32_bf16 v[80:83], a[80:83], v[136:139], v[80:83]
    ds_read_b128 a[112:115], v6 offset:20480
    buffer_load_dwordx4 v1, s[12:15], s25 offen offset:2048 lds
    s_waitcnt vmcnt(16)
    v_mfma_f32_16x16x32_bf16 v[84:87], a[80:83], v[140:143], v[84:87]
    buffer_load_dwordx4 v[180:183], v1, s[8:11], s38 offen offset:0
    v_mfma_f32_16x16x32_bf16 v[88:91], a[84:87], v[136:139], v[88:91]
    ds_read_b128 a[116:119], v6 offset:21504
    buffer_load_dwordx4 v1, s[12:15], s25 offen offset:3072 lds
    v_mfma_f32_16x16x32_bf16 v[92:95], a[84:87], v[140:143], v[92:95]
    buffer_load_dwordx4 v[184:187], v1, s[8:11], s36 offen offset:1024
    v_mfma_f32_16x16x32_bf16 v[96:99], a[88:91], v[136:139], v[96:99]
    ds_read_b128 a[120:123], v6 offset:22528
    s_add_u32 m0, s20, 45056
    v_mfma_f32_16x16x32_bf16 v[100:103], a[88:91], v[140:143], v[100:103]
    buffer_load_dwordx4 v[188:191], v1, s[8:11], s38 offen offset:1024
    v_mfma_f32_16x16x32_bf16 v[104:107], a[92:95], v[136:139], v[104:107]
    ds_read_b128 a[124:127], v6 offset:23552
    buffer_load_dwordx4 v1, s[12:15], s26 offen offset:0 lds
    v_mfma_f32_16x16x32_bf16 v[108:111], a[92:95], v[140:143], v[108:111]
    buffer_load_dwordx4 v[192:195], v1, s[8:11], s36 offen offset:2048
    s_waitcnt lgkmcnt(4)
    s_waitcnt vmcnt(21)
    v_mfma_f32_16x16x32_bf16 v[80:83], a[96:99], v[144:147], v[80:83]
    ds_read_b128 a[80:83], v6 offset:24576
    s_waitcnt vmcnt(20)
    v_mfma_f32_16x16x32_bf16 v[84:87], a[96:99], v[148:151], v[84:87]
    s_add_u32 s24, s24, 36864
    v_mfma_f32_16x16x32_bf16 v[88:91], a[100:103], v[144:147], v[88:91]
    ds_read_b128 a[84:87], v6 offset:25600
    buffer_load_dwordx4 v[196:199], v1, s[8:11], s38 offen offset:2048
    v_mfma_f32_16x16x32_bf16 v[92:95], a[100:103], v[148:151], v[92:95]
    s_add_u32 s25, s25, 36864
    v_mfma_f32_16x16x32_bf16 v[96:99], a[104:107], v[144:147], v[96:99]
    ds_read_b128 a[88:91], v6 offset:26624
    buffer_load_dwordx4 v[200:203], v1, s[8:11], s36 offen offset:3072
    v_mfma_f32_16x16x32_bf16 v[100:103], a[104:107], v[148:151], v[100:103]
    s_add_u32 s26, s26, 36864
    v_mfma_f32_16x16x32_bf16 v[104:107], a[108:111], v[144:147], v[104:107]
    ds_read_b128 a[92:95], v6 offset:27648
    buffer_load_dwordx4 v[204:207], v1, s[8:11], s38 offen offset:3072
    v_mfma_f32_16x16x32_bf16 v[108:111], a[108:111], v[148:151], v[108:111]
    s_waitcnt lgkmcnt(4)
    s_waitcnt vmcnt(22)
    v_mfma_f32_16x16x32_bf16 v[80:83], a[112:115], v[152:155], v[80:83]
    ds_read_b128 a[96:99], v6 offset:28672
    s_add_u32 s36, s36, 0x1000
    s_waitcnt vmcnt(21)
    v_mfma_f32_16x16x32_bf16 v[84:87], a[112:115], v[156:159], v[84:87]
    v_mfma_f32_16x16x32_bf16 v[88:91], a[116:119], v[152:155], v[88:91]
    ds_read_b128 a[100:103], v6 offset:29696
    s_add_u32 m0, s20, 73728
    v_mfma_f32_16x16x32_bf16 v[92:95], a[116:119], v[156:159], v[92:95]
    s_add_u32 s38, s38, 0x1000
    buffer_load_dwordx4 v1, s[12:15], s24 offen offset:0 lds
    v_mfma_f32_16x16x32_bf16 v[96:99], a[120:123], v[152:155], v[96:99]
    ds_read_b128 a[104:107], v6 offset:30720
    v_mfma_f32_16x16x32_bf16 v[100:103], a[120:123], v[156:159], v[100:103]
    buffer_load_dwordx4 v[208:211], v1, s[8:11], s36 offen offset:0
    buffer_load_dwordx4 v1, s[12:15], s24 offen offset:1024 lds
    v_mfma_f32_16x16x32_bf16 v[104:107], a[124:127], v[152:155], v[104:107]
    ds_read_b128 a[108:111], v6 offset:31744
    v_mfma_f32_16x16x32_bf16 v[108:111], a[124:127], v[156:159], v[108:111]
    buffer_load_dwordx4 v[212:215], v1, s[8:11], s38 offen offset:0
    s_waitcnt lgkmcnt(4)
    s_waitcnt vmcnt(23)
    v_mfma_f32_16x16x32_bf16 v[80:83], a[80:83], v[160:163], v[80:83]
    ds_read_b128 a[112:115], v6 offset:32768
    buffer_load_dwordx4 v1, s[12:15], s24 offen offset:2048 lds
    s_waitcnt vmcnt(22)
    v_mfma_f32_16x16x32_bf16 v[84:87], a[80:83], v[164:167], v[84:87]
    buffer_load_dwordx4 v1, s[12:15], s24 offen offset:3072 lds
    v_mfma_f32_16x16x32_bf16 v[88:91], a[84:87], v[160:163], v[88:91]
    ds_read_b128 a[116:119], v6 offset:33792
    v_mfma_f32_16x16x32_bf16 v[92:95], a[84:87], v[164:167], v[92:95]
    s_add_u32 m0, s20, 77824
    v_mfma_f32_16x16x32_bf16 v[96:99], a[88:91], v[160:163], v[96:99]
    ds_read_b128 a[120:123], v6 offset:34816
    v_mfma_f32_16x16x32_bf16 v[100:103], a[88:91], v[164:167], v[100:103]
    buffer_load_dwordx4 v1, s[12:15], s25 offen offset:0 lds
    v_mfma_f32_16x16x32_bf16 v[104:107], a[92:95], v[160:163], v[104:107]
    ds_read_b128 a[124:127], v6 offset:35840
    v_mfma_f32_16x16x32_bf16 v[108:111], a[92:95], v[164:167], v[108:111]
    buffer_load_dwordx4 v1, s[12:15], s25 offen offset:1024 lds
    s_waitcnt lgkmcnt(4)
    s_waitcnt vmcnt(23)
    v_mfma_f32_16x16x32_bf16 v[80:83], a[96:99], v[168:171], v[80:83]
    s_waitcnt vmcnt(22)
    v_mfma_f32_16x16x32_bf16 v[84:87], a[96:99], v[172:175], v[84:87]
    buffer_load_dwordx4 v1, s[12:15], s25 offen offset:2048 lds
    v_mfma_f32_16x16x32_bf16 v[88:91], a[100:103], v[168:171], v[88:91]
    v_mfma_f32_16x16x32_bf16 v[92:95], a[100:103], v[172:175], v[92:95]
    buffer_load_dwordx4 v1, s[12:15], s25 offen offset:3072 lds
    v_mfma_f32_16x16x32_bf16 v[96:99], a[104:107], v[168:171], v[96:99]
    v_mfma_f32_16x16x32_bf16 v[100:103], a[104:107], v[172:175], v[100:103]
    s_add_u32 m0, s20, 81920
    v_mfma_f32_16x16x32_bf16 v[104:107], a[108:111], v[168:171], v[104:107]
    v_mfma_f32_16x16x32_bf16 v[108:111], a[108:111], v[172:175], v[108:111]
    buffer_load_dwordx4 v1, s[12:15], s26 offen offset:0 lds
    s_waitcnt lgkmcnt(0)
    s_waitcnt vmcnt(21)
    v_mfma_f32_16x16x32_bf16 v[80:83], a[112:115], v[176:179], v[80:83]
    s_waitcnt vmcnt(19)
    v_mfma_f32_16x16x32_bf16 v[84:87], a[112:115], v[180:183], v[84:87]
    s_add_u32 s24, s24, 36864
    v_mfma_f32_16x16x32_bf16 v[88:91], a[116:119], v[176:179], v[88:91]
    v_mfma_f32_16x16x32_bf16 v[92:95], a[116:119], v[180:183], v[92:95]
    s_add_u32 s25, s25, 36864
    v_mfma_f32_16x16x32_bf16 v[96:99], a[120:123], v[176:179], v[96:99]
    v_mfma_f32_16x16x32_bf16 v[100:103], a[120:123], v[180:183], v[100:103]
    s_add_u32 s26, s26, 36864
    v_mfma_f32_16x16x32_bf16 v[104:107], a[124:127], v[176:179], v[104:107]
    v_mfma_f32_16x16x32_bf16 v[108:111], a[124:127], v[180:183], v[108:111]
    s_waitcnt vmcnt(15)
    s_barrier
    ds_read_b128 a[80:83], v7 offset:0
    ds_read_b128 a[84:87], v7 offset:1024
    ds_read_b128 a[88:91], v7 offset:2048
    ds_read_b128 a[92:95], v7 offset:3072
    ds_read_b128 a[96:99], v7 offset:4096
    ds_read_b128 a[100:103], v7 offset:5120
    ds_read_b128 a[104:107], v7 offset:6144
    ds_read_b128 a[108:111], v7 offset:7168
    s_waitcnt lgkmcnt(4)
    v_mfma_f32_16x16x32_bf16 v[80:83], a[80:83], v[184:187], v[80:83]
    ds_read_b128 a[112:115], v7 offset:8192
    buffer_load_dwordx4 v[216:219], v1, s[8:11], s36 offen offset:1024
    v_mfma_f32_16x16x32_bf16 v[84:87], a[80:83], v[188:191], v[84:87]
    buffer_load_dwordx4 v[220:223], v1, s[8:11], s38 offen offset:1024
    v_mfma_f32_16x16x32_bf16 v[88:91], a[84:87], v[184:187], v[88:91]
    ds_read_b128 a[116:119], v7 offset:9216
    buffer_load_dwordx4 v[224:227], v1, s[8:11], s36 offen offset:2048
    v_mfma_f32_16x16x32_bf16 v[92:95], a[84:87], v[188:191], v[92:95]
    v_mfma_f32_16x16x32_bf16 v[96:99], a[88:91], v[184:187], v[96:99]
    ds_read_b128 a[120:123], v7 offset:10240
    buffer_load_dwordx4 v[228:231], v1, s[8:11], s38 offen offset:2048
    v_mfma_f32_16x16x32_bf16 v[100:103], a[88:91], v[188:191], v[100:103]
    s_add_u32 m0, s20, 110592
    buffer_load_dwordx4 v[232:235], v1, s[8:11], s36 offen offset:3072
    v_mfma_f32_16x16x32_bf16 v[104:107], a[92:95], v[184:187], v[104:107]
    ds_read_b128 a[124:127], v7 offset:11264
    buffer_load_dwordx4 v[236:239], v1, s[8:11], s38 offen offset:3072
    v_mfma_f32_16x16x32_bf16 v[108:111], a[92:95], v[188:191], v[108:111]
    buffer_load_dwordx4 v1, s[12:15], s24 offen offset:0 lds
    s_waitcnt lgkmcnt(4)
    s_waitcnt vmcnt(21)
    v_mfma_f32_16x16x32_bf16 v[80:83], a[96:99], v[192:195], v[80:83]
    ds_read_b128 a[80:83], v7 offset:12288
    s_add_u32 s36, s36, 0x1000
    s_waitcnt vmcnt(20)
    v_mfma_f32_16x16x32_bf16 v[84:87], a[96:99], v[196:199], v[84:87]
    buffer_load_dwordx4 v1, s[12:15], s24 offen offset:1024 lds
    s_add_u32 s38, s38, 0x1000
    v_mfma_f32_16x16x32_bf16 v[88:91], a[100:103], v[192:195], v[88:91]
    ds_read_b128 a[84:87], v7 offset:13312
    buffer_load_dwordx4 v[240:243], v1, s[8:11], s36 offen offset:0
    v_mfma_f32_16x16x32_bf16 v[92:95], a[100:103], v[196:199], v[92:95]
    buffer_load_dwordx4 v1, s[12:15], s24 offen offset:2048 lds
    v_mfma_f32_16x16x32_bf16 v[96:99], a[104:107], v[192:195], v[96:99]
    ds_read_b128 a[88:91], v7 offset:14336
    buffer_load_dwordx4 v[244:247], v1, s[8:11], s38 offen offset:0
    v_mfma_f32_16x16x32_bf16 v[100:103], a[104:107], v[196:199], v[100:103]
    buffer_load_dwordx4 v1, s[12:15], s24 offen offset:3072 lds
    buffer_load_dwordx4 v[248:251], v1, s[8:11], s36 offen offset:1024
    v_mfma_f32_16x16x32_bf16 v[104:107], a[108:111], v[192:195], v[104:107]
    ds_read_b128 a[92:95], v7 offset:15360
    buffer_load_dwordx4 v[252:255], v1, s[8:11], s38 offen offset:1024
    v_mfma_f32_16x16x32_bf16 v[108:111], a[108:111], v[196:199], v[108:111]
    s_add_u32 m0, s20, 114688
    s_waitcnt lgkmcnt(4)
    s_waitcnt vmcnt(26)
    v_mfma_f32_16x16x32_bf16 v[80:83], a[112:115], v[200:203], v[80:83]
    ds_read_b128 a[96:99], v7 offset:16384
    buffer_load_dwordx4 v1, s[12:15], s25 offen offset:0 lds
    s_waitcnt vmcnt(26)
    v_mfma_f32_16x16x32_bf16 v[84:87], a[112:115], v[204:207], v[84:87]
    v_mfma_f32_16x16x32_bf16 v[88:91], a[116:119], v[200:203], v[88:91]
    ds_read_b128 a[100:103], v7 offset:17408
    buffer_load_dwordx4 v1, s[12:15], s25 offen offset:1024 lds
    v_mfma_f32_16x16x32_bf16 v[92:95], a[116:119], v[204:207], v[92:95]
    v_mfma_f32_16x16x32_bf16 v[96:99], a[120:123], v[200:203], v[96:99]
    ds_read_b128 a[104:107], v7 offset:18432
    buffer_load_dwordx4 v1, s[12:15], s25 offen offset:2048 lds
    v_mfma_f32_16x16x32_bf16 v[100:103], a[120:123], v[204:207], v[100:103]
    v_mfma_f32_16x16x32_bf16 v[104:107], a[124:127], v[200:203], v[104:107]
    ds_read_b128 a[108:111], v7 offset:19456
    buffer_load_dwordx4 v1, s[12:15], s25 offen offset:3072 lds
    v_mfma_f32_16x16x32_bf16 v[108:111], a[124:127], v[204:207], v[108:111]
    s_waitcnt lgkmcnt(4)
    s_waitcnt vmcnt(27)
    v_mfma_f32_16x16x32_bf16 v[80:83], a[80:83], v[208:211], v[80:83]
    ds_read_b128 a[112:115], v7 offset:20480
    s_add_u32 m0, s20, 118784
    s_waitcnt vmcnt(25)
    v_mfma_f32_16x16x32_bf16 v[84:87], a[80:83], v[212:215], v[84:87]
    v_mfma_f32_16x16x32_bf16 v[88:91], a[84:87], v[208:211], v[88:91]
    ds_read_b128 a[116:119], v7 offset:21504
    buffer_load_dwordx4 v1, s[12:15], s26 offen offset:0 lds
    v_mfma_f32_16x16x32_bf16 v[92:95], a[84:87], v[212:215], v[92:95]
    v_mfma_f32_16x16x32_bf16 v[96:99], a[88:91], v[208:211], v[96:99]
    ds_read_b128 a[120:123], v7 offset:22528
    s_add_u32 s24, s24, 36864
    v_mfma_f32_16x16x32_bf16 v[100:103], a[88:91], v[212:215], v[100:103]
    v_mfma_f32_16x16x32_bf16 v[104:107], a[92:95], v[208:211], v[104:107]
    ds_read_b128 a[124:127], v7 offset:23552
    s_add_u32 s25, s25, 36864
    v_mfma_f32_16x16x32_bf16 v[108:111], a[92:95], v[212:215], v[108:111]
    s_waitcnt lgkmcnt(4)
    s_waitcnt vmcnt(18)
    v_mfma_f32_16x16x32_bf16 v[80:83], a[96:99], v[216:219], v[80:83]
    ds_read_b128 a[80:83], v7 offset:24576
    s_add_u32 s26, s26, 36864
    s_waitcnt vmcnt(17)
    v_mfma_f32_16x16x32_bf16 v[84:87], a[96:99], v[220:223], v[84:87]
    v_mfma_f32_16x16x32_bf16 v[88:91], a[100:103], v[216:219], v[88:91]
    ds_read_b128 a[84:87], v7 offset:25600
    v_mfma_f32_16x16x32_bf16 v[92:95], a[100:103], v[220:223], v[92:95]
    v_mfma_f32_16x16x32_bf16 v[96:99], a[104:107], v[216:219], v[96:99]
    ds_read_b128 a[88:91], v7 offset:26624
    s_add_u32 m0, s20, 0
    v_mfma_f32_16x16x32_bf16 v[100:103], a[104:107], v[220:223], v[100:103]
    v_mfma_f32_16x16x32_bf16 v[104:107], a[108:111], v[216:219], v[104:107]
    ds_read_b128 a[92:95], v7 offset:27648
    buffer_load_dwordx4 v1, s[12:15], s24 offen offset:0 lds
    v_mfma_f32_16x16x32_bf16 v[108:111], a[108:111], v[220:223], v[108:111]
    s_waitcnt lgkmcnt(4)
    s_waitcnt vmcnt(17)
    v_mfma_f32_16x16x32_bf16 v[80:83], a[112:115], v[224:227], v[80:83]
    ds_read_b128 a[96:99], v7 offset:28672
    buffer_load_dwordx4 v1, s[12:15], s24 offen offset:1024 lds
    s_waitcnt vmcnt(17)
    v_mfma_f32_16x16x32_bf16 v[84:87], a[112:115], v[228:231], v[84:87]
    v_mfma_f32_16x16x32_bf16 v[88:91], a[116:119], v[224:227], v[88:91]
    ds_read_b128 a[100:103], v7 offset:29696
    buffer_load_dwordx4 v1, s[12:15], s24 offen offset:2048 lds
    v_mfma_f32_16x16x32_bf16 v[92:95], a[116:119], v[228:231], v[92:95]
    v_mfma_f32_16x16x32_bf16 v[96:99], a[120:123], v[224:227], v[96:99]
    ds_read_b128 a[104:107], v7 offset:30720
    buffer_load_dwordx4 v1, s[12:15], s24 offen offset:3072 lds
    v_mfma_f32_16x16x32_bf16 v[100:103], a[120:123], v[228:231], v[100:103]
    v_mfma_f32_16x16x32_bf16 v[104:107], a[124:127], v[224:227], v[104:107]
    ds_read_b128 a[108:111], v7 offset:31744
    s_add_u32 m0, s20, 4096
    v_mfma_f32_16x16x32_bf16 v[108:111], a[124:127], v[228:231], v[108:111]
    s_waitcnt lgkmcnt(4)
    s_waitcnt vmcnt(18)
    v_mfma_f32_16x16x32_bf16 v[80:83], a[80:83], v[232:235], v[80:83]
    ds_read_b128 a[112:115], v7 offset:32768
    buffer_load_dwordx4 v1, s[12:15], s25 offen offset:0 lds
    s_waitcnt vmcnt(18)
    v_mfma_f32_16x16x32_bf16 v[84:87], a[80:83], v[236:239], v[84:87]
    v_mfma_f32_16x16x32_bf16 v[88:91], a[84:87], v[232:235], v[88:91]
    ds_read_b128 a[116:119], v7 offset:33792
    buffer_load_dwordx4 v1, s[12:15], s25 offen offset:1024 lds
    v_mfma_f32_16x16x32_bf16 v[92:95], a[84:87], v[236:239], v[92:95]
    v_mfma_f32_16x16x32_bf16 v[96:99], a[88:91], v[232:235], v[96:99]
    ds_read_b128 a[120:123], v7 offset:34816
    buffer_load_dwordx4 v1, s[12:15], s25 offen offset:2048 lds
    v_mfma_f32_16x16x32_bf16 v[100:103], a[88:91], v[236:239], v[100:103]
    v_mfma_f32_16x16x32_bf16 v[104:107], a[92:95], v[232:235], v[104:107]
    ds_read_b128 a[124:127], v7 offset:35840
    buffer_load_dwordx4 v1, s[12:15], s25 offen offset:3072 lds
    v_mfma_f32_16x16x32_bf16 v[108:111], a[92:95], v[236:239], v[108:111]
    s_waitcnt lgkmcnt(4)
    s_waitcnt vmcnt(18)
    v_mfma_f32_16x16x32_bf16 v[80:83], a[96:99], v[240:243], v[80:83]
    s_add_u32 m0, s20, 8192
    s_waitcnt vmcnt(16)
    v_mfma_f32_16x16x32_bf16 v[84:87], a[96:99], v[244:247], v[84:87]
    v_mfma_f32_16x16x32_bf16 v[88:91], a[100:103], v[240:243], v[88:91]
    buffer_load_dwordx4 v1, s[12:15], s26 offen offset:0 lds
    v_mfma_f32_16x16x32_bf16 v[92:95], a[100:103], v[244:247], v[92:95]
    v_mfma_f32_16x16x32_bf16 v[96:99], a[104:107], v[240:243], v[96:99]
    s_add_u32 s24, s24, 36864
    v_mfma_f32_16x16x32_bf16 v[100:103], a[104:107], v[244:247], v[100:103]
    v_mfma_f32_16x16x32_bf16 v[104:107], a[108:111], v[240:243], v[104:107]
    s_add_u32 s25, s25, 36864
    v_mfma_f32_16x16x32_bf16 v[108:111], a[108:111], v[244:247], v[108:111]
    s_waitcnt lgkmcnt(0)
    s_waitcnt vmcnt(15)
    v_mfma_f32_16x16x32_bf16 v[80:83], a[112:115], v[248:251], v[80:83]
    s_add_u32 s26, s26, 36864
    s_waitcnt vmcnt(14)
    v_mfma_f32_16x16x32_bf16 v[84:87], a[112:115], v[252:255], v[84:87]
    v_mfma_f32_16x16x32_bf16 v[88:91], a[116:119], v[248:251], v[88:91]
    v_mfma_f32_16x16x32_bf16 v[92:95], a[116:119], v[252:255], v[92:95]
    v_mfma_f32_16x16x32_bf16 v[96:99], a[120:123], v[248:251], v[96:99]
    v_mfma_f32_16x16x32_bf16 v[100:103], a[120:123], v[252:255], v[100:103]
    v_mfma_f32_16x16x32_bf16 v[104:107], a[124:127], v[248:251], v[104:107]
    v_mfma_f32_16x16x32_bf16 v[108:111], a[124:127], v[252:255], v[108:111]
    s_waitcnt vmcnt(9)
    s_barrier
    ds_read_b128 a[80:83], v4 offset:0
    ds_read_b128 a[84:87], v4 offset:1024
    ds_read_b128 a[88:91], v4 offset:2048
    ds_read_b128 a[92:95], v4 offset:3072
    ds_read_b128 a[96:99], v4 offset:4096
    ds_read_b128 a[100:103], v4 offset:5120
    ds_read_b128 a[104:107], v4 offset:6144
    ds_read_b128 a[108:111], v4 offset:7168
.p2align 3
K5_p1_A:
    s_waitcnt lgkmcnt(4)
    v_mfma_f32_16x16x32_bf16 v[48:51], a[80:83], v[112:115], 0
    ds_read_b128 a[112:115], v4 offset:8192
    s_cmp_eq_u32 s30, 40
    s_cselect_b32 s53, s45, s54
    buffer_load_dwordx4 v[20:23], v24, s[8:11], s53 offen sc1
    v_mfma_f32_16x16x32_bf16 v[52:55], a[80:83], v[116:119], 0
    s_add_u32 m0, s20, 36864
    v_mfma_f32_16x16x32_bf16 v[56:59], a[84:87], v[112:115], 0
    ds_read_b128 a[116:119], v4 offset:9216
    v_mfma_f32_16x16x32_bf16 v[60:63], a[84:87], v[116:119], 0
    v_mfma_f32_16x16x32_bf16 v[64:67], a[88:91], v[112:115], 0
    ds_read_b128 a[120:123], v4 offset:10240
    v_mfma_f32_16x16x32_bf16 v[68:71], a[88:91], v[116:119], 0
    buffer_load_dwordx4 v1, s[12:15], s24 offen offset:0 lds
    v_max_f32 v80, 0, v80
    v_mfma_f32_16x16x32_bf16 v[72:75], a[92:95], v[112:115], 0
    ds_read_b128 a[124:127], v4 offset:11264
    v_max_f32 v81, 0, v81
    v_mfma_f32_16x16x32_bf16 v[76:79], a[92:95], v[116:119], 0
    v_max_f32 v82, 0, v82
    s_waitcnt lgkmcnt(4)
    v_mfma_f32_16x16x32_bf16 v[48:51], a[96:99], v[120:123], v[48:51]
    ds_read_b128 a[80:83], v4 offset:12288
    v_max_f32 v83, 0, v83
    v_mfma_f32_16x16x32_bf16 v[52:55], a[96:99], v[124:127], v[52:55]
    buffer_load_dwordx4 v1, s[12:15], s24 offen offset:1024 lds
    v_mul_f32 v80, v80, v96
    v_mfma_f32_16x16x32_bf16 v[56:59], a[100:103], v[120:123], v[56:59]
    ds_read_b128 a[84:87], v4 offset:13312
    v_mfma_f32_16x16x32_bf16 v[60:63], a[100:103], v[124:127], v[60:63]
    v_mul_f32 v81, v81, v97
    v_mfma_f32_16x16x32_bf16 v[64:67], a[104:107], v[120:123], v[64:67]
    ds_read_b128 a[88:91], v4 offset:14336
    v_mul_f32 v82, v82, v98
    v_mfma_f32_16x16x32_bf16 v[68:71], a[104:107], v[124:127], v[68:71]
    buffer_load_dwordx4 v1, s[12:15], s24 offen offset:2048 lds
    v_mul_f32 v83, v83, v99
    v_mfma_f32_16x16x32_bf16 v[72:75], a[108:111], v[120:123], v[72:75]
    ds_read_b128 a[92:95], v4 offset:15360
    v_cvt_pk_bf16_f32 v8, v80, v81
    v_mfma_f32_16x16x32_bf16 v[76:79], a[108:111], v[124:127], v[76:79]
    v_cvt_pk_bf16_f32 v9, v82, v83
    s_waitcnt lgkmcnt(4)
    v_mfma_f32_16x16x32_bf16 v[48:51], a[112:115], v[128:131], v[48:51]
    ds_read_b128 a[96:99], v4 offset:16384
    v_mfma_f32_16x16x32_bf16 v[52:55], a[112:115], v[132:135], v[52:55]
    buffer_load_dwordx4 v1, s[12:15], s24 offen offset:3072 lds
    v_max_f32 v88, 0, v88
    v_mfma_f32_16x16x32_bf16 v[56:59], a[116:119], v[128:131], v[56:59]
    ds_read_b128 a[100:103], v4 offset:17408
    v_max_f32 v89, 0, v89
    v_mfma_f32_16x16x32_bf16 v[60:63], a[116:119], v[132:135], v[60:63]
    v_max_f32 v90, 0, v90
    v_mfma_f32_16x16x32_bf16 v[64:67], a[120:123], v[128:131], v[64:67]
    ds_read_b128 a[104:107], v4 offset:18432
    v_max_f32 v91, 0, v91
    v_mfma_f32_16x16x32_bf16 v[68:71], a[120:123], v[132:135], v[68:71]
    s_add_u32 m0, s20, 40960
    v_mfma_f32_16x16x32_bf16 v[72:75], a[124:127], v[128:131], v[72:75]
    ds_read_b128 a[108:111], v4 offset:19456
    v_mul_f32 v88, v88, v104
    v_mfma_f32_16x16x32_bf16 v[76:79], a[124:127], v[132:135], v[76:79]
    v_mul_f32 v89, v89, v105
    s_waitcnt lgkmcnt(4)
    v_mfma_f32_16x16x32_bf16 v[48:51], a[80:83], v[136:139], v[48:51]
    ds_read_b128 a[112:115], v4 offset:20480
    v_mul_f32 v90, v90, v106
    v_mfma_f32_16x16x32_bf16 v[52:55], a[80:83], v[140:143], v[52:55]
    buffer_load_dwordx4 v1, s[12:15], s25 offen offset:0 lds
    v_mul_f32 v91, v91, v107
    v_mfma_f32_16x16x32_bf16 v[56:59], a[84:87], v[136:139], v[56:59]
    ds_read_b128 a[116:119], v4 offset:21504
    v_cvt_pk_bf16_f32 v10, v88, v89
    v_mfma_f32_16x16x32_bf16 v[60:63], a[84:87], v[140:143], v[60:63]
    v_mfma_f32_16x16x32_bf16 v[64:67], a[88:91], v[136:139], v[64:67]
    ds_read_b128 a[120:123], v4 offset:22528
    v_cvt_pk_bf16_f32 v11, v90, v91
    v_mfma_f32_16x16x32_bf16 v[68:71], a[88:91], v[140:143], v[68:71]
    buffer_load_dwordx4 v1, s[12:15], s25 offen offset:1024 lds
    buffer_store_dwordx4 v[8:11], v1, s[8:11], s41 offen offset:0 sc1
    v_mfma_f32_16x16x32_bf16 v[72:75], a[92:95], v[136:139], v[72:75]
    ds_read_b128 a[124:127], v4 offset:23552
    v_max_f32 v84, 0, v84
    v_mfma_f32_16x16x32_bf16 v[76:79], a[92:95], v[140:143], v[76:79]
    v_max_f32 v85, 0, v85
    s_waitcnt lgkmcnt(4)
    v_mfma_f32_16x16x32_bf16 v[48:51], a[96:99], v[144:147], v[48:51]
    ds_read_b128 a[80:83], v4 offset:24576
    v_max_f32 v86, 0, v86
    v_mfma_f32_16x16x32_bf16 v[52:55], a[96:99], v[148:151], v[52:55]
    buffer_load_dwordx4 v1, s[12:15], s25 offen offset:2048 lds
    v_mfma_f32_16x16x32_bf16 v[56:59], a[100:103], v[144:147], v[56:59]
    ds_read_b128 a[84:87], v4 offset:25600
    v_max_f32 v87, 0, v87
    v_mfma_f32_16x16x32_bf16 v[60:63], a[100:103], v[148:151], v[60:63]
    v_mul_f32 v84, v84, v100
    v_mfma_f32_16x16x32_bf16 v[64:67], a[104:107], v[144:147], v[64:67]
    ds_read_b128 a[88:91], v4 offset:26624
    v_mul_f32 v85, v85, v101
    v_mfma_f32_16x16x32_bf16 v[68:71], a[104:107], v[148:151], v[68:71]
    buffer_load_dwordx4 v1, s[12:15], s25 offen offset:3072 lds
    v_mul_f32 v86, v86, v102
    v_mfma_f32_16x16x32_bf16 v[72:75], a[108:111], v[144:147], v[72:75]
    ds_read_b128 a[92:95], v4 offset:27648
    v_mfma_f32_16x16x32_bf16 v[76:79], a[108:111], v[148:151], v[76:79]
    v_mul_f32 v87, v87, v103
    s_waitcnt lgkmcnt(4)
    v_mfma_f32_16x16x32_bf16 v[48:51], a[112:115], v[152:155], v[48:51]
    ds_read_b128 a[96:99], v4 offset:28672
    v_cvt_pk_bf16_f32 v12, v84, v85
    v_mfma_f32_16x16x32_bf16 v[52:55], a[112:115], v[156:159], v[52:55]
    s_add_u32 m0, s20, 45056
    v_cvt_pk_bf16_f32 v13, v86, v87
    v_mfma_f32_16x16x32_bf16 v[56:59], a[116:119], v[152:155], v[56:59]
    ds_read_b128 a[100:103], v4 offset:29696
    v_max_f32 v92, 0, v92
    v_mfma_f32_16x16x32_bf16 v[60:63], a[116:119], v[156:159], v[60:63]
    v_max_f32 v93, 0, v93
    v_mfma_f32_16x16x32_bf16 v[64:67], a[120:123], v[152:155], v[64:67]
    ds_read_b128 a[104:107], v4 offset:30720
    v_mfma_f32_16x16x32_bf16 v[68:71], a[120:123], v[156:159], v[68:71]
    buffer_load_dwordx4 v1, s[12:15], s26 offen offset:0 lds
    v_max_f32 v94, 0, v94
    v_mfma_f32_16x16x32_bf16 v[72:75], a[124:127], v[152:155], v[72:75]
    ds_read_b128 a[108:111], v4 offset:31744
    v_max_f32 v95, 0, v95
    v_mfma_f32_16x16x32_bf16 v[76:79], a[124:127], v[156:159], v[76:79]
    v_mul_f32 v92, v92, v108
    s_waitcnt lgkmcnt(4)
    v_mfma_f32_16x16x32_bf16 v[48:51], a[80:83], v[160:163], v[48:51]
    ds_read_b128 a[112:115], v4 offset:32768
    v_mul_f32 v93, v93, v109
    v_mfma_f32_16x16x32_bf16 v[52:55], a[80:83], v[164:167], v[52:55]
    v_mul_f32 v94, v94, v110
    v_mfma_f32_16x16x32_bf16 v[56:59], a[84:87], v[160:163], v[56:59]
    ds_read_b128 a[116:119], v4 offset:33792
    v_mfma_f32_16x16x32_bf16 v[60:63], a[84:87], v[164:167], v[60:63]
    s_add_u32 s24, s24, 36864
    s_add_u32 s25, s25, 36864
    v_mfma_f32_16x16x32_bf16 v[64:67], a[88:91], v[160:163], v[64:67]
    ds_read_b128 a[120:123], v4 offset:34816
    s_add_u32 s26, s26, 36864
    v_mfma_f32_16x16x32_bf16 v[68:71], a[88:91], v[164:167], v[68:71]
    v_mul_f32 v95, v95, v111
    v_cvt_pk_bf16_f32 v14, v92, v93
    v_mfma_f32_16x16x32_bf16 v[72:75], a[92:95], v[160:163], v[72:75]
    ds_read_b128 a[124:127], v4 offset:35840
    v_cvt_pk_bf16_f32 v15, v94, v95
    v_mfma_f32_16x16x32_bf16 v[76:79], a[92:95], v[164:167], v[76:79]
    buffer_store_dwordx4 v[12:15], v1, s[8:11], s41 offen offset:1024 sc1
    s_waitcnt lgkmcnt(4)
    v_mfma_f32_16x16x32_bf16 v[48:51], a[96:99], v[168:171], v[48:51]
    ds_read_b128 a[80:83], v5 offset:0
    v_mfma_f32_16x16x32_bf16 v[52:55], a[96:99], v[172:175], v[52:55]
    s_set_gpr_idx_on s30, gpr_idx(DST)
    v_accvgpr_write_b32 a0, v8
    v_accvgpr_write_b32 a1, v9
    s_set_gpr_idx_off
    v_mfma_f32_16x16x32_bf16 v[56:59], a[100:103], v[168:171], v[56:59]
    ds_read_b128 a[84:87], v5 offset:1024
    v_mfma_f32_16x16x32_bf16 v[60:63], a[100:103], v[172:175], v[60:63]
    s_set_gpr_idx_on s30, gpr_idx(DST)
    v_accvgpr_write_b32 a2, v10
    v_accvgpr_write_b32 a3, v11
    s_set_gpr_idx_off
    v_mfma_f32_16x16x32_bf16 v[64:67], a[104:107], v[168:171], v[64:67]
    ds_read_b128 a[88:91], v5 offset:2048
    v_mfma_f32_16x16x32_bf16 v[68:71], a[104:107], v[172:175], v[68:71]
    s_set_gpr_idx_on s30, gpr_idx(DST)
    v_accvgpr_write_b32 a4, v12
    v_accvgpr_write_b32 a5, v13
    s_set_gpr_idx_off
    v_mfma_f32_16x16x32_bf16 v[72:75], a[108:111], v[168:171], v[72:75]
    ds_read_b128 a[92:95], v5 offset:3072
    v_mfma_f32_16x16x32_bf16 v[76:79], a[108:111], v[172:175], v[76:79]
    s_waitcnt lgkmcnt(4)
    v_mfma_f32_16x16x32_bf16 v[48:51], a[112:115], v[176:179], v[48:51]
    ds_read_b128 a[96:99], v5 offset:4096
    s_set_gpr_idx_on s30, gpr_idx(DST)
    v_accvgpr_write_b32 a6, v14
    v_accvgpr_write_b32 a7, v15
    s_set_gpr_idx_off
    v_mfma_f32_16x16x32_bf16 v[52:55], a[112:115], v[180:183], v[52:55]
    v_mfma_f32_16x16x32_bf16 v[56:59], a[116:119], v[176:179], v[56:59]
    ds_read_b128 a[100:103], v5 offset:5120
    s_add_u32 s30, s30, 8
    v_mfma_f32_16x16x32_bf16 v[60:63], a[116:119], v[180:183], v[60:63]
    v_mfma_f32_16x16x32_bf16 v[64:67], a[120:123], v[176:179], v[64:67]
    ds_read_b128 a[104:107], v5 offset:6144
    s_add_u32 s41, s41, 0x800
    v_mfma_f32_16x16x32_bf16 v[68:71], a[120:123], v[180:183], v[68:71]
    v_mfma_f32_16x16x32_bf16 v[72:75], a[124:127], v[176:179], v[72:75]
    ds_read_b128 a[108:111], v5 offset:7168
    v_mfma_f32_16x16x32_bf16 v[76:79], a[124:127], v[180:183], v[76:79]
    s_waitcnt vmcnt(12)
    s_barrier
    s_waitcnt lgkmcnt(4)
    v_mfma_f32_16x16x32_bf16 v[48:51], a[80:83], v[184:187], v[48:51]
    ds_read_b128 a[112:115], v5 offset:8192
    v_mfma_f32_16x16x32_bf16 v[52:55], a[80:83], v[188:191], v[52:55]
    s_add_u32 m0, s20, 73728
    v_mfma_f32_16x16x32_bf16 v[56:59], a[84:87], v[184:187], v[56:59]
    ds_read_b128 a[116:119], v5 offset:9216
    v_mfma_f32_16x16x32_bf16 v[60:63], a[84:87], v[188:191], v[60:63]
    v_mfma_f32_16x16x32_bf16 v[64:67], a[88:91], v[184:187], v[64:67]
    ds_read_b128 a[120:123], v5 offset:10240
    v_mfma_f32_16x16x32_bf16 v[68:71], a[88:91], v[188:191], v[68:71]
    buffer_load_dwordx4 v1, s[12:15], s24 offen offset:0 lds
    v_mfma_f32_16x16x32_bf16 v[72:75], a[92:95], v[184:187], v[72:75]
    ds_read_b128 a[124:127], v5 offset:11264
    v_mfma_f32_16x16x32_bf16 v[76:79], a[92:95], v[188:191], v[76:79]
    s_waitcnt lgkmcnt(4)
    v_mfma_f32_16x16x32_bf16 v[48:51], a[96:99], v[192:195], v[48:51]
    ds_read_b128 a[80:83], v5 offset:12288
    v_mfma_f32_16x16x32_bf16 v[52:55], a[96:99], v[196:199], v[52:55]
    buffer_load_dwordx4 v1, s[12:15], s24 offen offset:1024 lds
    v_mfma_f32_16x16x32_bf16 v[56:59], a[100:103], v[192:195], v[56:59]
    ds_read_b128 a[84:87], v5 offset:13312
    v_mfma_f32_16x16x32_bf16 v[60:63], a[100:103], v[196:199], v[60:63]
    v_mfma_f32_16x16x32_bf16 v[64:67], a[104:107], v[192:195], v[64:67]
    ds_read_b128 a[88:91], v5 offset:14336
    v_mfma_f32_16x16x32_bf16 v[68:71], a[104:107], v[196:199], v[68:71]
    buffer_load_dwordx4 v1, s[12:15], s24 offen offset:2048 lds
    v_mfma_f32_16x16x32_bf16 v[72:75], a[108:111], v[192:195], v[72:75]
    ds_read_b128 a[92:95], v5 offset:15360
    v_mfma_f32_16x16x32_bf16 v[76:79], a[108:111], v[196:199], v[76:79]
    s_waitcnt lgkmcnt(4)
    v_mfma_f32_16x16x32_bf16 v[48:51], a[112:115], v[200:203], v[48:51]
    ds_read_b128 a[96:99], v5 offset:16384
    v_mfma_f32_16x16x32_bf16 v[52:55], a[112:115], v[204:207], v[52:55]
    buffer_load_dwordx4 v1, s[12:15], s24 offen offset:3072 lds
    v_mfma_f32_16x16x32_bf16 v[56:59], a[116:119], v[200:203], v[56:59]
    ds_read_b128 a[100:103], v5 offset:17408
    v_mfma_f32_16x16x32_bf16 v[60:63], a[116:119], v[204:207], v[60:63]
    v_mfma_f32_16x16x32_bf16 v[64:67], a[120:123], v[200:203], v[64:67]
    ds_read_b128 a[104:107], v5 offset:18432
    v_mfma_f32_16x16x32_bf16 v[68:71], a[120:123], v[204:207], v[68:71]
    s_add_u32 m0, s20, 77824
    v_mfma_f32_16x16x32_bf16 v[72:75], a[124:127], v[200:203], v[72:75]
    ds_read_b128 a[108:111], v5 offset:19456
    v_mfma_f32_16x16x32_bf16 v[76:79], a[124:127], v[204:207], v[76:79]
    s_waitcnt lgkmcnt(4)
    v_mfma_f32_16x16x32_bf16 v[48:51], a[80:83], v[208:211], v[48:51]
    ds_read_b128 a[112:115], v5 offset:20480
    v_mfma_f32_16x16x32_bf16 v[52:55], a[80:83], v[212:215], v[52:55]
    buffer_load_dwordx4 v1, s[12:15], s25 offen offset:0 lds
    v_mfma_f32_16x16x32_bf16 v[56:59], a[84:87], v[208:211], v[56:59]
    ds_read_b128 a[116:119], v5 offset:21504
    v_mfma_f32_16x16x32_bf16 v[60:63], a[84:87], v[212:215], v[60:63]
    v_mfma_f32_16x16x32_bf16 v[64:67], a[88:91], v[208:211], v[64:67]
    ds_read_b128 a[120:123], v5 offset:22528
    v_mfma_f32_16x16x32_bf16 v[68:71], a[88:91], v[212:215], v[68:71]
    buffer_load_dwordx4 v1, s[12:15], s25 offen offset:1024 lds
    v_mfma_f32_16x16x32_bf16 v[72:75], a[92:95], v[208:211], v[72:75]
    ds_read_b128 a[124:127], v5 offset:23552
    v_mfma_f32_16x16x32_bf16 v[76:79], a[92:95], v[212:215], v[76:79]
    s_waitcnt lgkmcnt(4)
    v_mfma_f32_16x16x32_bf16 v[48:51], a[96:99], v[216:219], v[48:51]
    ds_read_b128 a[80:83], v5 offset:24576
    v_mfma_f32_16x16x32_bf16 v[52:55], a[96:99], v[220:223], v[52:55]
    buffer_load_dwordx4 v1, s[12:15], s25 offen offset:2048 lds
    v_mfma_f32_16x16x32_bf16 v[56:59], a[100:103], v[216:219], v[56:59]
    ds_read_b128 a[84:87], v5 offset:25600
    v_mfma_f32_16x16x32_bf16 v[60:63], a[100:103], v[220:223], v[60:63]
    v_mfma_f32_16x16x32_bf16 v[64:67], a[104:107], v[216:219], v[64:67]
    ds_read_b128 a[88:91], v5 offset:26624
    v_mfma_f32_16x16x32_bf16 v[68:71], a[104:107], v[220:223], v[68:71]
    buffer_load_dwordx4 v1, s[12:15], s25 offen offset:3072 lds
    v_mfma_f32_16x16x32_bf16 v[72:75], a[108:111], v[216:219], v[72:75]
    ds_read_b128 a[92:95], v5 offset:27648
    v_mfma_f32_16x16x32_bf16 v[76:79], a[108:111], v[220:223], v[76:79]
    s_waitcnt lgkmcnt(4)
    v_mfma_f32_16x16x32_bf16 v[48:51], a[112:115], v[224:227], v[48:51]
    ds_read_b128 a[96:99], v5 offset:28672
    v_mfma_f32_16x16x32_bf16 v[52:55], a[112:115], v[228:231], v[52:55]
    s_add_u32 m0, s20, 81920
    v_mfma_f32_16x16x32_bf16 v[56:59], a[116:119], v[224:227], v[56:59]
    ds_read_b128 a[100:103], v5 offset:29696
    v_mfma_f32_16x16x32_bf16 v[60:63], a[116:119], v[228:231], v[60:63]
    v_mfma_f32_16x16x32_bf16 v[64:67], a[120:123], v[224:227], v[64:67]
    ds_read_b128 a[104:107], v5 offset:30720
    v_mfma_f32_16x16x32_bf16 v[68:71], a[120:123], v[228:231], v[68:71]
    buffer_load_dwordx4 v1, s[12:15], s26 offen offset:0 lds
    v_mfma_f32_16x16x32_bf16 v[72:75], a[124:127], v[224:227], v[72:75]
    ds_read_b128 a[108:111], v5 offset:31744
    v_mfma_f32_16x16x32_bf16 v[76:79], a[124:127], v[228:231], v[76:79]
    s_waitcnt lgkmcnt(4)
    v_mfma_f32_16x16x32_bf16 v[48:51], a[80:83], v[232:235], v[48:51]
    ds_read_b128 a[112:115], v5 offset:32768
    v_mfma_f32_16x16x32_bf16 v[52:55], a[80:83], v[236:239], v[52:55]
    v_mfma_f32_16x16x32_bf16 v[56:59], a[84:87], v[232:235], v[56:59]
    ds_read_b128 a[116:119], v5 offset:33792
    v_mfma_f32_16x16x32_bf16 v[60:63], a[84:87], v[236:239], v[60:63]
    s_add_u32 s24, s24, 36864
    s_add_u32 s25, s25, 36864
    v_mfma_f32_16x16x32_bf16 v[64:67], a[88:91], v[232:235], v[64:67]
    ds_read_b128 a[120:123], v5 offset:34816
    s_add_u32 s26, s26, 36864
    v_mfma_f32_16x16x32_bf16 v[68:71], a[88:91], v[236:239], v[68:71]
    v_mfma_f32_16x16x32_bf16 v[72:75], a[92:95], v[232:235], v[72:75]
    ds_read_b128 a[124:127], v5 offset:35840
    v_mfma_f32_16x16x32_bf16 v[76:79], a[92:95], v[236:239], v[76:79]
    s_waitcnt lgkmcnt(4)
    v_mfma_f32_16x16x32_bf16 v[48:51], a[96:99], v[240:243], v[48:51]
    ds_read_b128 a[80:83], v6 offset:0
    v_mfma_f32_16x16x32_bf16 v[52:55], a[96:99], v[244:247], v[52:55]
    v_mfma_f32_16x16x32_bf16 v[56:59], a[100:103], v[240:243], v[56:59]
    ds_read_b128 a[84:87], v6 offset:1024
    v_mfma_f32_16x16x32_bf16 v[60:63], a[100:103], v[244:247], v[60:63]
    v_mfma_f32_16x16x32_bf16 v[64:67], a[104:107], v[240:243], v[64:67]
    ds_read_b128 a[88:91], v6 offset:2048
    v_mfma_f32_16x16x32_bf16 v[68:71], a[104:107], v[244:247], v[68:71]
    v_mfma_f32_16x16x32_bf16 v[72:75], a[108:111], v[240:243], v[72:75]
    ds_read_b128 a[92:95], v6 offset:3072
    v_mfma_f32_16x16x32_bf16 v[76:79], a[108:111], v[244:247], v[76:79]
    s_waitcnt lgkmcnt(4)
    v_mfma_f32_16x16x32_bf16 v[48:51], a[112:115], v[248:251], v[48:51]
    ds_read_b128 a[96:99], v6 offset:4096
    v_mfma_f32_16x16x32_bf16 v[52:55], a[112:115], v[252:255], v[52:55]
    v_mfma_f32_16x16x32_bf16 v[56:59], a[116:119], v[248:251], v[56:59]
    ds_read_b128 a[100:103], v6 offset:5120
    v_mfma_f32_16x16x32_bf16 v[60:63], a[116:119], v[252:255], v[60:63]
    v_mfma_f32_16x16x32_bf16 v[64:67], a[120:123], v[248:251], v[64:67]
    ds_read_b128 a[104:107], v6 offset:6144
    v_mfma_f32_16x16x32_bf16 v[68:71], a[120:123], v[252:255], v[68:71]
    v_mfma_f32_16x16x32_bf16 v[72:75], a[124:127], v[248:251], v[72:75]
    ds_read_b128 a[108:111], v6 offset:7168
    v_mfma_f32_16x16x32_bf16 v[76:79], a[124:127], v[252:255], v[76:79]
    s_waitcnt vmcnt(9)
    s_barrier
    s_cmp_eq_u32 s30, 48
    s_cbranch_scc1 K5_p1_x
    s_waitcnt lgkmcnt(4)
    v_mfma_f32_16x16x32_bf16 v[80:83], a[80:83], v[112:115], 0
    ds_read_b128 a[112:115], v6 offset:8192
    s_cmp_eq_u32 s30, 32
    s_cselect_b32 s52, s46, s54
    buffer_store_dword v19, v18, s[8:11], s52 offen sc1
    v_mfma_f32_16x16x32_bf16 v[84:87], a[80:83], v[116:119], 0
    s_add_u32 m0, s20, 110592
    v_mfma_f32_16x16x32_bf16 v[88:91], a[84:87], v[112:115], 0
    ds_read_b128 a[116:119], v6 offset:9216
    v_mfma_f32_16x16x32_bf16 v[92:95], a[84:87], v[116:119], 0
    v_mfma_f32_16x16x32_bf16 v[96:99], a[88:91], v[112:115], 0
    ds_read_b128 a[120:123], v6 offset:10240
    v_mfma_f32_16x16x32_bf16 v[100:103], a[88:91], v[116:119], 0
    buffer_load_dwordx4 v1, s[12:15], s24 offen offset:0 lds
    v_max_f32 v48, 0, v48
    v_mfma_f32_16x16x32_bf16 v[104:107], a[92:95], v[112:115], 0
    ds_read_b128 a[124:127], v6 offset:11264
    v_max_f32 v49, 0, v49
    v_mfma_f32_16x16x32_bf16 v[108:111], a[92:95], v[116:119], 0
    v_max_f32 v50, 0, v50
    s_waitcnt lgkmcnt(4)
    v_mfma_f32_16x16x32_bf16 v[80:83], a[96:99], v[120:123], v[80:83]
    ds_read_b128 a[80:83], v6 offset:12288
    v_max_f32 v51, 0, v51
    v_mfma_f32_16x16x32_bf16 v[84:87], a[96:99], v[124:127], v[84:87]
    buffer_load_dwordx4 v1, s[12:15], s24 offen offset:1024 lds
    v_mul_f32 v48, v48, v64
    v_mfma_f32_16x16x32_bf16 v[88:91], a[100:103], v[120:123], v[88:91]
    ds_read_b128 a[84:87], v6 offset:13312
    v_mfma_f32_16x16x32_bf16 v[92:95], a[100:103], v[124:127], v[92:95]
    v_mul_f32 v49, v49, v65
    v_mfma_f32_16x16x32_bf16 v[96:99], a[104:107], v[120:123], v[96:99]
    ds_read_b128 a[88:91], v6 offset:14336
    v_mul_f32 v50, v50, v66
    v_mfma_f32_16x16x32_bf16 v[100:103], a[104:107], v[124:127], v[100:103]
    buffer_load_dwordx4 v1, s[12:15], s24 offen offset:2048 lds
    v_mul_f32 v51, v51, v67
    v_mfma_f32_16x16x32_bf16 v[104:107], a[108:111], v[120:123], v[104:107]
    ds_read_b128 a[92:95], v6 offset:15360
    v_cvt_pk_bf16_f32 v8, v48, v49
    v_mfma_f32_16x16x32_bf16 v[108:111], a[108:111], v[124:127], v[108:111]
    v_cvt_pk_bf16_f32 v9, v50, v51
    s_waitcnt lgkmcnt(4)
    v_mfma_f32_16x16x32_bf16 v[80:83], a[112:115], v[128:131], v[80:83]
    ds_read_b128 a[96:99], v6 offset:16384
    v_mfma_f32_16x16x32_bf16 v[84:87], a[112:115], v[132:135], v[84:87]
    buffer_load_dwordx4 v1, s[12:15], s24 offen offset:3072 lds
    v_max_f32 v56, 0, v56
    v_mfma_f32_16x16x32_bf16 v[88:91], a[116:119], v[128:131], v[88:91]
    ds_read_b128 a[100:103], v6 offset:17408
    v_max_f32 v57, 0, v57
    v_mfma_f32_16x16x32_bf16 v[92:95], a[116:119], v[132:135], v[92:95]
    v_max_f32 v58, 0, v58
    v_mfma_f32_16x16x32_bf16 v[96:99], a[120:123], v[128:131], v[96:99]
    ds_read_b128 a[104:107], v6 offset:18432
    v_max_f32 v59, 0, v59
    v_mfma_f32_16x16x32_bf16 v[100:103], a[120:123], v[132:135], v[100:103]
    s_add_u32 m0, s20, 114688
    v_mfma_f32_16x16x32_bf16 v[104:107], a[124:127], v[128:131], v[104:107]
    ds_read_b128 a[108:111], v6 offset:19456
    v_mul_f32 v56, v56, v72
    v_mfma_f32_16x16x32_bf16 v[108:111], a[124:127], v[132:135], v[108:111]
    v_mul_f32 v57, v57, v73
    s_waitcnt lgkmcnt(4)
    v_mfma_f32_16x16x32_bf16 v[80:83], a[80:83], v[136:139], v[80:83]
    ds_read_b128 a[112:115], v6 offset:20480
    v_mul_f32 v58, v58, v74
    v_mfma_f32_16x16x32_bf16 v[84:87], a[80:83], v[140:143], v[84:87]
    buffer_load_dwordx4 v1, s[12:15], s25 offen offset:0 lds
    v_mul_f32 v59, v59, v75
    v_mfma_f32_16x16x32_bf16 v[88:91], a[84:87], v[136:139], v[88:91]
    ds_read_b128 a[116:119], v6 offset:21504
    v_cvt_pk_bf16_f32 v10, v56, v57
    v_mfma_f32_16x16x32_bf16 v[92:95], a[84:87], v[140:143], v[92:95]
    v_mfma_f32_16x16x32_bf16 v[96:99], a[88:91], v[136:139], v[96:99]
    ds_read_b128 a[120:123], v6 offset:22528
    v_cvt_pk_bf16_f32 v11, v58, v59
    v_mfma_f32_16x16x32_bf16 v[100:103], a[88:91], v[140:143], v[100:103]
    buffer_load_dwordx4 v1, s[12:15], s25 offen offset:1024 lds
    buffer_store_dwordx4 v[8:11], v1, s[8:11], s41 offen offset:0 sc1
    v_mfma_f32_16x16x32_bf16 v[104:107], a[92:95], v[136:139], v[104:107]
    ds_read_b128 a[124:127], v6 offset:23552
    v_max_f32 v52, 0, v52
    v_mfma_f32_16x16x32_bf16 v[108:111], a[92:95], v[140:143], v[108:111]
    v_max_f32 v53, 0, v53
    s_waitcnt lgkmcnt(4)
    v_mfma_f32_16x16x32_bf16 v[80:83], a[96:99], v[144:147], v[80:83]
    ds_read_b128 a[80:83], v6 offset:24576
    v_max_f32 v54, 0, v54
    v_mfma_f32_16x16x32_bf16 v[84:87], a[96:99], v[148:151], v[84:87]
    buffer_load_dwordx4 v1, s[12:15], s25 offen offset:2048 lds
    v_mfma_f32_16x16x32_bf16 v[88:91], a[100:103], v[144:147], v[88:91]
    ds_read_b128 a[84:87], v6 offset:25600
    v_max_f32 v55, 0, v55
    v_mfma_f32_16x16x32_bf16 v[92:95], a[100:103], v[148:151], v[92:95]
    v_mul_f32 v52, v52, v68
    v_mfma_f32_16x16x32_bf16 v[96:99], a[104:107], v[144:147], v[96:99]
    ds_read_b128 a[88:91], v6 offset:26624
    v_mul_f32 v53, v53, v69
    v_mfma_f32_16x16x32_bf16 v[100:103], a[104:107], v[148:151], v[100:103]
    buffer_load_dwordx4 v1, s[12:15], s25 offen offset:3072 lds
    v_mul_f32 v54, v54, v70
    v_mfma_f32_16x16x32_bf16 v[104:107], a[108:111], v[144:147], v[104:107]
    ds_read_b128 a[92:95], v6 offset:27648
    v_mfma_f32_16x16x32_bf16 v[108:111], a[108:111], v[148:151], v[108:111]
    v_mul_f32 v55, v55, v71
    s_waitcnt lgkmcnt(4)
    v_mfma_f32_16x16x32_bf16 v[80:83], a[112:115], v[152:155], v[80:83]
    ds_read_b128 a[96:99], v6 offset:28672
    v_cvt_pk_bf16_f32 v12, v52, v53
    v_mfma_f32_16x16x32_bf16 v[84:87], a[112:115], v[156:159], v[84:87]
    s_add_u32 m0, s20, 118784
    v_cvt_pk_bf16_f32 v13, v54, v55
    v_mfma_f32_16x16x32_bf16 v[88:91], a[116:119], v[152:155], v[88:91]
    ds_read_b128 a[100:103], v6 offset:29696
    v_max_f32 v60, 0, v60
    v_mfma_f32_16x16x32_bf16 v[92:95], a[116:119], v[156:159], v[92:95]
    v_max_f32 v61, 0, v61
    v_mfma_f32_16x16x32_bf16 v[96:99], a[120:123], v[152:155], v[96:99]
    ds_read_b128 a[104:107], v6 offset:30720
    v_mfma_f32_16x16x32_bf16 v[100:103], a[120:123], v[156:159], v[100:103]
    buffer_load_dwordx4 v1, s[12:15], s26 offen offset:0 lds
    v_max_f32 v62, 0, v62
    v_mfma_f32_16x16x32_bf16 v[104:107], a[124:127], v[152:155], v[104:107]
    ds_read_b128 a[108:111], v6 offset:31744
    v_max_f32 v63, 0, v63
    v_mfma_f32_16x16x32_bf16 v[108:111], a[124:127], v[156:159], v[108:111]
    v_mul_f32 v60, v60, v76
    s_waitcnt lgkmcnt(4)
    v_mfma_f32_16x16x32_bf16 v[80:83], a[80:83], v[160:163], v[80:83]
    ds_read_b128 a[112:115], v6 offset:32768
    v_mul_f32 v61, v61, v77
    v_mfma_f32_16x16x32_bf16 v[84:87], a[80:83], v[164:167], v[84:87]
    v_mul_f32 v62, v62, v78
    v_mfma_f32_16x16x32_bf16 v[88:91], a[84:87], v[160:163], v[88:91]
    ds_read_b128 a[116:119], v6 offset:33792
    v_mfma_f32_16x16x32_bf16 v[92:95], a[84:87], v[164:167], v[92:95]
    s_add_u32 s24, s24, 36864
    s_add_u32 s25, s25, 36864
    v_mfma_f32_16x16x32_bf16 v[96:99], a[88:91], v[160:163], v[96:99]
    ds_read_b128 a[120:123], v6 offset:34816
    s_add_u32 s26, s26, 36864
    v_mfma_f32_16x16x32_bf16 v[100:103], a[88:91], v[164:167], v[100:103]
    v_mul_f32 v63, v63, v79
    v_cvt_pk_bf16_f32 v14, v60, v61
    v_mfma_f32_16x16x32_bf16 v[104:107], a[92:95], v[160:163], v[104:107]
    ds_read_b128 a[124:127], v6 offset:35840
    v_cvt_pk_bf16_f32 v15, v62, v63
    v_mfma_f32_16x16x32_bf16 v[108:111], a[92:95], v[164:167], v[108:111]
    buffer_store_dwordx4 v[12:15], v1, s[8:11], s41 offen offset:1024 sc1
    s_waitcnt lgkmcnt(4)
    v_mfma_f32_16x16x32_bf16 v[80:83], a[96:99], v[168:171], v[80:83]
    ds_read_b128 a[80:83], v7 offset:0
    v_mfma_f32_16x16x32_bf16 v[84:87], a[96:99], v[172:175], v[84:87]
    s_set_gpr_idx_on s30, gpr_idx(DST)
    v_accvgpr_write_b32 a0, v8
    v_accvgpr_write_b32 a1, v9
    s_set_gpr_idx_off
    v_mfma_f32_16x16x32_bf16 v[88:91], a[100:103], v[168:171], v[88:91]
    ds_read_b128 a[84:87], v7 offset:1024
    v_mfma_f32_16x16x32_bf16 v[92:95], a[100:103], v[172:175], v[92:95]
    s_set_gpr_idx_on s30, gpr_idx(DST)
    v_accvgpr_write_b32 a2, v10
    v_accvgpr_write_b32 a3, v11
    s_set_gpr_idx_off
    v_mfma_f32_16x16x32_bf16 v[96:99], a[104:107], v[168:171], v[96:99]
    ds_read_b128 a[88:91], v7 offset:2048
    v_mfma_f32_16x16x32_bf16 v[100:103], a[104:107], v[172:175], v[100:103]
    s_set_gpr_idx_on s30, gpr_idx(DST)
    v_accvgpr_write_b32 a4, v12
    v_accvgpr_write_b32 a5, v13
    s_set_gpr_idx_off
    v_mfma_f32_16x16x32_bf16 v[104:107], a[108:111], v[168:171], v[104:107]
    ds_read_b128 a[92:95], v7 offset:3072
    v_mfma_f32_16x16x32_bf16 v[108:111], a[108:111], v[172:175], v[108:111]
    s_waitcnt lgkmcnt(4)
    v_mfma_f32_16x16x32_bf16 v[80:83], a[112:115], v[176:179], v[80:83]
    ds_read_b128 a[96:99], v7 offset:4096
    s_set_gpr_idx_on s30, gpr_idx(DST)
    v_accvgpr_write_b32 a6, v14
    v_accvgpr_write_b32 a7, v15
    s_set_gpr_idx_off
    v_mfma_f32_16x16x32_bf16 v[84:87], a[112:115], v[180:183], v[84:87]
    v_mfma_f32_16x16x32_bf16 v[88:91], a[116:119], v[176:179], v[88:91]
    ds_read_b128 a[100:103], v7 offset:5120
    s_add_u32 s30, s30, 8
    v_mfma_f32_16x16x32_bf16 v[92:95], a[116:119], v[180:183], v[92:95]
    v_mfma_f32_16x16x32_bf16 v[96:99], a[120:123], v[176:179], v[96:99]
    ds_read_b128 a[104:107], v7 offset:6144
    s_add_u32 s41, s41, 0x800
    v_mfma_f32_16x16x32_bf16 v[100:103], a[120:123], v[180:183], v[100:103]
    v_mfma_f32_16x16x32_bf16 v[104:107], a[124:127], v[176:179], v[104:107]
    ds_read_b128 a[108:111], v7 offset:7168
    v_mfma_f32_16x16x32_bf16 v[108:111], a[124:127], v[180:183], v[108:111]
    s_waitcnt vmcnt(12)
    s_barrier
    s_waitcnt lgkmcnt(4)
    v_mfma_f32_16x16x32_bf16 v[80:83], a[80:83], v[184:187], v[80:83]
    ds_read_b128 a[112:115], v7 offset:8192
    v_mfma_f32_16x16x32_bf16 v[84:87], a[80:83], v[188:191], v[84:87]
    s_add_u32 m0, s20, 0
    v_mfma_f32_16x16x32_bf16 v[88:91], a[84:87], v[184:187], v[88:91]
    ds_read_b128 a[116:119], v7 offset:9216
    v_mfma_f32_16x16x32_bf16 v[92:95], a[84:87], v[188:191], v[92:95]
    v_mfma_f32_16x16x32_bf16 v[96:99], a[88:91], v[184:187], v[96:99]
    ds_read_b128 a[120:123], v7 offset:10240
    v_mfma_f32_16x16x32_bf16 v[100:103], a[88:91], v[188:191], v[100:103]
    buffer_load_dwordx4 v1, s[12:15], s24 offen offset:0 lds
    v_mfma_f32_16x16x32_bf16 v[104:107], a[92:95], v[184:187], v[104:107]
    ds_read_b128 a[124:127], v7 offset:11264
    v_mfma_f32_16x16x32_bf16 v[108:111], a[92:95], v[188:191], v[108:111]
    s_waitcnt lgkmcnt(4)
    v_mfma_f32_16x16x32_bf16 v[80:83], a[96:99], v[192:195], v[80:83]
    ds_read_b128 a[80:83], v7 offset:12288
    v_mfma_f32_16x16x32_bf16 v[84:87], a[96:99], v[196:199], v[84:87]
    buffer_load_dwordx4 v1, s[12:15], s24 offen offset:1024 lds
    v_mfma_f32_16x16x32_bf16 v[88:91], a[100:103], v[192:195], v[88:91]
    ds_read_b128 a[84:87], v7 offset:13312
    v_mfma_f32_16x16x32_bf16 v[92:95], a[100:103], v[196:199], v[92:95]
    v_mfma_f32_16x16x32_bf16 v[96:99], a[104:107], v[192:195], v[96:99]
    ds_read_b128 a[88:91], v7 offset:14336
    v_mfma_f32_16x16x32_bf16 v[100:103], a[104:107], v[196:199], v[100:103]
    buffer_load_dwordx4 v1, s[12:15], s24 offen offset:2048 lds
    v_mfma_f32_16x16x32_bf16 v[104:107], a[108:111], v[192:195], v[104:107]
    ds_read_b128 a[92:95], v7 offset:15360
    v_mfma_f32_16x16x32_bf16 v[108:111], a[108:111], v[196:199], v[108:111]
    s_waitcnt lgkmcnt(4)
    v_mfma_f32_16x16x32_bf16 v[80:83], a[112:115], v[200:203], v[80:83]
    ds_read_b128 a[96:99], v7 offset:16384
    v_mfma_f32_16x16x32_bf16 v[84:87], a[112:115], v[204:207], v[84:87]
    buffer_load_dwordx4 v1, s[12:15], s24 offen offset:3072 lds
    v_mfma_f32_16x16x32_bf16 v[88:91], a[116:119], v[200:203], v[88:91]
    ds_read_b128 a[100:103], v7 offset:17408
    v_mfma_f32_16x16x32_bf16 v[92:95], a[116:119], v[204:207], v[92:95]
    v_mfma_f32_16x16x32_bf16 v[96:99], a[120:123], v[200:203], v[96:99]
    ds_read_b128 a[104:107], v7 offset:18432
    v_mfma_f32_16x16x32_bf16 v[100:103], a[120:123], v[204:207], v[100:103]
    s_add_u32 m0, s20, 4096
    v_mfma_f32_16x16x32_bf16 v[104:107], a[124:127], v[200:203], v[104:107]
    ds_read_b128 a[108:111], v7 offset:19456
    v_mfma_f32_16x16x32_bf16 v[108:111], a[124:127], v[204:207], v[108:111]
    s_waitcnt lgkmcnt(4)
    v_mfma_f32_16x16x32_bf16 v[80:83], a[80:83], v[208:211], v[80:83]
    ds_read_b128 a[112:115], v7 offset:20480
    v_mfma_f32_16x16x32_bf16 v[84:87], a[80:83], v[212:215], v[84:87]
    buffer_load_dwordx4 v1, s[12:15], s25 offen offset:0 lds
    v_mfma_f32_16x16x32_bf16 v[88:91], a[84:87], v[208:211], v[88:91]
    ds_read_b128 a[116:119], v7 offset:21504
    v_mfma_f32_16x16x32_bf16 v[92:95], a[84:87], v[212:215], v[92:95]
    v_mfma_f32_16x16x32_bf16 v[96:99], a[88:91], v[208:211], v[96:99]
    ds_read_b128 a[120:123], v7 offset:22528
    v_mfma_f32_16x16x32_bf16 v[100:103], a[88:91], v[212:215], v[100:103]
    buffer_load_dwordx4 v1, s[12:15], s25 offen offset:1024 lds
    v_mfma_f32_16x16x32_bf16 v[104:107], a[92:95], v[208:211], v[104:107]
    ds_read_b128 a[124:127], v7 offset:23552
    v_mfma_f32_16x16x32_bf16 v[108:111], a[92:95], v[212:215], v[108:111]
    s_waitcnt lgkmcnt(4)
    v_mfma_f32_16x16x32_bf16 v[80:83], a[96:99], v[216:219], v[80:83]
    ds_read_b128 a[80:83], v7 offset:24576
    v_mfma_f32_16x16x32_bf16 v[84:87], a[96:99], v[220:223], v[84:87]
    buffer_load_dwordx4 v1, s[12:15], s25 offen offset:2048 lds
    v_mfma_f32_16x16x32_bf16 v[88:91], a[100:103], v[216:219], v[88:91]
    ds_read_b128 a[84:87], v7 offset:25600
    v_mfma_f32_16x16x32_bf16 v[92:95], a[100:103], v[220:223], v[92:95]
    v_mfma_f32_16x16x32_bf16 v[96:99], a[104:107], v[216:219], v[96:99]
    ds_read_b128 a[88:91], v7 offset:26624
    v_mfma_f32_16x16x32_bf16 v[100:103], a[104:107], v[220:223], v[100:103]
    buffer_load_dwordx4 v1, s[12:15], s25 offen offset:3072 lds
    v_mfma_f32_16x16x32_bf16 v[104:107], a[108:111], v[216:219], v[104:107]
    ds_read_b128 a[92:95], v7 offset:27648
    v_mfma_f32_16x16x32_bf16 v[108:111], a[108:111], v[220:223], v[108:111]
    s_waitcnt lgkmcnt(4)
    v_mfma_f32_16x16x32_bf16 v[80:83], a[112:115], v[224:227], v[80:83]
    ds_read_b128 a[96:99], v7 offset:28672
    v_mfma_f32_16x16x32_bf16 v[84:87], a[112:115], v[228:231], v[84:87]
    s_add_u32 m0, s20, 8192
    v_mfma_f32_16x16x32_bf16 v[88:91], a[116:119], v[224:227], v[88:91]
    ds_read_b128 a[100:103], v7 offset:29696
    v_mfma_f32_16x16x32_bf16 v[92:95], a[116:119], v[228:231], v[92:95]
    v_mfma_f32_16x16x32_bf16 v[96:99], a[120:123], v[224:227], v[96:99]
    ds_read_b128 a[104:107], v7 offset:30720
    v_mfma_f32_16x16x32_bf16 v[100:103], a[120:123], v[228:231], v[100:103]
    buffer_load_dwordx4 v1, s[12:15], s26 offen offset:0 lds
    v_mfma_f32_16x16x32_bf16 v[104:107], a[124:127], v[224:227], v[104:107]
    ds_read_b128 a[108:111], v7 offset:31744
    v_mfma_f32_16x16x32_bf16 v[108:111], a[124:127], v[228:231], v[108:111]
    s_waitcnt lgkmcnt(4)
    v_mfma_f32_16x16x32_bf16 v[80:83], a[80:83], v[232:235], v[80:83]
    ds_read_b128 a[112:115], v7 offset:32768
    v_mfma_f32_16x16x32_bf16 v[84:87], a[80:83], v[236:239], v[84:87]
    v_mfma_f32_16x16x32_bf16 v[88:91], a[84:87], v[232:235], v[88:91]
    ds_read_b128 a[116:119], v7 offset:33792
    v_mfma_f32_16x16x32_bf16 v[92:95], a[84:87], v[236:239], v[92:95]
    s_add_u32 s24, s24, 36864
    s_add_u32 s25, s25, 36864
    v_mfma_f32_16x16x32_bf16 v[96:99], a[88:91], v[232:235], v[96:99]
    ds_read_b128 a[120:123], v7 offset:34816
    s_add_u32 s26, s26, 36864
    v_mfma_f32_16x16x32_bf16 v[100:103], a[88:91], v[236:239], v[100:103]
    v_mfma_f32_16x16x32_bf16 v[104:107], a[92:95], v[232:235], v[104:107]
    ds_read_b128 a[124:127], v7 offset:35840
    v_mfma_f32_16x16x32_bf16 v[108:111], a[92:95], v[236:239], v[108:111]
    s_waitcnt lgkmcnt(4)
    v_mfma_f32_16x16x32_bf16 v[80:83], a[96:99], v[240:243], v[80:83]
    ds_read_b128 a[80:83], v4 offset:0
    v_mfma_f32_16x16x32_bf16 v[84:87], a[96:99], v[244:247], v[84:87]
    v_mfma_f32_16x16x32_bf16 v[88:91], a[100:103], v[240:243], v[88:91]
    ds_read_b128 a[84:87], v4 offset:1024
    v_mfma_f32_16x16x32_bf16 v[92:95], a[100:103], v[244:247], v[92:95]
    v_mfma_f32_16x16x32_bf16 v[96:99], a[104:107], v[240:243], v[96:99]
    ds_read_b128 a[88:91], v4 offset:2048
    v_mfma_f32_16x16x32_bf16 v[100:103], a[104:107], v[244:247], v[100:103]
    v_mfma_f32_16x16x32_bf16 v[104:107], a[108:111], v[240:243], v[104:107]
    ds_read_b128 a[92:95], v4 offset:3072
    v_mfma_f32_16x16x32_bf16 v[108:111], a[108:111], v[244:247], v[108:111]
    s_waitcnt lgkmcnt(4)
    v_mfma_f32_16x16x32_bf16 v[80:83], a[112:115], v[248:251], v[80:83]
    ds_read_b128 a[96:99], v4 offset:4096
    v_mfma_f32_16x16x32_bf16 v[84:87], a[112:115], v[252:255], v[84:87]
    v_mfma_f32_16x16x32_bf16 v[88:91], a[116:119], v[248:251], v[88:91]
    ds_read_b128 a[100:103], v4 offset:5120
    v_mfma_f32_16x16x32_bf16 v[92:95], a[116:119], v[252:255], v[92:95]
    v_mfma_f32_16x16x32_bf16 v[96:99], a[120:123], v[248:251], v[96:99]
    ds_read_b128 a[104:107], v4 offset:6144
    v_mfma_f32_16x16x32_bf16 v[100:103], a[120:123], v[252:255], v[100:103]
    v_mfma_f32_16x16x32_bf16 v[104:107], a[124:127], v[248:251], v[104:107]
    ds_read_b128 a[108:111], v4 offset:7168
    v_mfma_f32_16x16x32_bf16 v[108:111], a[124:127], v[252:255], v[108:111]
    s_waitcnt vmcnt(9)
    s_barrier
    s_branch K5_p1_A
K5_p1_x:
K5_chk0:
    v_min_i32 v25, v20, v21
    v_min3_i32 v25, v22, v23, v25
    v_cmp_gt_i32 vcc, 3, v25
    s_cbranch_vccz K5_ok0
    s_sleep 2
    buffer_load_dwordx4 v[20:23], v24, s[8:11], s45 offen sc1
    s_waitcnt vmcnt(0)
    s_branch K5_chk0
K5_ok0:
    s_waitcnt lgkmcnt(4)
    v_mfma_f32_16x16x32_bf16 v[80:83], a[80:83], v[112:115], 0
    ds_read_b128 a[112:115], v6 offset:8192
    v_mov_b32 v19, 5
    v_mfma_f32_16x16x32_bf16 v[84:87], a[80:83], v[116:119], 0
    buffer_store_dword v19, v18, s[8:11], s46 offen sc1
    s_add_u32 m0, s20, 110592
    v_mfma_f32_16x16x32_bf16 v[88:91], a[84:87], v[112:115], 0
    ds_read_b128 a[116:119], v6 offset:9216
    v_mfma_f32_16x16x32_bf16 v[92:95], a[84:87], v[116:119], 0
    buffer_load_dwordx4 a[128:131], v1, s[8:11], s42 offen offset:0 sc1
    v_mfma_f32_16x16x32_bf16 v[96:99], a[88:91], v[112:115], 0
    ds_read_b128 a[120:123], v6 offset:10240
    v_mfma_f32_16x16x32_bf16 v[100:103], a[88:91], v[116:119], 0
    buffer_load_dwordx4 v1, s[12:15], s24 offen offset:0 lds
    v_max_f32 v48, 0, v48
    v_mfma_f32_16x16x32_bf16 v[104:107], a[92:95], v[112:115], 0
    ds_read_b128 a[124:127], v6 offset:11264
    v_max_f32 v49, 0, v49
    v_mfma_f32_16x16x32_bf16 v[108:111], a[92:95], v[116:119], 0
    v_max_f32 v50, 0, v50
    s_waitcnt lgkmcnt(4)
    v_mfma_f32_16x16x32_bf16 v[80:83], a[96:99], v[120:123], v[80:83]
    ds_read_b128 a[80:83], v6 offset:12288
    v_max_f32 v51, 0, v51
    v_mfma_f32_16x16x32_bf16 v[84:87], a[96:99], v[124:127], v[84:87]
    buffer_load_dwordx4 v1, s[12:15], s24 offen offset:1024 lds
    v_mul_f32 v48, v48, v64
    v_mfma_f32_16x16x32_bf16 v[88:91], a[100:103], v[120:123], v[88:91]
    ds_read_b128 a[84:87], v6 offset:13312
    v_mfma_f32_16x16x32_bf16 v[92:95], a[100:103], v[124:127], v[92:95]
    v_mul_f32 v49, v49, v65
    v_mfma_f32_16x16x32_bf16 v[96:99], a[104:107], v[120:123], v[96:99]
    ds_read_b128 a[88:91], v6 offset:14336
    v_mul_f32 v50, v50, v66
    v_mfma_f32_16x16x32_bf16 v[100:103], a[104:107], v[124:127], v[100:103]
    buffer_load_dwordx4 v1, s[12:15], s24 offen offset:2048 lds
    v_mul_f32 v51, v51, v67
    v_mfma_f32_16x16x32_bf16 v[104:107], a[108:111], v[120:123], v[104:107]
    ds_read_b128 a[92:95], v6 offset:15360
    v_cvt_pk_bf16_f32 v8, v48, v49
    v_mfma_f32_16x16x32_bf16 v[108:111], a[108:111], v[124:127], v[108:111]
    v_cvt_pk_bf16_f32 v9, v50, v51
    s_waitcnt lgkmcnt(4)
    v_mfma_f32_16x16x32_bf16 v[80:83], a[112:115], v[128:131], v[80:83]
    ds_read_b128 a[96:99], v6 offset:16384
    v_mfma_f32_16x16x32_bf16 v[84:87], a[112:115], v[132:135], v[84:87]
    buffer_load_dwordx4 v1, s[12:15], s24 offen offset:3072 lds
    v_max_f32 v56, 0, v56
    v_mfma_f32_16x16x32_bf16 v[88:91], a[116:119], v[128:131], v[88:91]
    ds_read_b128 a[100:103], v6 offset:17408
    v_max_f32 v57, 0, v57
    v_mfma_f32_16x16x32_bf16 v[92:95], a[116:119], v[132:135], v[92:95]
    buffer_load_dwordx4 a[132:135], v1, s[8:11], s42 offen offset:1024 sc1
    v_max_f32 v58, 0, v58
    v_mfma_f32_16x16x32_bf16 v[96:99], a[120:123], v[128:131], v[96:99]
    ds_read_b128 a[104:107], v6 offset:18432
    v_max_f32 v59, 0, v59
    v_mfma_f32_16x16x32_bf16 v[100:103], a[120:123], v[132:135], v[100:103]
    s_add_u32 m0, s20, 114688
    v_mfma_f32_16x16x32_bf16 v[104:107], a[124:127], v[128:131], v[104:107]
    ds_read_b128 a[108:111], v6 offset:19456
    v_mul_f32 v56, v56, v72
    v_mfma_f32_16x16x32_bf16 v[108:111], a[124:127], v[132:135], v[108:111]
    v_mul_f32 v57, v57, v73
    s_waitcnt lgkmcnt(4)
    v_mfma_f32_16x16x32_bf16 v[80:83], a[80:83], v[136:139], v[80:83]
    ds_read_b128 a[112:115], v6 offset:20480
    v_mul_f32 v58, v58, v74
    v_mfma_f32_16x16x32_bf16 v[84:87], a[80:83], v[140:143], v[84:87]
    buffer_load_dwordx4 v1, s[12:15], s25 offen offset:0 lds
    v_mul_f32 v59, v59, v75
    v_mfma_f32_16x16x32_bf16 v[88:91], a[84:87], v[136:139], v[88:91]
    ds_read_b128 a[116:119], v6 offset:21504
    v_cvt_pk_bf16_f32 v10, v56, v57
    v_mfma_f32_16x16x32_bf16 v[92:95], a[84:87], v[140:143], v[92:95]
    v_mfma_f32_16x16x32_bf16 v[96:99], a[88:91], v[136:139], v[96:99]
    ds_read_b128 a[120:123], v6 offset:22528
    v_cvt_pk_bf16_f32 v11, v58, v59
    v_mfma_f32_16x16x32_bf16 v[100:103], a[88:91], v[140:143], v[100:103]
    buffer_load_dwordx4 v1, s[12:15], s25 offen offset:1024 lds
    buffer_store_dwordx4 v[8:11], v1, s[8:11], s41 offen offset:0 sc1
    v_mfma_f32_16x16x32_bf16 v[104:107], a[92:95], v[136:139], v[104:107]
    ds_read_b128 a[124:127], v6 offset:23552
    v_max_f32 v52, 0, v52
    v_mfma_f32_16x16x32_bf16 v[108:111], a[92:95], v[140:143], v[108:111]
    v_max_f32 v53, 0, v53
    s_waitcnt lgkmcnt(4)
    v_mfma_f32_16x16x32_bf16 v[80:83], a[96:99], v[144:147], v[80:83]
    ds_read_b128 a[80:83], v6 offset:24576
    v_max_f32 v54, 0, v54
    v_mfma_f32_16x16x32_bf16 v[84:87], a[96:99], v[148:151], v[84:87]
    buffer_load_dwordx4 v1, s[12:15], s25 offen offset:2048 lds
    buffer_load_dwordx4 a[136:139], v1, s[8:11], s43 offen offset:0 sc1
    v_mfma_f32_16x16x32_bf16 v[88:91], a[100:103], v[144:147], v[88:91]
    ds_read_b128 a[84:87], v6 offset:25600
    v_max_f32 v55, 0, v55
    v_mfma_f32_16x16x32_bf16 v[92:95], a[100:103], v[148:151], v[92:95]
    v_mul_f32 v52, v52, v68
    v_mfma_f32_16x16x32_bf16 v[96:99], a[104:107], v[144:147], v[96:99]
    ds_read_b128 a[88:91], v6 offset:26624
    v_mul_f32 v53, v53, v69
    v_mfma_f32_16x16x32_bf16 v[100:103], a[104:107], v[148:151], v[100:103]
    buffer_load_dwordx4 v1, s[12:15], s25 offen offset:3072 lds
    v_mul_f32 v54, v54, v70
    v_mfma_f32_16x16x32_bf16 v[104:107], a[108:111], v[144:147], v[104:107]
    ds_read_b128 a[92:95], v6 offset:27648
    v_mfma_f32_16x16x32_bf16 v[108:111], a[108:111], v[148:151], v[108:111]
    v_mul_f32 v55, v55, v71
    s_waitcnt lgkmcnt(4)
    v_mfma_f32_16x16x32_bf16 v[80:83], a[112:115], v[152:155], v[80:83]
    ds_read_b128 a[96:99], v6 offset:28672
    v_cvt_pk_bf16_f32 v12, v52, v53
    v_mfma_f32_16x16x32_bf16 v[84:87], a[112:115], v[156:159], v[84:87]
    s_add_u32 m0, s20, 118784
    v_cvt_pk_bf16_f32 v13, v54, v55
    v_mfma_f32_16x16x32_bf16 v[88:91], a[116:119], v[152:155], v[88:91]
    ds_read_b128 a[100:103], v6 offset:29696
    v_max_f32 v60, 0, v60
    v_mfma_f32_16x16x32_bf16 v[92:95], a[116:119], v[156:159], v[92:95]
    v_max_f32 v61, 0, v61
    v_mfma_f32_16x16x32_bf16 v[96:99], a[120:123], v[152:155], v[96:99]
    ds_read_b128 a[104:107], v6 offset:30720
    v_mfma_f32_16x16x32_bf16 v[100:103], a[120:123], v[156:159], v[100:103]
    buffer_load_dwordx4 v1, s[12:15], s26 offen offset:0 lds
    v_max_f32 v62, 0, v62
    v_mfma_f32_16x16x32_bf16 v[104:107], a[124:127], v[152:155], v[104:107]
    ds_read_b128 a[108:111], v6 offset:31744
    v_max_f32 v63, 0, v63
    v_mfma_f32_16x16x32_bf16 v[108:111], a[124:127], v[156:159], v[108:111]
    v_mul_f32 v60, v60, v76
    s_waitcnt lgkmcnt(4)
    v_mfma_f32_16x16x32_bf16 v[80:83], a[80:83], v[160:163], v[80:83]
    ds_read_b128 a[112:115], v6 offset:32768
    v_mul_f32 v61, v61, v77
    v_mfma_f32_16x16x32_bf16 v[84:87], a[80:83], v[164:167], v[84:87]
    buffer_load_dwordx4 a[140:143], v1, s[8:11], s43 offen offset:1024 sc1
    v_mul_f32 v62, v62, v78
    v_mfma_f32_16x16x32_bf16 v[88:91], a[84:87], v[160:163], v[88:91]
    ds_read_b128 a[116:119], v6 offset:33792
    v_mfma_f32_16x16x32_bf16 v[92:95], a[84:87], v[164:167], v[92:95]
    s_add_u32 s24, s24, 36864
    s_add_u32 s25, s25, 36864
    v_mfma_f32_16x16x32_bf16 v[96:99], a[88:91], v[160:163], v[96:99]
    ds_read_b128 a[120:123], v6 offset:34816
    s_add_u32 s26, s26, 36864
    v_mfma_f32_16x16x32_bf16 v[100:103], a[88:91], v[164:167], v[100:103]
    v_mul_f32 v63, v63, v79
    v_cvt_pk_bf16_f32 v14, v60, v61
    v_mfma_f32_16x16x32_bf16 v[104:107], a[92:95], v[160:163], v[104:107]
    ds_read_b128 a[124:127], v6 offset:35840
    v_cvt_pk_bf16_f32 v15, v62, v63
    v_mfma_f32_16x16x32_bf16 v[108:111], a[92:95], v[164:167], v[108:111]
    buffer_store_dwordx4 v[12:15], v1, s[8:11], s41 offen offset:1024 sc1
    s_waitcnt lgkmcnt(4)
    v_mfma_f32_16x16x32_bf16 v[80:83], a[96:99], v[168:171], v[80:83]
    ds_read_b128 a[80:83], v7 offset:0
    v_mfma_f32_16x16x32_bf16 v[84:87], a[96:99], v[172:175], v[84:87]
    s_set_gpr_idx_on s30, gpr_idx(DST)
    v_accvgpr_write_b32 a0, v8
    v_accvgpr_write_b32 a1, v9
    s_set_gpr_idx_off
    v_mfma_f32_16x16x32_bf16 v[88:91], a[100:103], v[168:171], v[88:91]
    ds_read_b128 a[84:87], v7 offset:1024
    v_mfma_f32_16x16x32_bf16 v[92:95], a[100:103], v[172:175], v[92:95]
    s_set_gpr_idx_on s30, gpr_idx(DST)
    v_accvgpr_write_b32 a2, v10
    v_accvgpr_write_b32 a3, v11
    s_set_gpr_idx_off
    v_mfma_f32_16x16x32_bf16 v[96:99], a[104:107], v[168:171], v[96:99]
    ds_read_b128 a[88:91], v7 offset:2048
    v_mfma_f32_16x16x32_bf16 v[100:103], a[104:107], v[172:175], v[100:103]
    s_set_gpr_idx_on s30, gpr_idx(DST)
    v_accvgpr_write_b32 a4, v12
    v_accvgpr_write_b32 a5, v13
    s_set_gpr_idx_off
    v_mfma_f32_16x16x32_bf16 v[104:107], a[108:111], v[168:171], v[104:107]
    ds_read_b128 a[92:95], v7 offset:3072
    v_mfma_f32_16x16x32_bf16 v[108:111], a[108:111], v[172:175], v[108:111]
    s_waitcnt lgkmcnt(4)
    v_mfma_f32_16x16x32_bf16 v[80:83], a[112:115], v[176:179], v[80:83]
    ds_read_b128 a[96:99], v7 offset:4096
    s_set_gpr_idx_on s30, gpr_idx(DST)
    v_accvgpr_write_b32 a6, v14
    v_accvgpr_write_b32 a7, v15
    s_set_gpr_idx_off
    v_mfma_f32_16x16x32_bf16 v[84:87], a[112:115], v[180:183], v[84:87]
    v_mfma_f32_16x16x32_bf16 v[88:91], a[116:119], v[176:179], v[88:91]
    ds_read_b128 a[100:103], v7 offset:5120
    s_add_u32 s30, s30, 8
    v_mfma_f32_16x16x32_bf16 v[92:95], a[116:119], v[180:183], v[92:95]
    v_mfma_f32_16x16x32_bf16 v[96:99], a[120:123], v[176:179], v[96:99]
    ds_read_b128 a[104:107], v7 offset:6144
    s_add_u32 s41, s41, 0x800
    v_mfma_f32_16x16x32_bf16 v[100:103], a[120:123], v[180:183], v[100:103]
    v_mfma_f32_16x16x32_bf16 v[104:107], a[124:127], v[176:179], v[104:107]
    ds_read_b128 a[108:111], v7 offset:7168
    v_mfma_f32_16x16x32_bf16 v[108:111], a[124:127], v[180:183], v[108:111]
    s_waitcnt vmcnt(16)
    s_barrier
    s_waitcnt lgkmcnt(4)
    v_mfma_f32_16x16x32_bf16 v[80:83], a[80:83], v[184:187], v[80:83]
    ds_read_b128 a[112:115], v7 offset:8192
    v_mfma_f32_16x16x32_bf16 v[84:87], a[80:83], v[188:191], v[84:87]
    s_add_u32 m0, s20, 0
    v_mfma_f32_16x16x32_bf16 v[88:91], a[84:87], v[184:187], v[88:91]
    ds_read_b128 a[116:119], v7 offset:9216
    v_mfma_f32_16x16x32_bf16 v[92:95], a[84:87], v[188:191], v[92:95]
    buffer_load_dwordx4 a[144:147], v1, s[8:11], s44 offen offset:0 sc1
    v_mfma_f32_16x16x32_bf16 v[96:99], a[88:91], v[184:187], v[96:99]
    ds_read_b128 a[120:123], v7 offset:10240
    v_mfma_f32_16x16x32_bf16 v[100:103], a[88:91], v[188:191], v[100:103]
    buffer_load_dwordx4 v1, s[12:15], s24 offen offset:0 lds
    v_mfma_f32_16x16x32_bf16 v[104:107], a[92:95], v[184:187], v[104:107]
    ds_read_b128 a[124:127], v7 offset:11264
    v_mfma_f32_16x16x32_bf16 v[108:111], a[92:95], v[188:191], v[108:111]
    s_waitcnt lgkmcnt(4)
    v_mfma_f32_16x16x32_bf16 v[80:83], a[96:99], v[192:195], v[80:83]
    ds_read_b128 a[80:83], v7 offset:12288
    v_mfma_f32_16x16x32_bf16 v[84:87], a[96:99], v[196:199], v[84:87]
    buffer_load_dwordx4 v1, s[12:15], s24 offen offset:1024 lds
    v_mfma_f32_16x16x32_bf16 v[88:91], a[100:103], v[192:195], v[88:91]
    ds_read_b128 a[84:87], v7 offset:13312
    buffer_load_dwordx4 a[148:151], v1, s[8:11], s44 offen offset:1024 sc1
    v_mfma_f32_16x16x32_bf16 v[92:95], a[100:103], v[196:199], v[92:95]
    v_mfma_f32_16x16x32_bf16 v[96:99], a[104:107], v[192:195], v[96:99]
    ds_read_b128 a[88:91], v7 offset:14336
    v_mfma_f32_16x16x32_bf16 v[100:103], a[104:107], v[196:199], v[100:103]
    buffer_load_dwordx4 v1, s[12:15], s24 offen offset:2048 lds
    v_mfma_f32_16x16x32_bf16 v[104:107], a[108:111], v[192:195], v[104:107]
    ds_read_b128 a[92:95], v7 offset:15360
    v_mfma_f32_16x16x32_bf16 v[108:111], a[108:111], v[196:199], v[108:111]
    s_waitcnt lgkmcnt(4)
    v_mfma_f32_16x16x32_bf16 v[80:83], a[112:115], v[200:203], v[80:83]
    ds_read_b128 a[96:99], v7 offset:16384
    v_mfma_f32_16x16x32_bf16 v[84:87], a[112:115], v[204:207], v[84:87]
    buffer_load_dwordx4 v1, s[12:15], s24 offen offset:3072 lds
    v_mfma_f32_16x16x32_bf16 v[88:91], a[116:119], v[200:203], v[88:91]
    ds_read_b128 a[100:103], v7 offset:17408
    buffer_load_dwordx4 a[152:155], v1, s[8:11], s42 offen offset:2048 sc1
    v_mfma_f32_16x16x32_bf16 v[92:95], a[116:119], v[204:207], v[92:95]
    v_mfma_f32_16x16x32_bf16 v[96:99], a[120:123], v[200:203], v[96:99]
    ds_read_b128 a[104:107], v7 offset:18432
    v_mfma_f32_16x16x32_bf16 v[100:103], a[120:123], v[204:207], v[100:103]
    s_add_u32 m0, s20, 4096
    v_mfma_f32_16x16x32_bf16 v[104:107], a[124:127], v[200:203], v[104:107]
    ds_read_b128 a[108:111], v7 offset:19456
    v_mfma_f32_16x16x32_bf16 v[108:111], a[124:127], v[204:207], v[108:111]
    s_waitcnt lgkmcnt(4)
    v_mfma_f32_16x16x32_bf16 v[80:83], a[80:83], v[208:211], v[80:83]
    ds_read_b128 a[112:115], v7 offset:20480
    v_mfma_f32_16x16x32_bf16 v[84:87], a[80:83], v[212:215], v[84:87]
    buffer_load_dwordx4 v1, s[12:15], s25 offen offset:0 lds
    buffer_load_dwordx4 a[156:159], v1, s[8:11], s42 offen offset:3072 sc1
    v_mfma_f32_16x16x32_bf16 v[88:91], a[84:87], v[208:211], v[88:91]
    ds_read_b128 a[116:119], v7 offset:21504
    v_mfma_f32_16x16x32_bf16 v[92:95], a[84:87], v[212:215], v[92:95]
    v_mfma_f32_16x16x32_bf16 v[96:99], a[88:91], v[208:211], v[96:99]
    ds_read_b128 a[120:123], v7 offset:22528
    v_mfma_f32_16x16x32_bf16 v[100:103], a[88:91], v[212:215], v[100:103]
    buffer_load_dwordx4 v1, s[12:15], s25 offen offset:1024 lds
    v_mfma_f32_16x16x32_bf16 v[104:107], a[92:95], v[208:211], v[104:107]
    ds_read_b128 a[124:127], v7 offset:23552
    v_mfma_f32_16x16x32_bf16 v[108:111], a[92:95], v[212:215], v[108:111]
    s_waitcnt lgkmcnt(4)
    v_mfma_f32_16x16x32_bf16 v[80:83], a[96:99], v[216:219], v[80:83]
    ds_read_b128 a[80:83], v7 offset:24576
    v_mfma_f32_16x16x32_bf16 v[84:87], a[96:99], v[220:223], v[84:87]
    buffer_load_dwordx4 v1, s[12:15], s25 offen offset:2048 lds
    s_add_u32 s42, s42, 0x1000
    v_mfma_f32_16x16x32_bf16 v[88:91], a[100:103], v[216:219], v[88:91]
    ds_read_b128 a[84:87], v7 offset:25600
    v_mfma_f32_16x16x32_bf16 v[92:95], a[100:103], v[220:223], v[92:95]
    v_mfma_f32_16x16x32_bf16 v[96:99], a[104:107], v[216:219], v[96:99]
    ds_read_b128 a[88:91], v7 offset:26624
    v_mfma_f32_16x16x32_bf16 v[100:103], a[104:107], v[220:223], v[100:103]
    buffer_load_dwordx4 v1, s[12:15], s25 offen offset:3072 lds
    v_mfma_f32_16x16x32_bf16 v[104:107], a[108:111], v[216:219], v[104:107]
    ds_read_b128 a[92:95], v7 offset:27648
    v_mfma_f32_16x16x32_bf16 v[108:111], a[108:111], v[220:223], v[108:111]
    s_waitcnt lgkmcnt(4)
    v_mfma_f32_16x16x32_bf16 v[80:83], a[112:115], v[224:227], v[80:83]
    ds_read_b128 a[96:99], v7 offset:28672
    v_mfma_f32_16x16x32_bf16 v[84:87], a[112:115], v[228:231], v[84:87]
    s_add_u32 m0, s20, 8192
    buffer_load_dwordx4 a[160:163], v1, s[8:11], s43 offen offset:2048 sc1
    v_mfma_f32_16x16x32_bf16 v[88:91], a[116:119], v[224:227], v[88:91]
    ds_read_b128 a[100:103], v7 offset:29696
    v_mfma_f32_16x16x32_bf16 v[92:95], a[116:119], v[228:231], v[92:95]
    v_mfma_f32_16x16x32_bf16 v[96:99], a[120:123], v[224:227], v[96:99]
    ds_read_b128 a[104:107], v7 offset:30720
    v_mfma_f32_16x16x32_bf16 v[100:103], a[120:123], v[228:231], v[100:103]
    buffer_load_dwordx4 v1, s[12:15], s26 offen offset:0 lds
    v_mfma_f32_16x16x32_bf16 v[104:107], a[124:127], v[224:227], v[104:107]
    ds_read_b128 a[108:111], v7 offset:31744
    v_mfma_f32_16x16x32_bf16 v[108:111], a[124:127], v[228:231], v[108:111]
    s_waitcnt lgkmcnt(4)
    v_mfma_f32_16x16x32_bf16 v[80:83], a[80:83], v[232:235], v[80:83]
    ds_read_b128 a[112:115], v7 offset:32768
    buffer_load_dwordx4 a[164:167], v1, s[8:11], s43 offen offset:3072 sc1
    v_mfma_f32_16x16x32_bf16 v[84:87], a[80:83], v[236:239], v[84:87]
    v_mfma_f32_16x16x32_bf16 v[88:91], a[84:87], v[232:235], v[88:91]
    ds_read_b128 a[116:119], v7 offset:33792
    v_mfma_f32_16x16x32_bf16 v[92:95], a[84:87], v[236:239], v[92:95]
    s_add_u32 s24, s24, 36864
    s_add_u32 s25, s25, 36864
    v_mfma_f32_16x16x32_bf16 v[96:99], a[88:91], v[232:235], v[96:99]
    ds_read_b128 a[120:123], v7 offset:34816
    s_add_u32 s26, s26, 36864
    v_mfma_f32_16x16x32_bf16 v[100:103], a[88:91], v[236:239], v[100:103]
    v_mfma_f32_16x16x32_bf16 v[104:107], a[92:95], v[232:235], v[104:107]
    ds_read_b128 a[124:127], v7 offset:35840
    v_mfma_f32_16x16x32_bf16 v[108:111], a[92:95], v[236:239], v[108:111]
    s_waitcnt lgkmcnt(4)
    v_mfma_f32_16x16x32_bf16 v[80:83], a[96:99], v[240:243], v[80:83]
    ds_read_b128 a[80:83], v4 offset:0
    s_add_u32 s43, s43, 0x1000
    v_mfma_f32_16x16x32_bf16 v[84:87], a[96:99], v[244:247], v[84:87]
    v_mfma_f32_16x16x32_bf16 v[88:91], a[100:103], v[240:243], v[88:91]
    ds_read_b128 a[84:87], v4 offset:1024
    v_mfma_f32_16x16x32_bf16 v[92:95], a[100:103], v[244:247], v[92:95]
    v_mfma_f32_16x16x32_bf16 v[96:99], a[104:107], v[240:243], v[96:99]
    ds_read_b128 a[88:91], v4 offset:2048
    v_mfma_f32_16x16x32_bf16 v[100:103], a[104:107], v[244:247], v[100:103]
    v_mfma_f32_16x16x32_bf16 v[104:107], a[108:111], v[240:243], v[104:107]
    ds_read_b128 a[92:95], v4 offset:3072
    v_mfma_f32_16x16x32_bf16 v[108:111], a[108:111], v[244:247], v[108:111]
    s_waitcnt lgkmcnt(4)
    v_mfma_f32_16x16x32_bf16 v[80:83], a[112:115], v[248:251], v[80:83]
    ds_read_b128 a[96:99], v4 offset:4096
    v_mfma_f32_16x16x32_bf16 v[84:87], a[112:115], v[252:255], v[84:87]
    v_mfma_f32_16x16x32_bf16 v[88:91], a[116:119], v[248:251], v[88:91]
    ds_read_b128 a[100:103], v4 offset:5120
    v_mfma_f32_16x16x32_bf16 v[92:95], a[116:119], v[252:255], v[92:95]
    v_mfma_f32_16x16x32_bf16 v[96:99], a[120:123], v[248:251], v[96:99]
    ds_read_b128 a[104:107], v4 offset:6144
    v_mfma_f32_16x16x32_bf16 v[100:103], a[120:123], v[252:255], v[100:103]
    v_mfma_f32_16x16x32_bf16 v[104:107], a[124:127], v[248:251], v[104:107]
    ds_read_b128 a[108:111], v4 offset:7168
    v_mfma_f32_16x16x32_bf16 v[108:111], a[124:127], v[252:255], v[108:111]
    s_waitcnt vmcnt(15)
    s_barrier
    s_waitcnt lgkmcnt(4)
    v_mfma_f32_16x16x32_bf16 v[48:51], a[80:83], v[112:115], 0
    ds_read_b128 a[112:115], v4 offset:8192
    buffer_load_dwordx4 v[20:23], v24, s[8:11], s45 offen sc1
    v_mfma_f32_16x16x32_bf16 v[52:55], a[80:83], v[116:119], 0
    s_add_u32 m0, s20, 36864
    v_mfma_f32_16x16x32_bf16 v[56:59], a[84:87], v[112:115], 0
    ds_read_b128 a[116:119], v4 offset:9216
    v_mfma_f32_16x16x32_bf16 v[60:63], a[84:87], v[116:119], 0
    buffer_load_dwordx4 a[168:171], v1, s[8:11], s44 offen offset:2048 sc1
    v_mfma_f32_16x16x32_bf16 v[64:67], a[88:91], v[112:115], 0
    ds_read_b128 a[120:123], v4 offset:10240
    v_mfma_f32_16x16x32_bf16 v[68:71], a[88:91], v[116:119], 0
    buffer_load_dwordx4 v1, s[12:15], s24 offen offset:0 lds
    v_max_f32 v80, 0, v80
    v_mfma_f32_16x16x32_bf16 v[72:75], a[92:95], v[112:115], 0
    ds_read_b128 a[124:127], v4 offset:11264
    v_max_f32 v81, 0, v81
    v_mfma_f32_16x16x32_bf16 v[76:79], a[92:95], v[116:119], 0
    v_max_f32 v82, 0, v82
    s_waitcnt lgkmcnt(4)
    v_mfma_f32_16x16x32_bf16 v[48:51], a[96:99], v[120:123], v[48:51]
    ds_read_b128 a[80:83], v4 offset:12288
    v_max_f32 v83, 0, v83
    v_mfma_f32_16x16x32_bf16 v[52:55], a[96:99], v[124:127], v[52:55]
    buffer_load_dwordx4 v1, s[12:15], s24 offen offset:1024 lds
    v_mul_f32 v80, v80, v96
    v_mfma_f32_16x16x32_bf16 v[56:59], a[100:103], v[120:123], v[56:59]
    ds_read_b128 a[84:87], v4 offset:13312
    v_mfma_f32_16x16x32_bf16 v[60:63], a[100:103], v[124:127], v[60:63]
    v_mul_f32 v81, v81, v97
    v_mfma_f32_16x16x32_bf16 v[64:67], a[104:107], v[120:123], v[64:67]
    ds_read_b128 a[88:91], v4 offset:14336
    v_mul_f32 v82, v82, v98
    v_mfma_f32_16x16x32_bf16 v[68:71], a[104:107], v[124:127], v[68:71]
    buffer_load_dwordx4 v1, s[12:15], s24 offen offset:2048 lds
    v_mul_f32 v83, v83, v99
    v_mfma_f32_16x16x32_bf16 v[72:75], a[108:111], v[120:123], v[72:75]
    ds_read_b128 a[92:95], v4 offset:15360
    v_cvt_pk_bf16_f32 v8, v80, v81
    v_mfma_f32_16x16x32_bf16 v[76:79], a[108:111], v[124:127], v[76:79]
    v_cvt_pk_bf16_f32 v9, v82, v83
    s_waitcnt lgkmcnt(4)
    v_mfma_f32_16x16x32_bf16 v[48:51], a[112:115], v[128:131], v[48:51]
    ds_read_b128 a[96:99], v4 offset:16384
    buffer_load_dwordx4 a[172:175], v1, s[8:11], s44 offen offset:3072 sc1
    v_mfma_f32_16x16x32_bf16 v[52:55], a[112:115], v[132:135], v[52:55]
    buffer_load_dwordx4 v1, s[12:15], s24 offen offset:3072 lds
    v_max_f32 v88, 0, v88
    v_mfma_f32_16x16x32_bf16 v[56:59], a[116:119], v[128:131], v[56:59]
    ds_read_b128 a[100:103], v4 offset:17408
    v_max_f32 v89, 0, v89
    v_mfma_f32_16x16x32_bf16 v[60:63], a[116:119], v[132:135], v[60:63]
    v_max_f32 v90, 0, v90
    v_mfma_f32_16x16x32_bf16 v[64:67], a[120:123], v[128:131], v[64:67]
    ds_read_b128 a[104:107], v4 offset:18432
    v_max_f32 v91, 0, v91
    v_mfma_f32_16x16x32_bf16 v[68:71], a[120:123], v[132:135], v[68:71]
    s_add_u32 m0, s20, 40960
    v_mfma_f32_16x16x32_bf16 v[72:75], a[124:127], v[128:131], v[72:75]
    ds_read_b128 a[108:111], v4 offset:19456
    v_mul_f32 v88, v88, v104
    v_mfma_f32_16x16x32_bf16 v[76:79], a[124:127], v[132:135], v[76:79]
    v_mul_f32 v89, v89, v105
    s_waitcnt lgkmcnt(4)
    v_mfma_f32_16x16x32_bf16 v[48:51], a[80:83], v[136:139], v[48:51]
    ds_read_b128 a[112:115], v4 offset:20480
    v_mul_f32 v90, v90, v106
    v_mfma_f32_16x16x32_bf16 v[52:55], a[80:83], v[140:143], v[52:55]
    buffer_load_dwordx4 v1, s[12:15], s25 offen offset:0 lds
    v_mul_f32 v91, v91, v107
    v_mfma_f32_16x16x32_bf16 v[56:59], a[84:87], v[136:139], v[56:59]
    ds_read_b128 a[116:119], v4 offset:21504
    v_cvt_pk_bf16_f32 v10, v88, v89
    v_mfma_f32_16x16x32_bf16 v[60:63], a[84:87], v[140:143], v[60:63]
    s_add_u32 s44, s44, 0x1000
    v_mfma_f32_16x16x32_bf16 v[64:67], a[88:91], v[136:139], v[64:67]
    ds_read_b128 a[120:123], v4 offset:22528
    v_cvt_pk_bf16_f32 v11, v90, v91
    v_mfma_f32_16x16x32_bf16 v[68:71], a[88:91], v[140:143], v[68:71]
    buffer_load_dwordx4 v1, s[12:15], s25 offen offset:1024 lds
    buffer_store_dwordx4 v[8:11], v1, s[8:11], s41 offen offset:0 sc1
    v_mfma_f32_16x16x32_bf16 v[72:75], a[92:95], v[136:139], v[72:75]
    ds_read_b128 a[124:127], v4 offset:23552
    v_max_f32 v84, 0, v84
    v_mfma_f32_16x16x32_bf16 v[76:79], a[92:95], v[140:143], v[76:79]
    v_max_f32 v85, 0, v85
    s_waitcnt lgkmcnt(4)
    v_mfma_f32_16x16x32_bf16 v[48:51], a[96:99], v[144:147], v[48:51]
    ds_read_b128 a[80:83], v4 offset:24576
    v_max_f32 v86, 0, v86
    v_mfma_f32_16x16x32_bf16 v[52:55], a[96:99], v[148:151], v[52:55]
    buffer_load_dwordx4 v1, s[12:15], s25 offen offset:2048 lds
    v_mfma_f32_16x16x32_bf16 v[56:59], a[100:103], v[144:147], v[56:59]
    ds_read_b128 a[84:87], v4 offset:25600
    v_max_f32 v87, 0, v87
    v_mfma_f32_16x16x32_bf16 v[60:63], a[100:103], v[148:151], v[60:63]
    v_mul_f32 v84, v84, v100
    v_mfma_f32_16x16x32_bf16 v[64:67], a[104:107], v[144:147], v[64:67]
    ds_read_b128 a[88:91], v4 offset:26624
    v_mul_f32 v85, v85, v101
    v_mfma_f32_16x16x32_bf16 v[68:71], a[104:107], v[148:151], v[68:71]
    buffer_load_dwordx4 v1, s[12:15], s25 offen offset:3072 lds
    v_mul_f32 v86, v86, v102
    v_mfma_f32_16x16x32_bf16 v[72:75], a[108:111], v[144:147], v[72:75]
    ds_read_b128 a[92:95], v4 offset:27648
    v_mfma_f32_16x16x32_bf16 v[76:79], a[108:111], v[148:151], v[76:79]
    v_mul_f32 v87, v87, v103
    s_waitcnt lgkmcnt(4)
    v_mfma_f32_16x16x32_bf16 v[48:51], a[112:115], v[152:155], v[48:51]
    ds_read_b128 a[96:99], v4 offset:28672
    buffer_load_dwordx4 a[176:179], v1, s[8:11], s42 offen offset:0 sc1
    v_mfma_f32_16x16x32_bf16 v[52:55], a[112:115], v[156:159], v[52:55]
    v_cvt_pk_bf16_f32 v12, v84, v85
    s_add_u32 m0, s20, 45056
    v_mfma_f32_16x16x32_bf16 v[56:59], a[116:119], v[152:155], v[56:59]
    ds_read_b128 a[100:103], v4 offset:29696
    v_cvt_pk_bf16_f32 v13, v86, v87
    v_mfma_f32_16x16x32_bf16 v[60:63], a[116:119], v[156:159], v[60:63]
    v_max_f32 v92, 0, v92
    v_max_f32 v93, 0, v93
    v_mfma_f32_16x16x32_bf16 v[64:67], a[120:123], v[152:155], v[64:67]
    ds_read_b128 a[104:107], v4 offset:30720
    v_mfma_f32_16x16x32_bf16 v[68:71], a[120:123], v[156:159], v[68:71]
    buffer_load_dwordx4 v1, s[12:15], s26 offen offset:0 lds
    v_max_f32 v94, 0, v94
    v_mfma_f32_16x16x32_bf16 v[72:75], a[124:127], v[152:155], v[72:75]
    ds_read_b128 a[108:111], v4 offset:31744
    v_max_f32 v95, 0, v95
    v_mfma_f32_16x16x32_bf16 v[76:79], a[124:127], v[156:159], v[76:79]
    v_mul_f32 v92, v92, v108
    s_waitcnt lgkmcnt(4)
    v_mfma_f32_16x16x32_bf16 v[48:51], a[80:83], v[160:163], v[48:51]
    ds_read_b128 a[112:115], v4 offset:32768
    v_mul_f32 v93, v93, v109
    v_mfma_f32_16x16x32_bf16 v[52:55], a[80:83], v[164:167], v[52:55]
    v_mul_f32 v94, v94, v110
    v_mfma_f32_16x16x32_bf16 v[56:59], a[84:87], v[160:163], v[56:59]
    ds_read_b128 a[116:119], v4 offset:33792
    v_mfma_f32_16x16x32_bf16 v[60:63], a[84:87], v[164:167], v[60:63]
    s_add_u32 s24, s24, 36864
    s_add_u32 s25, s25, 36864
    v_mfma_f32_16x16x32_bf16 v[64:67], a[88:91], v[160:163], v[64:67]
    ds_read_b128 a[120:123], v4 offset:34816
    s_add_u32 s26, s26, 36864
    v_mfma_f32_16x16x32_bf16 v[68:71], a[88:91], v[164:167], v[68:71]
    v_mul_f32 v95, v95, v111
    buffer_load_dwordx4 a[180:183], v1, s[8:11], s42 offen offset:1024 sc1
    v_mfma_f32_16x16x32_bf16 v[72:75], a[92:95], v[160:163], v[72:75]
    ds_read_b128 a[124:127], v4 offset:35840
    v_cvt_pk_bf16_f32 v14, v92, v93
    v_mfma_f32_16x16x32_bf16 v[76:79], a[92:95], v[164:167], v[76:79]
    v_cvt_pk_bf16_f32 v15, v94, v95
    s_waitcnt lgkmcnt(4)
    v_mfma_f32_16x16x32_bf16 v[48:51], a[96:99], v[168:171], v[48:51]
    ds_read_b128 a[80:83], v5 offset:0
    buffer_store_dwordx4 v[12:15], v1, s[8:11], s41 offen offset:1024 sc1
    v_mfma_f32_16x16x32_bf16 v[52:55], a[96:99], v[172:175], v[52:55]
    s_set_gpr_idx_on s30, gpr_idx(DST)
    v_accvgpr_write_b32 a0, v8
    v_accvgpr_write_b32 a1, v9
    s_set_gpr_idx_off
    v_mfma_f32_16x16x32_bf16 v[56:59], a[100:103], v[168:171], v[56:59]
    ds_read_b128 a[84:87], v5 offset:1024
    v_mfma_f32_16x16x32_bf16 v[60:63], a[100:103], v[172:175], v[60:63]
    s_set_gpr_idx_on s30, gpr_idx(DST)
    v_accvgpr_write_b32 a2, v10
    v_accvgpr_write_b32 a3, v11
    s_set_gpr_idx_off
    v_mfma_f32_16x16x32_bf16 v[64:67], a[104:107], v[168:171], v[64:67]
    ds_read_b128 a[88:91], v5 offset:2048
    v_mfma_f32_16x16x32_bf16 v[68:71], a[104:107], v[172:175], v[68:71]
    s_set_gpr_idx_on s30, gpr_idx(DST)
    v_accvgpr_write_b32 a4, v12
    v_accvgpr_write_b32 a5, v13
    s_set_gpr_idx_off
    v_mfma_f32_16x16x32_bf16 v[72:75], a[108:111], v[168:171], v[72:75]
    ds_read_b128 a[92:95], v5 offset:3072
    v_mfma_f32_16x16x32_bf16 v[76:79], a[108:111], v[172:175], v[76:79]
    s_waitcnt lgkmcnt(4)
    v_mfma_f32_16x16x32_bf16 v[48:51], a[112:115], v[176:179], v[48:51]
    ds_read_b128 a[96:99], v5 offset:4096
    s_set_gpr_idx_on s30, gpr_idx(DST)
    v_accvgpr_write_b32 a6, v14
    v_accvgpr_write_b32 a7, v15
    s_set_gpr_idx_off
    v_mfma_f32_16x16x32_bf16 v[52:55], a[112:115], v[180:183], v[52:55]
    v_mfma_f32_16x16x32_bf16 v[56:59], a[116:119], v[176:179], v[56:59]
    ds_read_b128 a[100:103], v5 offset:5120
    s_add_u32 s30, s30, 8
    v_mfma_f32_16x16x32_bf16 v[60:63], a[116:119], v[180:183], v[60:63]
    v_mfma_f32_16x16x32_bf16 v[64:67], a[120:123], v[176:179], v[64:67]
    ds_read_b128 a[104:107], v5 offset:6144
    s_add_u32 s41, s41, 0x800
    v_mfma_f32_16x16x32_bf16 v[68:71], a[120:123], v[180:183], v[68:71]
    v_mfma_f32_16x16x32_bf16 v[72:75], a[124:127], v[176:179], v[72:75]
    ds_read_b128 a[108:111], v5 offset:7168
    v_mfma_f32_16x16x32_bf16 v[76:79], a[124:127], v[180:183], v[76:79]
    s_waitcnt vmcnt(16)
    s_barrier
    s_waitcnt lgkmcnt(4)
    v_mfma_f32_16x16x32_bf16 v[48:51], a[80:83], v[184:187], v[48:51]
    ds_read_b128 a[112:115], v5 offset:8192
    v_mfma_f32_16x16x32_bf16 v[52:55], a[80:83], v[188:191], v[52:55]
    s_add_u32 m0, s20, 73728
    v_mfma_f32_16x16x32_bf16 v[56:59], a[84:87], v[184:187], v[56:59]
    ds_read_b128 a[116:119], v5 offset:9216
    v_mfma_f32_16x16x32_bf16 v[60:63], a[84:87], v[188:191], v[60:63]
    buffer_load_dwordx4 a[184:187], v1, s[8:11], s43 offen offset:0 sc1
    v_mfma_f32_16x16x32_bf16 v[64:67], a[88:91], v[184:187], v[64:67]
    ds_read_b128 a[120:123], v5 offset:10240
    v_mfma_f32_16x16x32_bf16 v[68:71], a[88:91], v[188:191], v[68:71]
    buffer_load_dwordx4 v1, s[12:15], s24 offen offset:0 lds
    v_mfma_f32_16x16x32_bf16 v[72:75], a[92:95], v[184:187], v[72:75]
    ds_read_b128 a[124:127], v5 offset:11264
    v_mfma_f32_16x16x32_bf16 v[76:79], a[92:95], v[188:191], v[76:79]
    s_waitcnt lgkmcnt(4)
    v_mfma_f32_16x16x32_bf16 v[48:51], a[96:99], v[192:195], v[48:51]
    ds_read_b128 a[80:83], v5 offset:12288
    v_mfma_f32_16x16x32_bf16 v[52:55], a[96:99], v[196:199], v[52:55]
    buffer_load_dwordx4 v1, s[12:15], s24 offen offset:1024 lds
    v_mfma_f32_16x16x32_bf16 v[56:59], a[100:103], v[192:195], v[56:59]
    ds_read_b128 a[84:87], v5 offset:13312
    v_mfma_f32_16x16x32_bf16 v[60:63], a[100:103], v[196:199], v[60:63]
    v_mfma_f32_16x16x32_bf16 v[64:67], a[104:107], v[192:195], v[64:67]
    ds_read_b128 a[88:91], v5 offset:14336
    v_mfma_f32_16x16x32_bf16 v[68:71], a[104:107], v[196:199], v[68:71]
    buffer_load_dwordx4 v1, s[12:15], s24 offen offset:2048 lds
    v_mfma_f32_16x16x32_bf16 v[72:75], a[108:111], v[192:195], v[72:75]
    ds_read_b128 a[92:95], v5 offset:15360
    v_mfma_f32_16x16x32_bf16 v[76:79], a[108:111], v[196:199], v[76:79]
    s_waitcnt lgkmcnt(4)
    v_mfma_f32_16x16x32_bf16 v[48:51], a[112:115], v[200:203], v[48:51]
    ds_read_b128 a[96:99], v5 offset:16384
    v_mfma_f32_16x16x32_bf16 v[52:55], a[112:115], v[204:207], v[52:55]
    buffer_load_dwordx4 v1, s[12:15], s24 offen offset:3072 lds
    v_mfma_f32_16x16x32_bf16 v[56:59], a[116:119], v[200:203], v[56:59]
    ds_read_b128 a[100:103], v5 offset:17408
    buffer_load_dwordx4 a[188:191], v1, s[8:11], s43 offen offset:1024 sc1
    v_mfma_f32_16x16x32_bf16 v[60:63], a[116:119], v[204:207], v[60:63]
    v_mfma_f32_16x16x32_bf16 v[64:67], a[120:123], v[200:203], v[64:67]
    ds_read_b128 a[104:107], v5 offset:18432
    v_mfma_f32_16x16x32_bf16 v[68:71], a[120:123], v[204:207], v[68:71]
    s_add_u32 m0, s20, 77824
    v_mfma_f32_16x16x32_bf16 v[72:75], a[124:127], v[200:203], v[72:75]
    ds_read_b128 a[108:111], v5 offset:19456
    v_mfma_f32_16x16x32_bf16 v[76:79], a[124:127], v[204:207], v[76:79]
    s_waitcnt lgkmcnt(4)
    v_mfma_f32_16x16x32_bf16 v[48:51], a[80:83], v[208:211], v[48:51]
    ds_read_b128 a[112:115], v5 offset:20480
    v_mfma_f32_16x16x32_bf16 v[52:55], a[80:83], v[212:215], v[52:55]
    buffer_load_dwordx4 v1, s[12:15], s25 offen offset:0 lds
    v_mfma_f32_16x16x32_bf16 v[56:59], a[84:87], v[208:211], v[56:59]
    ds_read_b128 a[116:119], v5 offset:21504
    v_mfma_f32_16x16x32_bf16 v[60:63], a[84:87], v[212:215], v[60:63]
    v_mfma_f32_16x16x32_bf16 v[64:67], a[88:91], v[208:211], v[64:67]
    ds_read_b128 a[120:123], v5 offset:22528
    v_mfma_f32_16x16x32_bf16 v[68:71], a[88:91], v[212:215], v[68:71]
    buffer_load_dwordx4 v1, s[12:15], s25 offen offset:1024 lds
    v_mfma_f32_16x16x32_bf16 v[72:75], a[92:95], v[208:211], v[72:75]
    ds_read_b128 a[124:127], v5 offset:23552
    v_mfma_f32_16x16x32_bf16 v[76:79], a[92:95], v[212:215], v[76:79]
    s_waitcnt lgkmcnt(4)
    v_mfma_f32_16x16x32_bf16 v[48:51], a[96:99], v[216:219], v[48:51]
    ds_read_b128 a[80:83], v5 offset:24576
    v_mfma_f32_16x16x32_bf16 v[52:55], a[96:99], v[220:223], v[52:55]
    buffer_load_dwordx4 v1, s[12:15], s25 offen offset:2048 lds
    buffer_load_dwordx4 a[192:195], v1, s[8:11], s44 offen offset:0 sc1
    v_mfma_f32_16x16x32_bf16 v[56:59], a[100:103], v[216:219], v[56:59]
    ds_read_b128 a[84:87], v5 offset:25600
    v_mfma_f32_16x16x32_bf16 v[60:63], a[100:103], v[220:223], v[60:63]
    v_mfma_f32_16x16x32_bf16 v[64:67], a[104:107], v[216:219], v[64:67]
    ds_read_b128 a[88:91], v5 offset:26624
    v_mfma_f32_16x16x32_bf16 v[68:71], a[104:107], v[220:223], v[68:71]
    buffer_load_dwordx4 v1, s[12:15], s25 offen offset:3072 lds
    v_mfma_f32_16x16x32_bf16 v[72:75], a[108:111], v[216:219], v[72:75]
    ds_read_b128 a[92:95], v5 offset:27648
    v_mfma_f32_16x16x32_bf16 v[76:79], a[108:111], v[220:223], v[76:79]
    s_waitcnt lgkmcnt(4)
    v_mfma_f32_16x16x32_bf16 v[48:51], a[112:115], v[224:227], v[48:51]
    ds_read_b128 a[96:99], v5 offset:28672
    v_mfma_f32_16x16x32_bf16 v[52:55], a[112:115], v[228:231], v[52:55]
    s_add_u32 m0, s20, 81920
    v_mfma_f32_16x16x32_bf16 v[56:59], a[116:119], v[224:227], v[56:59]
    ds_read_b128 a[100:103], v5 offset:29696
    v_mfma_f32_16x16x32_bf16 v[60:63], a[116:119], v[228:231], v[60:63]
    v_mfma_f32_16x16x32_bf16 v[64:67], a[120:123], v[224:227], v[64:67]
    ds_read_b128 a[104:107], v5 offset:30720
    v_mfma_f32_16x16x32_bf16 v[68:71], a[120:123], v[228:231], v[68:71]
    buffer_load_dwordx4 v1, s[12:15], s26 offen offset:0 lds
    v_mfma_f32_16x16x32_bf16 v[72:75], a[124:127], v[224:227], v[72:75]
    ds_read_b128 a[108:111], v5 offset:31744
    v_mfma_f32_16x16x32_bf16 v[76:79], a[124:127], v[228:231], v[76:79]
    s_waitcnt lgkmcnt(4)
    v_mfma_f32_16x16x32_bf16 v[48:51], a[80:83], v[232:235], v[48:51]
    ds_read_b128 a[112:115], v5 offset:32768
    buffer_load_dwordx4 a[196:199], v1, s[8:11], s44 offen offset:1024 sc1
    v_mfma_f32_16x16x32_bf16 v[52:55], a[80:83], v[236:239], v[52:55]
    v_mfma_f32_16x16x32_bf16 v[56:59], a[84:87], v[232:235], v[56:59]
    ds_read_b128 a[116:119], v5 offset:33792
    v_mfma_f32_16x16x32_bf16 v[60:63], a[84:87], v[236:239], v[60:63]
    s_add_u32 s24, s24, 36864
    s_add_u32 s25, s25, 36864
    v_mfma_f32_16x16x32_bf16 v[64:67], a[88:91], v[232:235], v[64:67]
    ds_read_b128 a[120:123], v5 offset:34816
    s_add_u32 s26, s26, 36864
    v_mfma_f32_16x16x32_bf16 v[68:71], a[88:91], v[236:239], v[68:71]
    v_mfma_f32_16x16x32_bf16 v[72:75], a[92:95], v[232:235], v[72:75]
    ds_read_b128 a[124:127], v5 offset:35840
    v_mfma_f32_16x16x32_bf16 v[76:79], a[92:95], v[236:239], v[76:79]
    s_waitcnt lgkmcnt(4)
    v_mfma_f32_16x16x32_bf16 v[48:51], a[96:99], v[240:243], v[48:51]
    ds_read_b128 a[80:83], v6 offset:0
    v_mfma_f32_16x16x32_bf16 v[52:55], a[96:99], v[244:247], v[52:55]
    v_mfma_f32_16x16x32_bf16 v[56:59], a[100:103], v[240:243], v[56:59]
    ds_read_b128 a[84:87], v6 offset:1024
    v_mfma_f32_16x16x32_bf16 v[60:63], a[100:103], v[244:247], v[60:63]
    v_mfma_f32_16x16x32_bf16 v[64:67], a[104:107], v[240:243], v[64:67]
    ds_read_b128 a[88:91], v6 offset:2048
    v_mfma_f32_16x16x32_bf16 v[68:71], a[104:107], v[244:247], v[68:71]
    v_mfma_f32_16x16x32_bf16 v[72:75], a[108:111], v[240:243], v[72:75]
    ds_read_b128 a[92:95], v6 offset:3072
    v_mfma_f32_16x16x32_bf16 v[76:79], a[108:111], v[244:247], v[76:79]
    s_waitcnt lgkmcnt(4)
    v_mfma_f32_16x16x32_bf16 v[48:51], a[112:115], v[248:251], v[48:51]
    ds_read_b128 a[96:99], v6 offset:4096
    v_mfma_f32_16x16x32_bf16 v[52:55], a[112:115], v[252:255], v[52:55]
    v_mfma_f32_16x16x32_bf16 v[56:59], a[116:119], v[248:251], v[56:59]
    ds_read_b128 a[100:103], v6 offset:5120
    v_mfma_f32_16x16x32_bf16 v[60:63], a[116:119], v[252:255], v[60:63]
    v_mfma_f32_16x16x32_bf16 v[64:67], a[120:123], v[248:251], v[64:67]
    ds_read_b128 a[104:107], v6 offset:6144
    v_mfma_f32_16x16x32_bf16 v[68:71], a[120:123], v[252:255], v[68:71]
    v_mfma_f32_16x16x32_bf16 v[72:75], a[124:127], v[248:251], v[72:75]
    ds_read_b128 a[108:111], v6 offset:7168
    v_mfma_f32_16x16x32_bf16 v[76:79], a[124:127], v[252:255], v[76:79]
    s_waitcnt vmcnt(13)
    s_barrier
K5_chk1:
    v_min_i32 v25, v20, v21
    v_min3_i32 v25, v22, v23, v25
    v_cmp_gt_i32 vcc, 5, v25
    s_cbranch_vccz K5_ok1
    s_sleep 2
    buffer_load_dwordx4 v[20:23], v24, s[8:11], s45 offen sc1
    s_waitcnt vmcnt(0)
    s_branch K5_chk1
K5_ok1:
    s_waitcnt lgkmcnt(4)
    v_mfma_f32_16x16x32_bf16 v[80:83], a[80:83], v[112:115], 0
    ds_read_b128 a[112:115], v6 offset:8192
    v_mov_b32 v19, 7
    v_mfma_f32_16x16x32_bf16 v[84:87], a[80:83], v[116:119], 0
    buffer_store_dword v19, v18, s[8:11], s46 offen sc1
    s_add_u32 m0, s20, 110592
    v_mfma_f32_16x16x32_bf16 v[88:91], a[84:87], v[112:115], 0
    ds_read_b128 a[116:119], v6 offset:9216
    v_mfma_f32_16x16x32_bf16 v[92:95], a[84:87], v[116:119], 0
    buffer_load_dwordx4 a[200:203], v1, s[8:11], s42 offen offset:2048 sc1
    v_mfma_f32_16x16x32_bf16 v[96:99], a[88:91], v[112:115], 0
    ds_read_b128 a[120:123], v6 offset:10240
    v_mfma_f32_16x16x32_bf16 v[100:103], a[88:91], v[116:119], 0
    buffer_load_dwordx4 v1, s[12:15], s24 offen offset:0 lds
    v_max_f32 v48, 0, v48
    v_mfma_f32_16x16x32_bf16 v[104:107], a[92:95], v[112:115], 0
    ds_read_b128 a[124:127], v6 offset:11264
    v_max_f32 v49, 0, v49
    v_mfma_f32_16x16x32_bf16 v[108:111], a[92:95], v[116:119], 0
    v_max_f32 v50, 0, v50
    s_waitcnt lgkmcnt(4)
    v_mfma_f32_16x16x32_bf16 v[80:83], a[96:99], v[120:123], v[80:83]
    ds_read_b128 a[80:83], v6 offset:12288
    v_max_f32 v51, 0, v51
    v_mfma_f32_16x16x32_bf16 v[84:87], a[96:99], v[124:127], v[84:87]
    buffer_load_dwordx4 v1, s[12:15], s24 offen offset:1024 lds
    v_mul_f32 v48, v48, v64
    v_mfma_f32_16x16x32_bf16 v[88:91], a[100:103], v[120:123], v[88:91]
    ds_read_b128 a[84:87], v6 offset:13312
    v_mfma_f32_16x16x32_bf16 v[92:95], a[100:103], v[124:127], v[92:95]
    v_mul_f32 v49, v49, v65
    v_mfma_f32_16x16x32_bf16 v[96:99], a[104:107], v[120:123], v[96:99]
    ds_read_b128 a[88:91], v6 offset:14336
    v_mul_f32 v50, v50, v66
    v_mfma_f32_16x16x32_bf16 v[100:103], a[104:107], v[124:127], v[100:103]
    buffer_load_dwordx4 v1, s[12:15], s24 offen offset:2048 lds
    v_mul_f32 v51, v51, v67
    v_mfma_f32_16x16x32_bf16 v[104:107], a[108:111], v[120:123], v[104:107]
    ds_read_b128 a[92:95], v6 offset:15360
    buffer_load_dwordx4 a[204:207], v1, s[8:11], s42 offen offset:3072 sc1
    v_mfma_f32_16x16x32_bf16 v[108:111], a[108:111], v[124:127], v[108:111]
    v_cvt_pk_bf16_f32 v8, v48, v49
    s_waitcnt lgkmcnt(4)
    v_mfma_f32_16x16x32_bf16 v[80:83], a[112:115], v[128:131], v[80:83]
    ds_read_b128 a[96:99], v6 offset:16384
    v_cvt_pk_bf16_f32 v9, v50, v51
    v_mfma_f32_16x16x32_bf16 v[84:87], a[112:115], v[132:135], v[84:87]
    buffer_load_dwordx4 v1, s[12:15], s24 offen offset:3072 lds
    v_max_f32 v56, 0, v56
    v_mfma_f32_16x16x32_bf16 v[88:91], a[116:119], v[128:131], v[88:91]
    ds_read_b128 a[100:103], v6 offset:17408
    v_max_f32 v57, 0, v57
    v_mfma_f32_16x16x32_bf16 v[92:95], a[116:119], v[132:135], v[92:95]
    v_max_f32 v58, 0, v58
    v_mfma_f32_16x16x32_bf16 v[96:99], a[120:123], v[128:131], v[96:99]
    ds_read_b128 a[104:107], v6 offset:18432
    v_max_f32 v59, 0, v59
    v_mfma_f32_16x16x32_bf16 v[100:103], a[120:123], v[132:135], v[100:103]
    s_add_u32 m0, s20, 114688
    v_mfma_f32_16x16x32_bf16 v[104:107], a[124:127], v[128:131], v[104:107]
    ds_read_b128 a[108:111], v6 offset:19456
    v_mul_f32 v56, v56, v72
    v_mfma_f32_16x16x32_bf16 v[108:111], a[124:127], v[132:135], v[108:111]
    v_mul_f32 v57, v57, v73
    s_waitcnt lgkmcnt(4)
    v_mfma_f32_16x16x32_bf16 v[80:83], a[80:83], v[136:139], v[80:83]
    ds_read_b128 a[112:115], v6 offset:20480
    s_add_u32 s42, s42, 0x1000
    v_mfma_f32_16x16x32_bf16 v[84:87], a[80:83], v[140:143], v[84:87]
    v_mul_f32 v58, v58, v74
    buffer_load_dwordx4 v1, s[12:15], s25 offen offset:0 lds
    v_mfma_f32_16x16x32_bf16 v[88:91], a[84:87], v[136:139], v[88:91]
    ds_read_b128 a[116:119], v6 offset:21504
    v_mul_f32 v59, v59, v75
    v_mfma_f32_16x16x32_bf16 v[92:95], a[84:87], v[140:143], v[92:95]
    v_cvt_pk_bf16_f32 v10, v56, v57
    v_mfma_f32_16x16x32_bf16 v[96:99], a[88:91], v[136:139], v[96:99]
    ds_read_b128 a[120:123], v6 offset:22528
    v_cvt_pk_bf16_f32 v11, v58, v59
    v_mfma_f32_16x16x32_bf16 v[100:103], a[88:91], v[140:143], v[100:103]
    buffer_load_dwordx4 v1, s[12:15], s25 offen offset:1024 lds
    buffer_store_dwordx4 v[8:11], v1, s[8:11], s41 offen offset:0 sc1
    v_mfma_f32_16x16x32_bf16 v[104:107], a[92:95], v[136:139], v[104:107]
    ds_read_b128 a[124:127], v6 offset:23552
    v_max_f32 v52, 0, v52
    v_mfma_f32_16x16x32_bf16 v[108:111], a[92:95], v[140:143], v[108:111]
    v_max_f32 v53, 0, v53
    s_waitcnt lgkmcnt(4)
    v_mfma_f32_16x16x32_bf16 v[80:83], a[96:99], v[144:147], v[80:83]
    ds_read_b128 a[80:83], v6 offset:24576
    v_max_f32 v54, 0, v54
    v_mfma_f32_16x16x32_bf16 v[84:87], a[96:99], v[148:151], v[84:87]
    buffer_load_dwordx4 v1, s[12:15], s25 offen offset:2048 lds
    buffer_load_dwordx4 a[208:211], v1, s[8:11], s43 offen offset:2048 sc1
    v_mfma_f32_16x16x32_bf16 v[88:91], a[100:103], v[144:147], v[88:91]
    ds_read_b128 a[84:87], v6 offset:25600
    v_max_f32 v55, 0, v55
    v_mfma_f32_16x16x32_bf16 v[92:95], a[100:103], v[148:151], v[92:95]
    v_mul_f32 v52, v52, v68
    v_mfma_f32_16x16x32_bf16 v[96:99], a[104:107], v[144:147], v[96:99]
    ds_read_b128 a[88:91], v6 offset:26624
    v_mul_f32 v53, v53, v69
    v_mfma_f32_16x16x32_bf16 v[100:103], a[104:107], v[148:151], v[100:103]
    buffer_load_dwordx4 v1, s[12:15], s25 offen offset:3072 lds
    v_mul_f32 v54, v54, v70
    v_mfma_f32_16x16x32_bf16 v[104:107], a[108:111], v[144:147], v[104:107]
    ds_read_b128 a[92:95], v6 offset:27648
    v_mfma_f32_16x16x32_bf16 v[108:111], a[108:111], v[148:151], v[108:111]
    v_mul_f32 v55, v55, v71
    s_waitcnt lgkmcnt(4)
    v_mfma_f32_16x16x32_bf16 v[80:83], a[112:115], v[152:155], v[80:83]
    ds_read_b128 a[96:99], v6 offset:28672
    v_cvt_pk_bf16_f32 v12, v52, v53
    v_mfma_f32_16x16x32_bf16 v[84:87], a[112:115], v[156:159], v[84:87]
    s_add_u32 m0, s20, 118784
    v_cvt_pk_bf16_f32 v13, v54, v55
    v_mfma_f32_16x16x32_bf16 v[88:91], a[116:119], v[152:155], v[88:91]
    ds_read_b128 a[100:103], v6 offset:29696
    v_max_f32 v60, 0, v60
    v_mfma_f32_16x16x32_bf16 v[92:95], a[116:119], v[156:159], v[92:95]
    v_max_f32 v61, 0, v61
    buffer_load_dwordx4 a[212:215], v1, s[8:11], s43 offen offset:3072 sc1
    v_mfma_f32_16x16x32_bf16 v[96:99], a[120:123], v[152:155], v[96:99]
    ds_read_b128 a[104:107], v6 offset:30720
    v_mfma_f32_16x16x32_bf16 v[100:103], a[120:123], v[156:159], v[100:103]
    buffer_load_dwordx4 v1, s[12:15], s26 offen offset:0 lds
    v_max_f32 v62, 0, v62
    v_mfma_f32_16x16x32_bf16 v[104:107], a[124:127], v[152:155], v[104:107]
    ds_read_b128 a[108:111], v6 offset:31744
    v_max_f32 v63, 0, v63
    v_mfma_f32_16x16x32_bf16 v[108:111], a[124:127], v[156:159], v[108:111]
    v_mul_f32 v60, v60, v76
    s_waitcnt lgkmcnt(4)
    v_mfma_f32_16x16x32_bf16 v[80:83], a[80:83], v[160:163], v[80:83]
    ds_read_b128 a[112:115], v6 offset:32768
    v_mul_f32 v61, v61, v77
    v_mfma_f32_16x16x32_bf16 v[84:87], a[80:83], v[164:167], v[84:87]
    v_mul_f32 v62, v62, v78
    v_mfma_f32_16x16x32_bf16 v[88:91], a[84:87], v[160:163], v[88:91]
    ds_read_b128 a[116:119], v6 offset:33792
    v_mfma_f32_16x16x32_bf16 v[92:95], a[84:87], v[164:167], v[92:95]
    s_add_u32 s24, s24, 36864
    s_add_u32 s25, s25, 36864
    v_mfma_f32_16x16x32_bf16 v[96:99], a[88:91], v[160:163], v[96:99]
    ds_read_b128 a[120:123], v6 offset:34816
    s_add_u32 s26, s26, 36864
    v_mfma_f32_16x16x32_bf16 v[100:103], a[88:91], v[164:167], v[100:103]
    v_mul_f32 v63, v63, v79
    v_cvt_pk_bf16_f32 v14, v60, v61
    v_mfma_f32_16x16x32_bf16 v[104:107], a[92:95], v[160:163], v[104:107]
    ds_read_b128 a[124:127], v6 offset:35840
    v_cvt_pk_bf16_f32 v15, v62, v63
    v_mfma_f32_16x16x32_bf16 v[108:111], a[92:95], v[164:167], v[108:111]
    s_add_u32 s43, s43, 0x1000
    s_waitcnt lgkmcnt(4)
    v_mfma_f32_16x16x32_bf16 v[80:83], a[96:99], v[168:171], v[80:83]
    ds_read_b128 a[80:83], v7 offset:0
    buffer_store_dwordx4 v[12:15], v1, s[8:11], s41 offen offset:1024 sc1
    v_mfma_f32_16x16x32_bf16 v[84:87], a[96:99], v[172:175], v[84:87]
    s_set_gpr_idx_on s30, gpr_idx(DST)
    v_accvgpr_write_b32 a0, v8
    v_accvgpr_write_b32 a1, v9
    s_set_gpr_idx_off
    v_mfma_f32_16x16x32_bf16 v[88:91], a[100:103], v[168:171], v[88:91]
    ds_read_b128 a[84:87], v7 offset:1024
    v_mfma_f32_16x16x32_bf16 v[92:95], a[100:103], v[172:175], v[92:95]
    s_set_gpr_idx_on s30, gpr_idx(DST)
    v_accvgpr_write_b32 a2, v10
    v_accvgpr_write_b32 a3, v11
    s_set_gpr_idx_off
    v_mfma_f32_16x16x32_bf16 v[96:99], a[104:107], v[168:171], v[96:99]
    ds_read_b128 a[88:91], v7 offset:2048
    v_mfma_f32_16x16x32_bf16 v[100:103], a[104:107], v[172:175], v[100:103]
    s_set_gpr_idx_on s30, gpr_idx(DST)
    v_accvgpr_write_b32 a4, v12
    v_accvgpr_write_b32 a5, v13
    s_set_gpr_idx_off
    v_mfma_f32_16x16x32_bf16 v[104:107], a[108:111], v[168:171], v[104:107]
    ds_read_b128 a[92:95], v7 offset:3072
    v_mfma_f32_16x16x32_bf16 v[108:111], a[108:111], v[172:175], v[108:111]
    s_waitcnt lgkmcnt(4)
    v_mfma_f32_16x16x32_bf16 v[80:83], a[112:115], v[176:179], v[80:83]
    ds_read_b128 a[96:99], v7 offset:4096
    s_set_gpr_idx_on s30, gpr_idx(DST)
    v_accvgpr_write_b32 a6, v14
    v_accvgpr_write_b32 a7, v15
    s_set_gpr_idx_off
    v_mfma_f32_16x16x32_bf16 v[84:87], a[112:115], v[180:183], v[84:87]
    v_mfma_f32_16x16x32_bf16 v[88:91], a[116:119], v[176:179], v[88:91]
    ds_read_b128 a[100:103], v7 offset:5120
    s_add_u32 s30, s30, 8
    v_mfma_f32_16x16x32_bf16 v[92:95], a[116:119], v[180:183], v[92:95]
    v_mfma_f32_16x16x32_bf16 v[96:99], a[120:123], v[176:179], v[96:99]
    ds_read_b128 a[104:107], v7 offset:6144
    s_add_u32 s41, s41, 0x800
    v_mfma_f32_16x16x32_bf16 v[100:103], a[120:123], v[180:183], v[100:103]
    v_mfma_f32_16x16x32_bf16 v[104:107], a[124:127], v[176:179], v[104:107]
    ds_read_b128 a[108:111], v7 offset:7168
    v_mfma_f32_16x16x32_bf16 v[108:111], a[124:127], v[180:183], v[108:111]
    s_waitcnt vmcnt(16)
    s_barrier
    s_waitcnt lgkmcnt(4)
    v_mfma_f32_16x16x32_bf16 v[80:83], a[80:83], v[184:187], v[80:83]
    ds_read_b128 a[112:115], v7 offset:8192
    v_mfma_f32_16x16x32_bf16 v[84:87], a[80:83], v[188:191], v[84:87]
    s_add_u32 m0, s20, 0
    v_mfma_f32_16x16x32_bf16 v[88:91], a[84:87], v[184:187], v[88:91]
    ds_read_b128 a[116:119], v7 offset:9216
    v_mfma_f32_16x16x32_bf16 v[92:95], a[84:87], v[188:191], v[92:95]
    buffer_load_dwordx4 a[216:219], v1, s[8:11], s44 offen offset:2048 sc1
    v_mfma_f32_16x16x32_bf16 v[96:99], a[88:91], v[184:187], v[96:99]
    ds_read_b128 a[120:123], v7 offset:10240
    v_mfma_f32_16x16x32_bf16 v[100:103], a[88:91], v[188:191], v[100:103]
    buffer_load_dwordx4 v1, s[12:15], s24 offen offset:0 lds
    v_mfma_f32_16x16x32_bf16 v[104:107], a[92:95], v[184:187], v[104:107]
    ds_read_b128 a[124:127], v7 offset:11264
    v_mfma_f32_16x16x32_bf16 v[108:111], a[92:95], v[188:191], v[108:111]
    s_waitcnt lgkmcnt(4)
    v_mfma_f32_16x16x32_bf16 v[80:83], a[96:99], v[192:195], v[80:83]
    ds_read_b128 a[80:83], v7 offset:12288
    v_mfma_f32_16x16x32_bf16 v[84:87], a[96:99], v[196:199], v[84:87]
    buffer_load_dwordx4 v1, s[12:15], s24 offen offset:1024 lds
    v_mfma_f32_16x16x32_bf16 v[88:91], a[100:103], v[192:195], v[88:91]
    ds_read_b128 a[84:87], v7 offset:13312
    v_mfma_f32_16x16x32_bf16 v[92:95], a[100:103], v[196:199], v[92:95]
    v_mfma_f32_16x16x32_bf16 v[96:99], a[104:107], v[192:195], v[96:99]
    ds_read_b128 a[88:91], v7 offset:14336
    v_mfma_f32_16x16x32_bf16 v[100:103], a[104:107], v[196:199], v[100:103]
    buffer_load_dwordx4 v1, s[12:15], s24 offen offset:2048 lds
    v_mfma_f32_16x16x32_bf16 v[104:107], a[108:111], v[192:195], v[104:107]
    ds_read_b128 a[92:95], v7 offset:15360
    v_mfma_f32_16x16x32_bf16 v[108:111], a[108:111], v[196:199], v[108:111]
    buffer_load_dwordx4 a[220:223], v1, s[8:11], s44 offen offset:3072 sc1
    s_waitcnt lgkmcnt(4)
    v_mfma_f32_16x16x32_bf16 v[80:83], a[112:115], v[200:203], v[80:83]
    ds_read_b128 a[96:99], v7 offset:16384
    v_mfma_f32_16x16x32_bf16 v[84:87], a[112:115], v[204:207], v[84:87]
    buffer_load_dwordx4 v1, s[12:15], s24 offen offset:3072 lds
    v_mfma_f32_16x16x32_bf16 v[88:91], a[116:119], v[200:203], v[88:91]
    ds_read_b128 a[100:103], v7 offset:17408
    v_mfma_f32_16x16x32_bf16 v[92:95], a[116:119], v[204:207], v[92:95]
    v_mfma_f32_16x16x32_bf16 v[96:99], a[120:123], v[200:203], v[96:99]
    ds_read_b128 a[104:107], v7 offset:18432
    v_mfma_f32_16x16x32_bf16 v[100:103], a[120:123], v[204:207], v[100:103]
    s_add_u32 m0, s20, 4096
    v_mfma_f32_16x16x32_bf16 v[104:107], a[124:127], v[200:203], v[104:107]
    ds_read_b128 a[108:111], v7 offset:19456
    v_mfma_f32_16x16x32_bf16 v[108:111], a[124:127], v[204:207], v[108:111]
    s_waitcnt lgkmcnt(4)
    v_mfma_f32_16x16x32_bf16 v[80:83], a[80:83], v[208:211], v[80:83]
    ds_read_b128 a[112:115], v7 offset:20480
    v_mfma_f32_16x16x32_bf16 v[84:87], a[80:83], v[212:215], v[84:87]
    buffer_load_dwordx4 v1, s[12:15], s25 offen offset:0 lds
    v_mfma_f32_16x16x32_bf16 v[88:91], a[84:87], v[208:211], v[88:91]
    ds_read_b128 a[116:119], v7 offset:21504
    v_mfma_f32_16x16x32_bf16 v[92:95], a[84:87], v[212:215], v[92:95]
    s_add_u32 s44, s44, 0x1000
    v_mfma_f32_16x16x32_bf16 v[96:99], a[88:91], v[208:211], v[96:99]
    ds_read_b128 a[120:123], v7 offset:22528
    v_mfma_f32_16x16x32_bf16 v[100:103], a[88:91], v[212:215], v[100:103]
    buffer_load_dwordx4 v1, s[12:15], s25 offen offset:1024 lds
    v_mfma_f32_16x16x32_bf16 v[104:107], a[92:95], v[208:211], v[104:107]
    ds_read_b128 a[124:127], v7 offset:23552
    v_mfma_f32_16x16x32_bf16 v[108:111], a[92:95], v[212:215], v[108:111]
    s_waitcnt lgkmcnt(4)
    v_mfma_f32_16x16x32_bf16 v[80:83], a[96:99], v[216:219], v[80:83]
    ds_read_b128 a[80:83], v7 offset:24576
    v_mfma_f32_16x16x32_bf16 v[84:87], a[96:99], v[220:223], v[84:87]
    buffer_load_dwordx4 v1, s[12:15], s25 offen offset:2048 lds
    v_mfma_f32_16x16x32_bf16 v[88:91], a[100:103], v[216:219], v[88:91]
    ds_read_b128 a[84:87], v7 offset:25600
    v_mfma_f32_16x16x32_bf16 v[92:95], a[100:103], v[220:223], v[92:95]
    v_mfma_f32_16x16x32_bf16 v[96:99], a[104:107], v[216:219], v[96:99]
    ds_read_b128 a[88:91], v7 offset:26624
    v_mfma_f32_16x16x32_bf16 v[100:103], a[104:107], v[220:223], v[100:103]
    buffer_load_dwordx4 v1, s[12:15], s25 offen offset:3072 lds
    v_mfma_f32_16x16x32_bf16 v[104:107], a[108:111], v[216:219], v[104:107]
    ds_read_b128 a[92:95], v7 offset:27648
    v_mfma_f32_16x16x32_bf16 v[108:111], a[108:111], v[220:223], v[108:111]
    buffer_load_dwordx4 a[224:227], v1, s[8:11], s42 offen offset:0 sc1
    s_waitcnt lgkmcnt(4)
    v_mfma_f32_16x16x32_bf16 v[80:83], a[112:115], v[224:227], v[80:83]
    ds_read_b128 a[96:99], v7 offset:28672
    v_mfma_f32_16x16x32_bf16 v[84:87], a[112:115], v[228:231], v[84:87]
    s_add_u32 m0, s20, 8192
    v_mfma_f32_16x16x32_bf16 v[88:91], a[116:119], v[224:227], v[88:91]
    ds_read_b128 a[100:103], v7 offset:29696
    v_mfma_f32_16x16x32_bf16 v[92:95], a[116:119], v[228:231], v[92:95]
    v_mfma_f32_16x16x32_bf16 v[96:99], a[120:123], v[224:227], v[96:99]
    ds_read_b128 a[104:107], v7 offset:30720
    v_mfma_f32_16x16x32_bf16 v[100:103], a[120:123], v[228:231], v[100:103]
    buffer_load_dwordx4 v1, s[12:15], s26 offen offset:0 lds
    v_mfma_f32_16x16x32_bf16 v[104:107], a[124:127], v[224:227], v[104:107]
    ds_read_b128 a[108:111], v7 offset:31744
    v_mfma_f32_16x16x32_bf16 v[108:111], a[124:127], v[228:231], v[108:111]
    s_waitcnt lgkmcnt(4)
    v_mfma_f32_16x16x32_bf16 v[80:83], a[80:83], v[232:235], v[80:83]
    ds_read_b128 a[112:115], v7 offset:32768
    v_mfma_f32_16x16x32_bf16 v[84:87], a[80:83], v[236:239], v[84:87]
    v_mfma_f32_16x16x32_bf16 v[88:91], a[84:87], v[232:235], v[88:91]
    ds_read_b128 a[116:119], v7 offset:33792
    v_mfma_f32_16x16x32_bf16 v[92:95], a[84:87], v[236:239], v[92:95]
    s_add_u32 s24, s24, 36864
    s_add_u32 s25, s25, 36864
    v_mfma_f32_16x16x32_bf16 v[96:99], a[88:91], v[232:235], v[96:99]
    ds_read_b128 a[120:123], v7 offset:34816
    s_add_u32 s26, s26, 36864
    v_mfma_f32_16x16x32_bf16 v[100:103], a[88:91], v[236:239], v[100:103]
    buffer_load_dwordx4 a[228:231], v1, s[8:11], s42 offen offset:1024 sc1
    v_mfma_f32_16x16x32_bf16 v[104:107], a[92:95], v[232:235], v[104:107]
    ds_read_b128 a[124:127], v7 offset:35840
    v_mfma_f32_16x16x32_bf16 v[108:111], a[92:95], v[236:239], v[108:111]
    s_waitcnt lgkmcnt(4)
    v_mfma_f32_16x16x32_bf16 v[80:83], a[96:99], v[240:243], v[80:83]
    ds_read_b128 a[80:83], v4 offset:0
    v_mfma_f32_16x16x32_bf16 v[84:87], a[96:99], v[244:247], v[84:87]
    v_mfma_f32_16x16x32_bf16 v[88:91], a[100:103], v[240:243], v[88:91]
    ds_read_b128 a[84:87], v4 offset:1024
    v_mfma_f32_16x16x32_bf16 v[92:95], a[100:103], v[244:247], v[92:95]
    v_mfma_f32_16x16x32_bf16 v[96:99], a[104:107], v[240:243], v[96:99]
    ds_read_b128 a[88:91], v4 offset:2048
    v_mfma_f32_16x16x32_bf16 v[100:103], a[104:107], v[244:247], v[100:103]
    v_mfma_f32_16x16x32_bf16 v[104:107], a[108:111], v[240:243], v[104:107]
    ds_read_b128 a[92:95], v4 offset:3072
    v_mfma_f32_16x16x32_bf16 v[108:111], a[108:111], v[244:247], v[108:111]
    s_waitcnt lgkmcnt(4)
    v_mfma_f32_16x16x32_bf16 v[80:83], a[112:115], v[248:251], v[80:83]
    ds_read_b128 a[96:99], v4 offset:4096
    v_mfma_f32_16x16x32_bf16 v[84:87], a[112:115], v[252:255], v[84:87]
    v_mfma_f32_16x16x32_bf16 v[88:91], a[116:119], v[248:251], v[88:91]
    ds_read_b128 a[100:103], v4 offset:5120
    v_mfma_f32_16x16x32_bf16 v[92:95], a[116:119], v[252:255], v[92:95]
    v_mfma_f32_16x16x32_bf16 v[96:99], a[120:123], v[248:251], v[96:99]
    ds_read_b128 a[104:107], v4 offset:6144
    v_mfma_f32_16x16x32_bf16 v[100:103], a[120:123], v[252:255], v[100:103]
    v_mfma_f32_16x16x32_bf16 v[104:107], a[124:127], v[248:251], v[104:107]
    ds_read_b128 a[108:111], v4 offset:7168
    v_mfma_f32_16x16x32_bf16 v[108:111], a[124:127], v[252:255], v[108:111]
    s_waitcnt vmcnt(13)
    s_barrier
    s_waitcnt lgkmcnt(4)
    v_mfma_f32_16x16x32_bf16 v[112:115], a[80:83], a[8:11], 0
    ds_read_b128 a[112:115], v4 offset:8192
    buffer_load_dwordx4 v[20:23], v24, s[8:11], s45 offen sc1
    v_mfma_f32_16x16x32_bf16 v[116:119], a[80:83], a[12:15], 0
    s_add_u32 m0, s20, 36864
    v_mfma_f32_16x16x32_bf16 v[120:123], a[84:87], a[8:11], 0
    ds_read_b128 a[116:119], v4 offset:9216
    v_mfma_f32_16x16x32_bf16 v[124:127], a[84:87], a[12:15], 0
    buffer_load_dwordx4 a[232:235], v1, s[8:11], s43 offen offset:0 sc1
    v_mfma_f32_16x16x32_bf16 v[128:131], a[88:91], a[8:11], 0
    ds_read_b128 a[120:123], v4 offset:10240
    v_mfma_f32_16x16x32_bf16 v[132:135], a[88:91], a[12:15], 0
    buffer_load_dwordx4 v1, s[12:15], s24 offen offset:0 lds
    v_max_f32 v80, 0, v80
    v_mfma_f32_16x16x32_bf16 v[136:139], a[92:95], a[8:11], 0
    ds_read_b128 a[124:127], v4 offset:11264
    v_max_f32 v81, 0, v81
    v_mfma_f32_16x16x32_bf16 v[140:143], a[92:95], a[12:15], 0
    v_max_f32 v82, 0, v82
    s_waitcnt lgkmcnt(4)
    v_mfma_f32_16x16x32_bf16 v[144:147], a[96:99], a[8:11], 0
    ds_read_b128 a[80:83], v4 offset:12288
    v_max_f32 v83, 0, v83
    v_mfma_f32_16x16x32_bf16 v[148:151], a[96:99], a[12:15], 0
    buffer_load_dwordx4 v1, s[12:15], s24 offen offset:1024 lds
    v_mul_f32 v80, v80, v96
    v_mfma_f32_16x16x32_bf16 v[152:155], a[100:103], a[8:11], 0
    ds_read_b128 a[84:87], v4 offset:13312
    v_mfma_f32_16x16x32_bf16 v[156:159], a[100:103], a[12:15], 0
    v_mul_f32 v81, v81, v97
    v_mfma_f32_16x16x32_bf16 v[160:163], a[104:107], a[8:11], 0
    ds_read_b128 a[88:91], v4 offset:14336
    v_mul_f32 v82, v82, v98
    v_mfma_f32_16x16x32_bf16 v[164:167], a[104:107], a[12:15], 0
    buffer_load_dwordx4 v1, s[12:15], s24 offen offset:2048 lds
    v_mul_f32 v83, v83, v99
    v_mfma_f32_16x16x32_bf16 v[112:115], a[108:111], a[16:19], v[112:115]
    ds_read_b128 a[92:95], v4 offset:15360
    v_cvt_pk_bf16_f32 v8, v80, v81
    v_mfma_f32_16x16x32_bf16 v[116:119], a[108:111], a[20:23], v[116:119]
    v_cvt_pk_bf16_f32 v9, v82, v83
    s_waitcnt lgkmcnt(4)
    v_mfma_f32_16x16x32_bf16 v[120:123], a[112:115], a[16:19], v[120:123]
    ds_read_b128 a[96:99], v4 offset:16384
    v_mfma_f32_16x16x32_bf16 v[124:127], a[112:115], a[20:23], v[124:127]
    buffer_load_dwordx4 v1, s[12:15], s24 offen offset:3072 lds
    v_max_f32 v88, 0, v88
    v_mfma_f32_16x16x32_bf16 v[128:131], a[116:119], a[16:19], v[128:131]
    ds_read_b128 a[100:103], v4 offset:17408
    v_max_f32 v89, 0, v89
    v_mfma_f32_16x16x32_bf16 v[132:135], a[116:119], a[20:23], v[132:135]
    buffer_load_dwordx4 a[236:239], v1, s[8:11], s43 offen offset:1024 sc1
    v_max_f32 v90, 0, v90
    v_mfma_f32_16x16x32_bf16 v[136:139], a[120:123], a[16:19], v[136:139]
    ds_read_b128 a[104:107], v4 offset:18432
    v_max_f32 v91, 0, v91
    v_mfma_f32_16x16x32_bf16 v[140:143], a[120:123], a[20:23], v[140:143]
    s_add_u32 m0, s20, 40960
    v_mfma_f32_16x16x32_bf16 v[144:147], a[124:127], a[16:19], v[144:147]
    ds_read_b128 a[108:111], v4 offset:19456
    v_mul_f32 v88, v88, v104
    v_mfma_f32_16x16x32_bf16 v[148:151], a[124:127], a[20:23], v[148:151]
    v_mul_f32 v89, v89, v105
    s_waitcnt lgkmcnt(4)
    v_mfma_f32_16x16x32_bf16 v[152:155], a[80:83], a[16:19], v[152:155]
    ds_read_b128 a[112:115], v4 offset:20480
    v_mul_f32 v90, v90, v106
    v_mfma_f32_16x16x32_bf16 v[156:159], a[80:83], a[20:23], v[156:159]
    buffer_load_dwordx4 v1, s[12:15], s25 offen offset:0 lds
    v_mul_f32 v91, v91, v107
    v_mfma_f32_16x16x32_bf16 v[160:163], a[84:87], a[16:19], v[160:163]
    ds_read_b128 a[116:119], v4 offset:21504
    v_cvt_pk_bf16_f32 v10, v88, v89
    v_mfma_f32_16x16x32_bf16 v[164:167], a[84:87], a[20:23], v[164:167]
    v_mfma_f32_16x16x32_bf16 v[112:115], a[88:91], a[24:27], v[112:115]
    ds_read_b128 a[120:123], v4 offset:22528
    v_cvt_pk_bf16_f32 v11, v90, v91
    v_mfma_f32_16x16x32_bf16 v[116:119], a[88:91], a[28:31], v[116:119]
    buffer_load_dwordx4 v1, s[12:15], s25 offen offset:1024 lds
    buffer_store_dwordx4 v[8:11], v1, s[8:11], s41 offen offset:0 sc1
    v_mfma_f32_16x16x32_bf16 v[120:123], a[92:95], a[24:27], v[120:123]
    ds_read_b128 a[124:127], v4 offset:23552
    v_max_f32 v84, 0, v84
    v_mfma_f32_16x16x32_bf16 v[124:127], a[92:95], a[28:31], v[124:127]
    v_max_f32 v85, 0, v85
    s_waitcnt lgkmcnt(4)
    v_mfma_f32_16x16x32_bf16 v[128:131], a[96:99], a[24:27], v[128:131]
    ds_read_b128 a[80:83], v4 offset:24576
    v_max_f32 v86, 0, v86
    v_mfma_f32_16x16x32_bf16 v[132:135], a[96:99], a[28:31], v[132:135]
    buffer_load_dwordx4 v1, s[12:15], s25 offen offset:2048 lds
    buffer_load_dwordx4 a[240:243], v1, s[8:11], s44 offen offset:0 sc1
    v_mfma_f32_16x16x32_bf16 v[136:139], a[100:103], a[24:27], v[136:139]
    ds_read_b128 a[84:87], v4 offset:25600
    v_max_f32 v87, 0, v87
    v_mfma_f32_16x16x32_bf16 v[140:143], a[100:103], a[28:31], v[140:143]
    v_mul_f32 v84, v84, v100
    v_mfma_f32_16x16x32_bf16 v[144:147], a[104:107], a[24:27], v[144:147]
    ds_read_b128 a[88:91], v4 offset:26624
    v_mul_f32 v85, v85, v101
    v_mfma_f32_16x16x32_bf16 v[148:151], a[104:107], a[28:31], v[148:151]
    buffer_load_dwordx4 v1, s[12:15], s25 offen offset:3072 lds
    v_mul_f32 v86, v86, v102
    v_mfma_f32_16x16x32_bf16 v[152:155], a[108:111], a[24:27], v[152:155]
    ds_read_b128 a[92:95], v4 offset:27648
    v_mfma_f32_16x16x32_bf16 v[156:159], a[108:111], a[28:31], v[156:159]
    v_mul_f32 v87, v87, v103
    s_waitcnt lgkmcnt(4)
    v_mfma_f32_16x16x32_bf16 v[160:163], a[112:115], a[24:27], v[160:163]
    ds_read_b128 a[96:99], v4 offset:28672
    v_cvt_pk_bf16_f32 v12, v84, v85
    v_mfma_f32_16x16x32_bf16 v[164:167], a[112:115], a[28:31], v[164:167]
    s_add_u32 m0, s20, 45056
    v_cvt_pk_bf16_f32 v13, v86, v87
    v_mfma_f32_16x16x32_bf16 v[112:115], a[116:119], a[32:35], v[112:115]
    ds_read_b128 a[100:103], v4 offset:29696
    v_max_f32 v92, 0, v92
    v_mfma_f32_16x16x32_bf16 v[116:119], a[116:119], a[36:39], v[116:119]
    v_max_f32 v93, 0, v93
    v_mfma_f32_16x16x32_bf16 v[120:123], a[120:123], a[32:35], v[120:123]
    ds_read_b128 a[104:107], v4 offset:30720
    v_mfma_f32_16x16x32_bf16 v[124:127], a[120:123], a[36:39], v[124:127]
    buffer_load_dwordx4 v1, s[12:15], s26 offen offset:0 lds
    v_max_f32 v94, 0, v94
    v_mfma_f32_16x16x32_bf16 v[128:131], a[124:127], a[32:35], v[128:131]
    ds_read_b128 a[108:111], v4 offset:31744
    v_max_f32 v95, 0, v95
    v_mfma_f32_16x16x32_bf16 v[132:135], a[124:127], a[36:39], v[132:135]
    v_mul_f32 v92, v92, v108
    s_waitcnt lgkmcnt(4)
    v_mfma_f32_16x16x32_bf16 v[136:139], a[80:83], a[32:35], v[136:139]
    ds_read_b128 a[112:115], v4 offset:32768
    v_mul_f32 v93, v93, v109
    v_mfma_f32_16x16x32_bf16 v[140:143], a[80:83], a[36:39], v[140:143]
    buffer_load_dwordx4 a[244:247], v1, s[8:11], s44 offen offset:1024 sc1
    v_mul_f32 v94, v94, v110
    v_mfma_f32_16x16x32_bf16 v[144:147], a[84:87], a[32:35], v[144:147]
    ds_read_b128 a[116:119], v4 offset:33792
    v_mfma_f32_16x16x32_bf16 v[148:151], a[84:87], a[36:39], v[148:151]
    s_add_u32 s24, s24, 36864
    s_add_u32 s25, s25, 36864
    v_mfma_f32_16x16x32_bf16 v[152:155], a[88:91], a[32:35], v[152:155]
    ds_read_b128 a[120:123], v4 offset:34816
    s_add_u32 s26, s26, 36864
    v_mfma_f32_16x16x32_bf16 v[156:159], a[88:91], a[36:39], v[156:159]
    v_mul_f32 v95, v95, v111
    v_cvt_pk_bf16_f32 v14, v92, v93
    v_mfma_f32_16x16x32_bf16 v[160:163], a[92:95], a[32:35], v[160:163]
    ds_read_b128 a[124:127], v4 offset:35840
    v_cvt_pk_bf16_f32 v15, v94, v95
    v_mfma_f32_16x16x32_bf16 v[164:167], a[92:95], a[36:39], v[164:167]
    buffer_store_dwordx4 v[12:15], v1, s[8:11], s41 offen offset:1024 sc1
    s_waitcnt lgkmcnt(4)
    v_mfma_f32_16x16x32_bf16 v[112:115], a[96:99], a[40:43], v[112:115]
    ds_read_b128 a[80:83], v5 offset:0
    v_mfma_f32_16x16x32_bf16 v[116:119], a[96:99], a[44:47], v[116:119]
    s_set_gpr_idx_on s30, gpr_idx(DST)
    v_accvgpr_write_b32 a0, v8
    v_accvgpr_write_b32 a1, v9
    s_set_gpr_idx_off
    v_mfma_f32_16x16x32_bf16 v[120:123], a[100:103], a[40:43], v[120:123]
    ds_read_b128 a[84:87], v5 offset:1024
    v_mfma_f32_16x16x32_bf16 v[124:127], a[100:103], a[44:47], v[124:127]
    s_set_gpr_idx_on s30, gpr_idx(DST)
    v_accvgpr_write_b32 a2, v10
    v_accvgpr_write_b32 a3, v11
    s_set_gpr_idx_off
    v_mfma_f32_16x16x32_bf16 v[128:131], a[104:107], a[40:43], v[128:131]
    ds_read_b128 a[88:91], v5 offset:2048
    v_mfma_f32_16x16x32_bf16 v[132:135], a[104:107], a[44:47], v[132:135]
    s_set_gpr_idx_on s30, gpr_idx(DST)
    v_accvgpr_write_b32 a4, v12
    v_accvgpr_write_b32 a5, v13
    s_set_gpr_idx_off
    v_mfma_f32_16x16x32_bf16 v[136:139], a[108:111], a[40:43], v[136:139]
    ds_read_b128 a[92:95], v5 offset:3072
    v_mfma_f32_16x16x32_bf16 v[140:143], a[108:111], a[44:47], v[140:143]
    s_waitcnt lgkmcnt(4)
    v_mfma_f32_16x16x32_bf16 v[144:147], a[112:115], a[40:43], v[144:147]
    ds_read_b128 a[96:99], v5 offset:4096
    s_set_gpr_idx_on s30, gpr_idx(DST)
    v_accvgpr_write_b32 a6, v14
    v_accvgpr_write_b32 a7, v15
    s_set_gpr_idx_off
    v_mfma_f32_16x16x32_bf16 v[148:151], a[112:115], a[44:47], v[148:151]
    v_mfma_f32_16x16x32_bf16 v[152:155], a[116:119], a[40:43], v[152:155]
    ds_read_b128 a[100:103], v5 offset:5120
    s_add_u32 s30, s30, 8
    v_mfma_f32_16x16x32_bf16 v[156:159], a[116:119], a[44:47], v[156:159]
    v_mfma_f32_16x16x32_bf16 v[160:163], a[120:123], a[40:43], v[160:163]
    ds_read_b128 a[104:107], v5 offset:6144
    s_add_u32 s41, s41, 0x800
    v_mfma_f32_16x16x32_bf16 v[164:167], a[120:123], a[44:47], v[164:167]
    v_mfma_f32_16x16x32_bf16 v[112:115], a[124:127], a[48:51], v[112:115]
    ds_read_b128 a[108:111], v5 offset:7168
    v_mfma_f32_16x16x32_bf16 v[116:119], a[124:127], a[52:55], v[116:119]
    s_waitcnt vmcnt(15)
    s_barrier
K5_chk4:
    v_min_i32 v25, v20, v21
    v_min3_i32 v25, v22, v23, v25
    v_cmp_gt_i32 vcc, 7, v25
    s_cbranch_vccz K5_ok4
    s_sleep 2
    buffer_load_dwordx4 v[20:23], v24, s[8:11], s45 offen sc1
    s_waitcnt vmcnt(0)
    s_branch K5_chk4
K5_ok4:
    s_waitcnt lgkmcnt(4)
    v_mfma_f32_16x16x32_bf16 v[120:123], a[80:83], a[48:51], v[120:123]
    ds_read_b128 a[112:115], v5 offset:8192
    v_mov_b32 v19, 8
    v_mfma_f32_16x16x32_bf16 v[124:127], a[80:83], a[52:55], v[124:127]
    buffer_store_dword v19, v18, s[8:11], s46 offen sc1
    s_add_u32 m0, s20, 73728
    v_mfma_f32_16x16x32_bf16 v[128:131], a[84:87], a[48:51], v[128:131]
    ds_read_b128 a[116:119], v5 offset:9216
    v_mfma_f32_16x16x32_bf16 v[132:135], a[84:87], a[52:55], v[132:135]
    buffer_load_dwordx4 a[248:251], v1, s[8:11], s42 offen offset:2048 sc1
    v_mfma_f32_16x16x32_bf16 v[136:139], a[88:91], a[48:51], v[136:139]
    ds_read_b128 a[120:123], v5 offset:10240
    v_mfma_f32_16x16x32_bf16 v[140:143], a[88:91], a[52:55], v[140:143]
    buffer_load_dwordx4 v1, s[12:15], s24 offen offset:0 lds
    v_mfma_f32_16x16x32_bf16 v[144:147], a[92:95], a[48:51], v[144:147]
    ds_read_b128 a[124:127], v5 offset:11264
    v_mfma_f32_16x16x32_bf16 v[148:151], a[92:95], a[52:55], v[148:151]
    s_waitcnt lgkmcnt(4)
    v_mfma_f32_16x16x32_bf16 v[152:155], a[96:99], a[48:51], v[152:155]
    ds_read_b128 a[80:83], v5 offset:12288
    v_mfma_f32_16x16x32_bf16 v[156:159], a[96:99], a[52:55], v[156:159]
    buffer_load_dwordx4 v1, s[12:15], s24 offen offset:1024 lds
    buffer_load_dwordx4 a[252:255], v1, s[8:11], s42 offen offset:3072 sc1
    v_mfma_f32_16x16x32_bf16 v[160:163], a[100:103], a[48:51], v[160:163]
    ds_read_b128 a[84:87], v5 offset:13312
    v_mfma_f32_16x16x32_bf16 v[164:167], a[100:103], a[52:55], v[164:167]
    v_mfma_f32_16x16x32_bf16 v[112:115], a[104:107], a[56:59], v[112:115]
    ds_read_b128 a[88:91], v5 offset:14336
    v_mfma_f32_16x16x32_bf16 v[116:119], a[104:107], a[60:63], v[116:119]
    buffer_load_dwordx4 v1, s[12:15], s24 offen offset:2048 lds
    v_mfma_f32_16x16x32_bf16 v[120:123], a[108:111], a[56:59], v[120:123]
    ds_read_b128 a[92:95], v5 offset:15360
    v_mfma_f32_16x16x32_bf16 v[124:127], a[108:111], a[60:63], v[124:127]
    s_waitcnt lgkmcnt(4)
    v_mfma_f32_16x16x32_bf16 v[128:131], a[112:115], a[56:59], v[128:131]
    ds_read_b128 a[96:99], v5 offset:16384
    s_add_u32 s42, s42, 0x1000
    v_mfma_f32_16x16x32_bf16 v[132:135], a[112:115], a[60:63], v[132:135]
    buffer_load_dwordx4 v1, s[12:15], s24 offen offset:3072 lds
    v_mfma_f32_16x16x32_bf16 v[136:139], a[116:119], a[56:59], v[136:139]
    ds_read_b128 a[100:103], v5 offset:17408
    v_mfma_f32_16x16x32_bf16 v[140:143], a[116:119], a[60:63], v[140:143]
    v_mfma_f32_16x16x32_bf16 v[144:147], a[120:123], a[56:59], v[144:147]
    ds_read_b128 a[104:107], v5 offset:18432
    v_mfma_f32_16x16x32_bf16 v[148:151], a[120:123], a[60:63], v[148:151]
    s_add_u32 m0, s20, 77824
    v_mfma_f32_16x16x32_bf16 v[152:155], a[124:127], a[56:59], v[152:155]
    ds_read_b128 a[108:111], v5 offset:19456
    v_mfma_f32_16x16x32_bf16 v[156:159], a[124:127], a[60:63], v[156:159]
    buffer_load_dwordx4 v[184:187], v1, s[8:11], s43 offen offset:2048 sc1
    s_waitcnt lgkmcnt(4)
    v_mfma_f32_16x16x32_bf16 v[160:163], a[80:83], a[56:59], v[160:163]
    ds_read_b128 a[112:115], v5 offset:20480
    v_mfma_f32_16x16x32_bf16 v[164:167], a[80:83], a[60:63], v[164:167]
    buffer_load_dwordx4 v1, s[12:15], s25 offen offset:0 lds
    v_mfma_f32_16x16x32_bf16 v[112:115], a[84:87], a[64:67], v[112:115]
    ds_read_b128 a[116:119], v5 offset:21504
    v_mfma_f32_16x16x32_bf16 v[116:119], a[84:87], a[68:71], v[116:119]
    v_mfma_f32_16x16x32_bf16 v[120:123], a[88:91], a[64:67], v[120:123]
    ds_read_b128 a[120:123], v5 offset:22528
    v_mfma_f32_16x16x32_bf16 v[124:127], a[88:91], a[68:71], v[124:127]
    buffer_load_dwordx4 v1, s[12:15], s25 offen offset:1024 lds
    v_mfma_f32_16x16x32_bf16 v[128:131], a[92:95], a[64:67], v[128:131]
    ds_read_b128 a[124:127], v5 offset:23552
    buffer_load_dwordx4 v[188:191], v1, s[8:11], s43 offen offset:3072 sc1
    v_mfma_f32_16x16x32_bf16 v[132:135], a[92:95], a[68:71], v[132:135]
    s_waitcnt lgkmcnt(4)
    v_mfma_f32_16x16x32_bf16 v[136:139], a[96:99], a[64:67], v[136:139]
    ds_read_b128 a[80:83], v5 offset:24576
    v_mfma_f32_16x16x32_bf16 v[140:143], a[96:99], a[68:71], v[140:143]
    buffer_load_dwordx4 v1, s[12:15], s25 offen offset:2048 lds
    v_mfma_f32_16x16x32_bf16 v[144:147], a[100:103], a[64:67], v[144:147]
    ds_read_b128 a[84:87], v5 offset:25600
    v_mfma_f32_16x16x32_bf16 v[148:151], a[100:103], a[68:71], v[148:151]
    v_mfma_f32_16x16x32_bf16 v[152:155], a[104:107], a[64:67], v[152:155]
    ds_read_b128 a[88:91], v5 offset:26624
    s_add_u32 s43, s43, 0x1000
    v_mfma_f32_16x16x32_bf16 v[156:159], a[104:107], a[68:71], v[156:159]
    buffer_load_dwordx4 v1, s[12:15], s25 offen offset:3072 lds
    v_mfma_f32_16x16x32_bf16 v[160:163], a[108:111], a[64:67], v[160:163]
    ds_read_b128 a[92:95], v5 offset:27648
    v_mfma_f32_16x16x32_bf16 v[164:167], a[108:111], a[68:71], v[164:167]
    s_waitcnt lgkmcnt(4)
    v_mfma_f32_16x16x32_bf16 v[112:115], a[112:115], a[72:75], v[112:115]
    ds_read_b128 a[96:99], v5 offset:28672
    v_mfma_f32_16x16x32_bf16 v[116:119], a[112:115], a[76:79], v[116:119]
    s_add_u32 m0, s20, 81920
    v_mfma_f32_16x16x32_bf16 v[120:123], a[116:119], a[72:75], v[120:123]
    ds_read_b128 a[100:103], v5 offset:29696
    v_mfma_f32_16x16x32_bf16 v[124:127], a[116:119], a[76:79], v[124:127]
    buffer_load_dwordx4 v[192:195], v1, s[8:11], s44 offen offset:2048 sc1
    v_mfma_f32_16x16x32_bf16 v[128:131], a[120:123], a[72:75], v[128:131]
    ds_read_b128 a[104:107], v5 offset:30720
    v_mfma_f32_16x16x32_bf16 v[132:135], a[120:123], a[76:79], v[132:135]
    buffer_load_dwordx4 v1, s[12:15], s26 offen offset:0 lds
    v_mfma_f32_16x16x32_bf16 v[136:139], a[124:127], a[72:75], v[136:139]
    ds_read_b128 a[108:111], v5 offset:31744
    v_mfma_f32_16x16x32_bf16 v[140:143], a[124:127], a[76:79], v[140:143]
    s_waitcnt lgkmcnt(4)
    v_mfma_f32_16x16x32_bf16 v[144:147], a[80:83], a[72:75], v[144:147]
    ds_read_b128 a[112:115], v5 offset:32768
    v_mfma_f32_16x16x32_bf16 v[148:151], a[80:83], a[76:79], v[148:151]
    v_mfma_f32_16x16x32_bf16 v[152:155], a[84:87], a[72:75], v[152:155]
    ds_read_b128 a[116:119], v5 offset:33792
    buffer_load_dwordx4 v[196:199], v1, s[8:11], s44 offen offset:3072 sc1
    v_mfma_f32_16x16x32_bf16 v[156:159], a[84:87], a[76:79], v[156:159]
    s_add_u32 s24, s24, 36864
    s_add_u32 s25, s25, 36864
    v_mfma_f32_16x16x32_bf16 v[160:163], a[88:91], a[72:75], v[160:163]
    ds_read_b128 a[120:123], v5 offset:34816
    s_add_u32 s26, s26, 36864
    v_mfma_f32_16x16x32_bf16 v[164:167], a[88:91], a[76:79], v[164:167]
    v_mfma_f32_16x16x32_bf16 v[112:115], a[92:95], a[128:131], v[112:115]
    ds_read_b128 a[124:127], v5 offset:35840
    v_mfma_f32_16x16x32_bf16 v[116:119], a[92:95], a[132:135], v[116:119]
    s_waitcnt lgkmcnt(4)
    v_mfma_f32_16x16x32_bf16 v[120:123], a[96:99], a[128:131], v[120:123]
    ds_read_b128 a[80:83], v6 offset:0
    v_mfma_f32_16x16x32_bf16 v[124:127], a[96:99], a[132:135], v[124:127]
    s_add_u32 s44, s44, 0x1000
    v_mfma_f32_16x16x32_bf16 v[128:131], a[100:103], a[128:131], v[128:131]
    ds_read_b128 a[84:87], v6 offset:1024
    v_mfma_f32_16x16x32_bf16 v[132:135], a[100:103], a[132:135], v[132:135]
    v_mfma_f32_16x16x32_bf16 v[136:139], a[104:107], a[128:131], v[136:139]
    ds_read_b128 a[88:91], v6 offset:2048
    v_mfma_f32_16x16x32_bf16 v[140:143], a[104:107], a[132:135], v[140:143]
    v_mfma_f32_16x16x32_bf16 v[144:147], a[108:111], a[128:131], v[144:147]
    ds_read_b128 a[92:95], v6 offset:3072
    v_mfma_f32_16x16x32_bf16 v[148:151], a[108:111], a[132:135], v[148:151]
    s_waitcnt lgkmcnt(4)
    v_mfma_f32_16x16x32_bf16 v[152:155], a[112:115], a[128:131], v[152:155]
    ds_read_b128 a[96:99], v6 offset:4096
    v_mfma_f32_16x16x32_bf16 v[156:159], a[112:115], a[132:135], v[156:159]
    v_mfma_f32_16x16x32_bf16 v[160:163], a[116:119], a[128:131], v[160:163]
    ds_read_b128 a[100:103], v6 offset:5120
    v_mfma_f32_16x16x32_bf16 v[164:167], a[116:119], a[132:135], v[164:167]
    v_mfma_f32_16x16x32_bf16 v[112:115], a[120:123], a[136:139], v[112:115]
    ds_read_b128 a[104:107], v6 offset:6144
    v_mfma_f32_16x16x32_bf16 v[116:119], a[120:123], a[140:143], v[116:119]
    v_mfma_f32_16x16x32_bf16 v[120:123], a[124:127], a[136:139], v[120:123]
    ds_read_b128 a[108:111], v6 offset:7168
    v_mfma_f32_16x16x32_bf16 v[124:127], a[124:127], a[140:143], v[124:127]
    s_waitcnt vmcnt(16)
    s_barrier
    s_waitcnt lgkmcnt(4)
    v_mfma_f32_16x16x32_bf16 v[128:131], a[80:83], a[136:139], v[128:131]
    ds_read_b128 a[112:115], v6 offset:8192
    buffer_load_dwordx4 v[20:23], v24, s[8:11], s45 offen sc1
    v_mfma_f32_16x16x32_bf16 v[132:135], a[80:83], a[140:143], v[132:135]
    s_add_u32 m0, s20, 110592
    v_mfma_f32_16x16x32_bf16 v[136:139], a[84:87], a[136:139], v[136:139]
    ds_read_b128 a[116:119], v6 offset:9216
    v_mfma_f32_16x16x32_bf16 v[140:143], a[84:87], a[140:143], v[140:143]
    buffer_load_dwordx4 v[200:203], v1, s[8:11], s42 offen offset:0 sc1
    v_mfma_f32_16x16x32_bf16 v[144:147], a[88:91], a[136:139], v[144:147]
    ds_read_b128 a[120:123], v6 offset:10240
    v_mfma_f32_16x16x32_bf16 v[148:151], a[88:91], a[140:143], v[148:151]
    buffer_load_dwordx4 v1, s[12:15], s24 offen offset:0 lds
    v_mfma_f32_16x16x32_bf16 v[152:155], a[92:95], a[136:139], v[152:155]
    ds_read_b128 a[124:127], v6 offset:11264
    v_mfma_f32_16x16x32_bf16 v[156:159], a[92:95], a[140:143], v[156:159]
    s_waitcnt lgkmcnt(4)
    v_mfma_f32_16x16x32_bf16 v[160:163], a[96:99], a[136:139], v[160:163]
    ds_read_b128 a[80:83], v6 offset:12288
    v_mfma_f32_16x16x32_bf16 v[164:167], a[96:99], a[140:143], v[164:167]
    buffer_load_dwordx4 v1, s[12:15], s24 offen offset:1024 lds
    v_mfma_f32_16x16x32_bf16 v[112:115], a[100:103], a[144:147], v[112:115]
    ds_read_b128 a[84:87], v6 offset:13312
    v_mfma_f32_16x16x32_bf16 v[116:119], a[100:103], a[148:151], v[116:119]
    v_mfma_f32_16x16x32_bf16 v[120:123], a[104:107], a[144:147], v[120:123]
    ds_read_b128 a[88:91], v6 offset:14336
    v_mfma_f32_16x16x32_bf16 v[124:127], a[104:107], a[148:151], v[124:127]
    buffer_load_dwordx4 v1, s[12:15], s24 offen offset:2048 lds
    buffer_load_dwordx4 v[204:207], v1, s[8:11], s42 offen offset:1024 sc1
    v_mfma_f32_16x16x32_bf16 v[128:131], a[108:111], a[144:147], v[128:131]
    ds_read_b128 a[92:95], v6 offset:15360
    v_mfma_f32_16x16x32_bf16 v[132:135], a[108:111], a[148:151], v[132:135]
    s_waitcnt lgkmcnt(4)
    v_mfma_f32_16x16x32_bf16 v[136:139], a[112:115], a[144:147], v[136:139]
    ds_read_b128 a[96:99], v6 offset:16384
    v_mfma_f32_16x16x32_bf16 v[140:143], a[112:115], a[148:151], v[140:143]
    buffer_load_dwordx4 v1, s[12:15], s24 offen offset:3072 lds
    v_mfma_f32_16x16x32_bf16 v[144:147], a[116:119], a[144:147], v[144:147]
    ds_read_b128 a[100:103], v6 offset:17408
    v_mfma_f32_16x16x32_bf16 v[148:151], a[116:119], a[148:151], v[148:151]
    v_mfma_f32_16x16x32_bf16 v[152:155], a[120:123], a[144:147], v[152:155]
    ds_read_b128 a[104:107], v6 offset:18432
    v_mfma_f32_16x16x32_bf16 v[156:159], a[120:123], a[148:151], v[156:159]
    s_add_u32 m0, s20, 114688
    v_mfma_f32_16x16x32_bf16 v[160:163], a[124:127], a[144:147], v[160:163]
    ds_read_b128 a[108:111], v6 offset:19456
    v_mfma_f32_16x16x32_bf16 v[164:167], a[124:127], a[148:151], v[164:167]
    buffer_load_dwordx4 v[208:211], v1, s[8:11], s43 offen offset:0 sc1
    s_waitcnt lgkmcnt(4)
    v_mfma_f32_16x16x32_bf16 v[112:115], a[80:83], a[152:155], v[112:115]
    ds_read_b128 a[112:115], v6 offset:20480
    v_mfma_f32_16x16x32_bf16 v[116:119], a[80:83], a[156:159], v[116:119]
    buffer_load_dwordx4 v1, s[12:15], s25 offen offset:0 lds
    v_mfma_f32_16x16x32_bf16 v[120:123], a[84:87], a[152:155], v[120:123]
    ds_read_b128 a[116:119], v6 offset:21504
    v_mfma_f32_16x16x32_bf16 v[124:127], a[84:87], a[156:159], v[124:127]
    v_mfma_f32_16x16x32_bf16 v[128:131], a[88:91], a[152:155], v[128:131]
    ds_read_b128 a[120:123], v6 offset:22528
    v_mfma_f32_16x16x32_bf16 v[132:135], a[88:91], a[156:159], v[132:135]
    buffer_load_dwordx4 v1, s[12:15], s25 offen offset:1024 lds
    v_mfma_f32_16x16x32_bf16 v[136:139], a[92:95], a[152:155], v[136:139]
    ds_read_b128 a[124:127], v6 offset:23552
    v_mfma_f32_16x16x32_bf16 v[140:143], a[92:95], a[156:159], v[140:143]
    s_waitcnt lgkmcnt(4)
    v_mfma_f32_16x16x32_bf16 v[144:147], a[96:99], a[152:155], v[144:147]
    ds_read_b128 a[80:83], v6 offset:24576
    v_mfma_f32_16x16x32_bf16 v[148:151], a[96:99], a[156:159], v[148:151]
    buffer_load_dwordx4 v1, s[12:15], s25 offen offset:2048 lds
    buffer_load_dwordx4 v[212:215], v1, s[8:11], s43 offen offset:1024 sc1
    v_mfma_f32_16x16x32_bf16 v[152:155], a[100:103], a[152:155], v[152:155]
    ds_read_b128 a[84:87], v6 offset:25600
    v_mfma_f32_16x16x32_bf16 v[156:159], a[100:103], a[156:159], v[156:159]
    v_mfma_f32_16x16x32_bf16 v[160:163], a[104:107], a[152:155], v[160:163]
    ds_read_b128 a[88:91], v6 offset:26624
    v_mfma_f32_16x16x32_bf16 v[164:167], a[104:107], a[156:159], v[164:167]
    buffer_load_dwordx4 v1, s[12:15], s25 offen offset:3072 lds
    v_mfma_f32_16x16x32_bf16 v[112:115], a[108:111], a[160:163], v[112:115]
    ds_read_b128 a[92:95], v6 offset:27648
    v_mfma_f32_16x16x32_bf16 v[116:119], a[108:111], a[164:167], v[116:119]
    s_waitcnt lgkmcnt(4)
    v_mfma_f32_16x16x32_bf16 v[120:123], a[112:115], a[160:163], v[120:123]
    ds_read_b128 a[96:99], v6 offset:28672
    v_mov_b32 v19, 9
    v_mfma_f32_16x16x32_bf16 v[124:127], a[112:115], a[164:167], v[124:127]
    buffer_store_dword v19, v18, s[8:11], s46 offen sc1
    s_add_u32 m0, s20, 118784
    v_mfma_f32_16x16x32_bf16 v[128:131], a[116:119], a[160:163], v[128:131]
    ds_read_b128 a[100:103], v6 offset:29696
    v_mfma_f32_16x16x32_bf16 v[132:135], a[116:119], a[164:167], v[132:135]
    buffer_load_dwordx4 v[216:219], v1, s[8:11], s44 offen offset:0 sc1
    v_mfma_f32_16x16x32_bf16 v[136:139], a[120:123], a[160:163], v[136:139]
    ds_read_b128 a[104:107], v6 offset:30720
    v_mfma_f32_16x16x32_bf16 v[140:143], a[120:123], a[164:167], v[140:143]
    buffer_load_dwordx4 v1, s[12:15], s26 offen offset:0 lds
    v_mfma_f32_16x16x32_bf16 v[144:147], a[124:127], a[160:163], v[144:147]
    ds_read_b128 a[108:111], v6 offset:31744
    v_mfma_f32_16x16x32_bf16 v[148:151], a[124:127], a[164:167], v[148:151]
    s_waitcnt lgkmcnt(4)
    v_mfma_f32_16x16x32_bf16 v[152:155], a[80:83], a[160:163], v[152:155]
    ds_read_b128 a[112:115], v6 offset:32768
    v_mfma_f32_16x16x32_bf16 v[156:159], a[80:83], a[164:167], v[156:159]
    v_mfma_f32_16x16x32_bf16 v[160:163], a[84:87], a[160:163], v[160:163]
    ds_read_b128 a[116:119], v6 offset:33792
    v_mfma_f32_16x16x32_bf16 v[164:167], a[84:87], a[164:167], v[164:167]
    s_add_u32 s24, s24, 36864
    s_add_u32 s25, s25, 36864
    v_mfma_f32_16x16x32_bf16 v[112:115], a[88:91], a[168:171], v[112:115]
    ds_read_b128 a[120:123], v6 offset:34816
    s_add_u32 s26, s26, 36864
    v_mfma_f32_16x16x32_bf16 v[116:119], a[88:91], a[172:175], v[116:119]
    buffer_load_dwordx4 v[220:223], v1, s[8:11], s44 offen offset:1024 sc1
    v_mfma_f32_16x16x32_bf16 v[120:123], a[92:95], a[168:171], v[120:123]
    ds_read_b128 a[124:127], v6 offset:35840
    v_mfma_f32_16x16x32_bf16 v[124:127], a[92:95], a[172:175], v[124:127]
    s_waitcnt lgkmcnt(4)
    v_mfma_f32_16x16x32_bf16 v[128:131], a[96:99], a[168:171], v[128:131]
    ds_read_b128 a[80:83], v7 offset:0
    v_mfma_f32_16x16x32_bf16 v[132:135], a[96:99], a[172:175], v[132:135]
    v_mfma_f32_16x16x32_bf16 v[136:139], a[100:103], a[168:171], v[136:139]
    ds_read_b128 a[84:87], v7 offset:1024
    v_mfma_f32_16x16x32_bf16 v[140:143], a[100:103], a[172:175], v[140:143]
    v_mfma_f32_16x16x32_bf16 v[144:147], a[104:107], a[168:171], v[144:147]
    ds_read_b128 a[88:91], v7 offset:2048
    v_mfma_f32_16x16x32_bf16 v[148:151], a[104:107], a[172:175], v[148:151]
    v_mfma_f32_16x16x32_bf16 v[152:155], a[108:111], a[168:171], v[152:155]
    ds_read_b128 a[92:95], v7 offset:3072
    v_mfma_f32_16x16x32_bf16 v[156:159], a[108:111], a[172:175], v[156:159]
    s_waitcnt lgkmcnt(4)
    v_mfma_f32_16x16x32_bf16 v[160:163], a[112:115], a[168:171], v[160:163]
    ds_read_b128 a[96:99], v7 offset:4096
    v_mfma_f32_16x16x32_bf16 v[164:167], a[112:115], a[172:175], v[164:167]
    v_mfma_f32_16x16x32_bf16 v[112:115], a[116:119], a[176:179], v[112:115]
    ds_read_b128 a[100:103], v7 offset:5120
    v_mfma_f32_16x16x32_bf16 v[116:119], a[116:119], a[180:183], v[116:119]
    v_mfma_f32_16x16x32_bf16 v[120:123], a[120:123], a[176:179], v[120:123]
    ds_read_b128 a[104:107], v7 offset:6144
    v_mfma_f32_16x16x32_bf16 v[124:127], a[120:123], a[180:183], v[124:127]
    v_mfma_f32_16x16x32_bf16 v[128:131], a[124:127], a[176:179], v[128:131]
    ds_read_b128 a[108:111], v7 offset:7168
    v_mfma_f32_16x16x32_bf16 v[132:135], a[124:127], a[180:183], v[132:135]
    s_waitcnt vmcnt(16)
    s_barrier
K5_chk2:
    v_min_i32 v25, v20, v21
    v_min3_i32 v25, v22, v23, v25
    v_cmp_gt_i32 vcc, 8, v25
    s_cbranch_vccz K5_ok2
    s_sleep 2
    buffer_load_dwordx4 v[20:23], v24, s[8:11], s45 offen sc1
    s_waitcnt vmcnt(0)
    s_branch K5_chk2
K5_ok2:
    s_waitcnt lgkmcnt(4)
    v_mfma_f32_16x16x32_bf16 v[136:139], a[80:83], a[176:179], v[136:139]
    ds_read_b128 a[112:115], v7 offset:8192
    v_mfma_f32_16x16x32_bf16 v[140:143], a[80:83], a[180:183], v[140:143]
    s_add_u32 m0, s20, 0
    v_mfma_f32_16x16x32_bf16 v[144:147], a[84:87], a[176:179], v[144:147]
    ds_read_b128 a[116:119], v7 offset:9216
    v_mfma_f32_16x16x32_bf16 v[148:151], a[84:87], a[180:183], v[148:151]
    buffer_load_dwordx4 v[224:227], v1, s[8:11], s42 offen offset:2048 sc1
    v_mfma_f32_16x16x32_bf16 v[152:155], a[88:91], a[176:179], v[152:155]
    ds_read_b128 a[120:123], v7 offset:10240
    v_mfma_f32_16x16x32_bf16 v[156:159], a[88:91], a[180:183], v[156:159]
    buffer_load_dwordx4 v1, s[12:15], s24 offen offset:0 lds
    v_mfma_f32_16x16x32_bf16 v[160:163], a[92:95], a[176:179], v[160:163]
    ds_read_b128 a[124:127], v7 offset:11264
    v_mfma_f32_16x16x32_bf16 v[164:167], a[92:95], a[180:183], v[164:167]
    s_waitcnt lgkmcnt(4)
    v_mfma_f32_16x16x32_bf16 v[112:115], a[96:99], a[184:187], v[112:115]
    ds_read_b128 a[80:83], v7 offset:12288
    v_mfma_f32_16x16x32_bf16 v[116:119], a[96:99], a[188:191], v[116:119]
    buffer_load_dwordx4 v1, s[12:15], s24 offen offset:1024 lds
    buffer_load_dwordx4 v[228:231], v1, s[8:11], s42 offen offset:3072 sc1
    v_mfma_f32_16x16x32_bf16 v[120:123], a[100:103], a[184:187], v[120:123]
    ds_read_b128 a[84:87], v7 offset:13312
    v_mfma_f32_16x16x32_bf16 v[124:127], a[100:103], a[188:191], v[124:127]
    v_mfma_f32_16x16x32_bf16 v[128:131], a[104:107], a[184:187], v[128:131]
    ds_read_b128 a[88:91], v7 offset:14336
    v_mfma_f32_16x16x32_bf16 v[132:135], a[104:107], a[188:191], v[132:135]
    buffer_load_dwordx4 v1, s[12:15], s24 offen offset:2048 lds
    v_mfma_f32_16x16x32_bf16 v[136:139], a[108:111], a[184:187], v[136:139]
    ds_read_b128 a[92:95], v7 offset:15360
    v_mfma_f32_16x16x32_bf16 v[140:143], a[108:111], a[188:191], v[140:143]
    s_waitcnt lgkmcnt(4)
    v_mfma_f32_16x16x32_bf16 v[144:147], a[112:115], a[184:187], v[144:147]
    ds_read_b128 a[96:99], v7 offset:16384
    s_add_u32 s42, s42, 0x1000
    v_mfma_f32_16x16x32_bf16 v[148:151], a[112:115], a[188:191], v[148:151]
    buffer_load_dwordx4 v1, s[12:15], s24 offen offset:3072 lds
    v_mfma_f32_16x16x32_bf16 v[152:155], a[116:119], a[184:187], v[152:155]
    ds_read_b128 a[100:103], v7 offset:17408
    v_mfma_f32_16x16x32_bf16 v[156:159], a[116:119], a[188:191], v[156:159]
    v_mfma_f32_16x16x32_bf16 v[160:163], a[120:123], a[184:187], v[160:163]
    ds_read_b128 a[104:107], v7 offset:18432
    v_mfma_f32_16x16x32_bf16 v[164:167], a[120:123], a[188:191], v[164:167]
    s_add_u32 m0, s20, 4096
    v_mfma_f32_16x16x32_bf16 v[112:115], a[124:127], a[192:195], v[112:115]
    ds_read_b128 a[108:111], v7 offset:19456
    v_mfma_f32_16x16x32_bf16 v[116:119], a[124:127], a[196:199], v[116:119]
    buffer_load_dwordx4 v[232:235], v1, s[8:11], s43 offen offset:2048 sc1
    s_waitcnt lgkmcnt(4)
    v_mfma_f32_16x16x32_bf16 v[120:123], a[80:83], a[192:195], v[120:123]
    ds_read_b128 a[112:115], v7 offset:20480
    v_mfma_f32_16x16x32_bf16 v[124:127], a[80:83], a[196:199], v[124:127]
    buffer_load_dwordx4 v1, s[12:15], s25 offen offset:0 lds
    v_mfma_f32_16x16x32_bf16 v[128:131], a[84:87], a[192:195], v[128:131]
    ds_read_b128 a[116:119], v7 offset:21504
    v_mfma_f32_16x16x32_bf16 v[132:135], a[84:87], a[196:199], v[132:135]
    v_mfma_f32_16x16x32_bf16 v[136:139], a[88:91], a[192:195], v[136:139]
    ds_read_b128 a[120:123], v7 offset:22528
    v_mfma_f32_16x16x32_bf16 v[140:143], a[88:91], a[196:199], v[140:143]
    buffer_load_dwordx4 v1, s[12:15], s25 offen offset:1024 lds
    v_mfma_f32_16x16x32_bf16 v[144:147], a[92:95], a[192:195], v[144:147]
    ds_read_b128 a[124:127], v7 offset:23552
    buffer_load_dwordx4 v[20:23], v24, s[8:11], s45 offen sc1
    v_mfma_f32_16x16x32_bf16 v[148:151], a[92:95], a[196:199], v[148:151]
    buffer_load_dwordx4 v[236:239], v1, s[8:11], s43 offen offset:3072 sc1
    s_waitcnt lgkmcnt(4)
    v_mfma_f32_16x16x32_bf16 v[152:155], a[96:99], a[192:195], v[152:155]
    ds_read_b128 a[80:83], v7 offset:24576
    v_mfma_f32_16x16x32_bf16 v[156:159], a[96:99], a[196:199], v[156:159]
    buffer_load_dwordx4 v1, s[12:15], s25 offen offset:2048 lds
    v_mfma_f32_16x16x32_bf16 v[160:163], a[100:103], a[192:195], v[160:163]
    ds_read_b128 a[84:87], v7 offset:25600
    v_mfma_f32_16x16x32_bf16 v[164:167], a[100:103], a[196:199], v[164:167]
    v_mfma_f32_16x16x32_bf16 v[112:115], a[104:107], a[200:203], v[112:115]
    ds_read_b128 a[88:91], v7 offset:26624
    s_add_u32 s43, s43, 0x1000
    v_mfma_f32_16x16x32_bf16 v[116:119], a[104:107], a[204:207], v[116:119]
    buffer_load_dwordx4 v1, s[12:15], s25 offen offset:3072 lds
    v_mfma_f32_16x16x32_bf16 v[120:123], a[108:111], a[200:203], v[120:123]
    ds_read_b128 a[92:95], v7 offset:27648
    v_mfma_f32_16x16x32_bf16 v[124:127], a[108:111], a[204:207], v[124:127]
    s_waitcnt lgkmcnt(4)
    v_mfma_f32_16x16x32_bf16 v[128:131], a[112:115], a[200:203], v[128:131]
    ds_read_b128 a[96:99], v7 offset:28672
    v_mfma_f32_16x16x32_bf16 v[132:135], a[112:115], a[204:207], v[132:135]
    s_add_u32 m0, s20, 8192
    v_mfma_f32_16x16x32_bf16 v[136:139], a[116:119], a[200:203], v[136:139]
    ds_read_b128 a[100:103], v7 offset:29696
    v_mfma_f32_16x16x32_bf16 v[140:143], a[116:119], a[204:207], v[140:143]
    buffer_load_dwordx4 v[240:243], v1, s[8:11], s44 offen offset:2048 sc1
    v_mfma_f32_16x16x32_bf16 v[144:147], a[120:123], a[200:203], v[144:147]
    ds_read_b128 a[104:107], v7 offset:30720
    v_mfma_f32_16x16x32_bf16 v[148:151], a[120:123], a[204:207], v[148:151]
    buffer_load_dwordx4 v1, s[12:15], s26 offen offset:0 lds
    v_mfma_f32_16x16x32_bf16 v[152:155], a[124:127], a[200:203], v[152:155]
    ds_read_b128 a[108:111], v7 offset:31744
    v_mfma_f32_16x16x32_bf16 v[156:159], a[124:127], a[204:207], v[156:159]
    s_waitcnt lgkmcnt(4)
    v_mfma_f32_16x16x32_bf16 v[160:163], a[80:83], a[200:203], v[160:163]
    ds_read_b128 a[112:115], v7 offset:32768
    v_mfma_f32_16x16x32_bf16 v[164:167], a[80:83], a[204:207], v[164:167]
    v_mfma_f32_16x16x32_bf16 v[112:115], a[84:87], a[208:211], v[112:115]
    ds_read_b128 a[116:119], v7 offset:33792
    buffer_load_dwordx4 v[244:247], v1, s[8:11], s44 offen offset:3072 sc1
    v_mfma_f32_16x16x32_bf16 v[116:119], a[84:87], a[212:215], v[116:119]
    s_add_u32 s24, s24, 36864
    s_add_u32 s25, s25, 36864
    v_mfma_f32_16x16x32_bf16 v[120:123], a[88:91], a[208:211], v[120:123]
    ds_read_b128 a[120:123], v7 offset:34816
    s_add_u32 s26, s26, 36864
    v_mfma_f32_16x16x32_bf16 v[124:127], a[88:91], a[212:215], v[124:127]
    v_mfma_f32_16x16x32_bf16 v[128:131], a[92:95], a[208:211], v[128:131]
    ds_read_b128 a[124:127], v7 offset:35840
    v_mfma_f32_16x16x32_bf16 v[132:135], a[92:95], a[212:215], v[132:135]
    s_waitcnt lgkmcnt(4)
    v_mfma_f32_16x16x32_bf16 v[136:139], a[96:99], a[208:211], v[136:139]
    ds_read_b128 a[80:83], v4 offset:0
    v_mfma_f32_16x16x32_bf16 v[140:143], a[96:99], a[212:215], v[140:143]
    s_add_u32 s44, s44, 0x1000
    v_mfma_f32_16x16x32_bf16 v[144:147], a[100:103], a[208:211], v[144:147]
    ds_read_b128 a[84:87], v4 offset:1024
    v_mfma_f32_16x16x32_bf16 v[148:151], a[100:103], a[212:215], v[148:151]
    v_mfma_f32_16x16x32_bf16 v[152:155], a[104:107], a[208:211], v[152:155]
    ds_read_b128 a[88:91], v4 offset:2048
    v_mfma_f32_16x16x32_bf16 v[156:159], a[104:107], a[212:215], v[156:159]
    v_mfma_f32_16x16x32_bf16 v[160:163], a[108:111], a[208:211], v[160:163]
    ds_read_b128 a[92:95], v4 offset:3072
    v_mfma_f32_16x16x32_bf16 v[164:167], a[108:111], a[212:215], v[164:167]
    s_waitcnt lgkmcnt(4)
    v_mfma_f32_16x16x32_bf16 v[112:115], a[112:115], a[216:219], v[112:115]
    ds_read_b128 a[96:99], v4 offset:4096
    v_mfma_f32_16x16x32_bf16 v[116:119], a[112:115], a[220:223], v[116:119]
    v_mfma_f32_16x16x32_bf16 v[120:123], a[116:119], a[216:219], v[120:123]
    ds_read_b128 a[100:103], v4 offset:5120
    v_mfma_f32_16x16x32_bf16 v[124:127], a[116:119], a[220:223], v[124:127]
    v_mfma_f32_16x16x32_bf16 v[128:131], a[120:123], a[216:219], v[128:131]
    ds_read_b128 a[104:107], v4 offset:6144
    v_mfma_f32_16x16x32_bf16 v[132:135], a[120:123], a[220:223], v[132:135]
    v_mfma_f32_16x16x32_bf16 v[136:139], a[124:127], a[216:219], v[136:139]
    ds_read_b128 a[108:111], v4 offset:7168
    v_mfma_f32_16x16x32_bf16 v[140:143], a[124:127], a[220:223], v[140:143]
    s_waitcnt vmcnt(6)
    s_barrier
K5_chk3:
    v_min_i32 v25, v20, v21
    v_min3_i32 v25, v22, v23, v25
    v_cmp_gt_i32 vcc, 9, v25
    s_cbranch_vccz K5_ok3
    s_sleep 2
    buffer_load_dwordx4 v[20:23], v24, s[8:11], s45 offen sc1
    s_waitcnt vmcnt(0)
    s_branch K5_chk3
K5_ok3:
    s_waitcnt lgkmcnt(4)
    v_mfma_f32_16x16x32_bf16 v[144:147], a[80:83], a[216:219], v[144:147]
    ds_read_b128 a[112:115], v4 offset:8192
    v_mfma_f32_16x16x32_bf16 v[148:151], a[80:83], a[220:223], v[148:151]
    s_add_u32 m0, s20, 36864
    v_mfma_f32_16x16x32_bf16 v[152:155], a[84:87], a[216:219], v[152:155]
    ds_read_b128 a[116:119], v4 offset:9216
    v_mfma_f32_16x16x32_bf16 v[156:159], a[84:87], a[220:223], v[156:159]
    buffer_load_dwordx4 v[248:251], v1, s[8:11], s42 offen offset:0 sc1
    v_mfma_f32_16x16x32_bf16 v[160:163], a[88:91], a[216:219], v[160:163]
    ds_read_b128 a[120:123], v4 offset:10240
    v_mfma_f32_16x16x32_bf16 v[164:167], a[88:91], a[220:223], v[164:167]
    buffer_load_dwordx4 v1, s[12:15], s24 offen offset:0 lds
    v_mfma_f32_16x16x32_bf16 v[112:115], a[92:95], a[224:227], v[112:115]
    ds_read_b128 a[124:127], v4 offset:11264
    v_mfma_f32_16x16x32_bf16 v[116:119], a[92:95], a[228:231], v[116:119]
    s_waitcnt lgkmcnt(4)
    v_mfma_f32_16x16x32_bf16 v[120:123], a[96:99], a[224:227], v[120:123]
    ds_read_b128 a[80:83], v4 offset:12288
    v_mfma_f32_16x16x32_bf16 v[124:127], a[96:99], a[228:231], v[124:127]
    buffer_load_dwordx4 v1, s[12:15], s24 offen offset:1024 lds
    v_mfma_f32_16x16x32_bf16 v[128:131], a[100:103], a[224:227], v[128:131]
    ds_read_b128 a[84:87], v4 offset:13312
    v_mfma_f32_16x16x32_bf16 v[132:135], a[100:103], a[228:231], v[132:135]
    v_mfma_f32_16x16x32_bf16 v[136:139], a[104:107], a[224:227], v[136:139]
    ds_read_b128 a[88:91], v4 offset:14336
    v_mfma_f32_16x16x32_bf16 v[140:143], a[104:107], a[228:231], v[140:143]
    buffer_load_dwordx4 v1, s[12:15], s24 offen offset:2048 lds
    buffer_load_dwordx4 v[252:255], v1, s[8:11], s42 offen offset:1024 sc1
    v_mfma_f32_16x16x32_bf16 v[144:147], a[108:111], a[224:227], v[144:147]
    ds_read_b128 a[92:95], v4 offset:15360
    v_mfma_f32_16x16x32_bf16 v[148:151], a[108:111], a[228:231], v[148:151]
    s_waitcnt lgkmcnt(4)
    v_mfma_f32_16x16x32_bf16 v[152:155], a[112:115], a[224:227], v[152:155]
    ds_read_b128 a[96:99], v4 offset:16384
    v_mfma_f32_16x16x32_bf16 v[156:159], a[112:115], a[228:231], v[156:159]
    buffer_load_dwordx4 v1, s[12:15], s24 offen offset:3072 lds
    v_mfma_f32_16x16x32_bf16 v[160:163], a[116:119], a[224:227], v[160:163]
    ds_read_b128 a[100:103], v4 offset:17408
    v_mfma_f32_16x16x32_bf16 v[164:167], a[116:119], a[228:231], v[164:167]
    v_mfma_f32_16x16x32_bf16 v[112:115], a[120:123], a[232:235], v[112:115]
    ds_read_b128 a[104:107], v4 offset:18432
    v_mfma_f32_16x16x32_bf16 v[116:119], a[120:123], a[236:239], v[116:119]
    s_add_u32 m0, s20, 40960
    v_mfma_f32_16x16x32_bf16 v[120:123], a[124:127], a[232:235], v[120:123]
    ds_read_b128 a[108:111], v4 offset:19456
    v_mfma_f32_16x16x32_bf16 v[124:127], a[124:127], a[236:239], v[124:127]
    buffer_load_dwordx4 v[48:51], v1, s[8:11], s43 offen offset:0 sc1
    s_waitcnt lgkmcnt(4)
    v_mfma_f32_16x16x32_bf16 v[128:131], a[80:83], a[232:235], v[128:131]
    ds_read_b128 a[112:115], v4 offset:20480
    v_mfma_f32_16x16x32_bf16 v[132:135], a[80:83], a[236:239], v[132:135]
    buffer_load_dwordx4 v1, s[12:15], s25 offen offset:0 lds
    v_mfma_f32_16x16x32_bf16 v[136:139], a[84:87], a[232:235], v[136:139]
    ds_read_b128 a[116:119], v4 offset:21504
    v_mfma_f32_16x16x32_bf16 v[140:143], a[84:87], a[236:239], v[140:143]
    v_mfma_f32_16x16x32_bf16 v[144:147], a[88:91], a[232:235], v[144:147]
    ds_read_b128 a[120:123], v4 offset:22528
    v_mfma_f32_16x16x32_bf16 v[148:151], a[88:91], a[236:239], v[148:151]
    buffer_load_dwordx4 v1, s[12:15], s25 offen offset:1024 lds
    v_mfma_f32_16x16x32_bf16 v[152:155], a[92:95], a[232:235], v[152:155]
    ds_read_b128 a[124:127], v4 offset:23552
    v_mfma_f32_16x16x32_bf16 v[156:159], a[92:95], a[236:239], v[156:159]
    s_waitcnt lgkmcnt(4)
    v_mfma_f32_16x16x32_bf16 v[160:163], a[96:99], a[232:235], v[160:163]
    ds_read_b128 a[80:83], v4 offset:24576
    v_mfma_f32_16x16x32_bf16 v[164:167], a[96:99], a[236:239], v[164:167]
    buffer_load_dwordx4 v1, s[12:15], s25 offen offset:2048 lds
    buffer_load_dwordx4 v[52:55], v1, s[8:11], s43 offen offset:1024 sc1
    v_mfma_f32_16x16x32_bf16 v[112:115], a[100:103], a[240:243], v[112:115]
    ds_read_b128 a[84:87], v4 offset:25600
    v_mfma_f32_16x16x32_bf16 v[116:119], a[100:103], a[244:247], v[116:119]
    v_mfma_f32_16x16x32_bf16 v[120:123], a[104:107], a[240:243], v[120:123]
    ds_read_b128 a[88:91], v4 offset:26624
    v_mfma_f32_16x16x32_bf16 v[124:127], a[104:107], a[244:247], v[124:127]
    buffer_load_dwordx4 v1, s[12:15], s25 offen offset:3072 lds
    v_mfma_f32_16x16x32_bf16 v[128:131], a[108:111], a[240:243], v[128:131]
    ds_read_b128 a[92:95], v4 offset:27648
    v_mfma_f32_16x16x32_bf16 v[132:135], a[108:111], a[244:247], v[132:135]
    s_waitcnt lgkmcnt(4)
    v_mfma_f32_16x16x32_bf16 v[136:139], a[112:115], a[240:243], v[136:139]
    ds_read_b128 a[96:99], v4 offset:28672
    v_mfma_f32_16x16x32_bf16 v[140:143], a[112:115], a[244:247], v[140:143]
    s_add_u32 m0, s20, 45056
    v_mfma_f32_16x16x32_bf16 v[144:147], a[116:119], a[240:243], v[144:147]
    ds_read_b128 a[100:103], v4 offset:29696
    v_mfma_f32_16x16x32_bf16 v[148:151], a[116:119], a[244:247], v[148:151]
    buffer_load_dwordx4 v[56:59], v1, s[8:11], s44 offen offset:0 sc1
    v_mfma_f32_16x16x32_bf16 v[152:155], a[120:123], a[240:243], v[152:155]
    ds_read_b128 a[104:107], v4 offset:30720
    v_mfma_f32_16x16x32_bf16 v[156:159], a[120:123], a[244:247], v[156:159]
    buffer_load_dwordx4 v1, s[12:15], s26 offen offset:0 lds
    v_mfma_f32_16x16x32_bf16 v[160:163], a[124:127], a[240:243], v[160:163]
    ds_read_b128 a[108:111], v4 offset:31744
    v_mfma_f32_16x16x32_bf16 v[164:167], a[124:127], a[244:247], v[164:167]
    s_waitcnt lgkmcnt(4)
    v_mfma_f32_16x16x32_bf16 v[112:115], a[80:83], a[248:251], v[112:115]
    ds_read_b128 a[112:115], v4 offset:32768
    v_mfma_f32_16x16x32_bf16 v[116:119], a[80:83], a[252:255], v[116:119]
    v_mfma_f32_16x16x32_bf16 v[120:123], a[84:87], a[248:251], v[120:123]
    ds_read_b128 a[116:119], v4 offset:33792
    v_mfma_f32_16x16x32_bf16 v[124:127], a[84:87], a[252:255], v[124:127]
    s_add_u32 s24, s24, 36864
    s_add_u32 s25, s25, 36864
    v_mfma_f32_16x16x32_bf16 v[128:131], a[88:91], a[248:251], v[128:131]
    ds_read_b128 a[120:123], v4 offset:34816
    s_add_u32 s26, s26, 36864
    v_mfma_f32_16x16x32_bf16 v[132:135], a[88:91], a[252:255], v[132:135]
    buffer_load_dwordx4 v[60:63], v1, s[8:11], s44 offen offset:1024 sc1
    v_mfma_f32_16x16x32_bf16 v[136:139], a[92:95], a[248:251], v[136:139]
    ds_read_b128 a[124:127], v4 offset:35840
    v_mfma_f32_16x16x32_bf16 v[140:143], a[92:95], a[252:255], v[140:143]
    s_waitcnt lgkmcnt(4)
    v_mfma_f32_16x16x32_bf16 v[144:147], a[96:99], a[248:251], v[144:147]
    ds_read_b128 a[80:83], v5 offset:0
    v_mfma_f32_16x16x32_bf16 v[148:151], a[96:99], a[252:255], v[148:151]
    v_mfma_f32_16x16x32_bf16 v[152:155], a[100:103], a[248:251], v[152:155]
    ds_read_b128 a[84:87], v5 offset:1024
    v_mfma_f32_16x16x32_bf16 v[156:159], a[100:103], a[252:255], v[156:159]
    v_mfma_f32_16x16x32_bf16 v[160:163], a[104:107], a[248:251], v[160:163]
    ds_read_b128 a[88:91], v5 offset:2048
    v_mfma_f32_16x16x32_bf16 v[164:167], a[104:107], a[252:255], v[164:167]
    v_mfma_f32_16x16x32_bf16 v[112:115], a[108:111], v[184:187], v[112:115]
    ds_read_b128 a[92:95], v5 offset:3072
    v_mfma_f32_16x16x32_bf16 v[116:119], a[108:111], v[188:191], v[116:119]
    s_waitcnt lgkmcnt(4)
    v_mfma_f32_16x16x32_bf16 v[120:123], a[112:115], v[184:187], v[120:123]
    ds_read_b128 a[96:99], v5 offset:4096
    v_mfma_f32_16x16x32_bf16 v[124:127], a[112:115], v[188:191], v[124:127]
    v_mfma_f32_16x16x32_bf16 v[128:131], a[116:119], v[184:187], v[128:131]
    ds_read_b128 a[100:103], v5 offset:5120
    v_mfma_f32_16x16x32_bf16 v[132:135], a[116:119], v[188:191], v[132:135]
    v_mfma_f32_16x16x32_bf16 v[136:139], a[120:123], v[184:187], v[136:139]
    ds_read_b128 a[104:107], v5 offset:6144
    v_mfma_f32_16x16x32_bf16 v[140:143], a[120:123], v[188:191], v[140:143]
    v_mfma_f32_16x16x32_bf16 v[144:147], a[124:127], v[184:187], v[144:147]
    ds_read_b128 a[108:111], v5 offset:7168
    v_mfma_f32_16x16x32_bf16 v[148:151], a[124:127], v[188:191], v[148:151]
    s_waitcnt vmcnt(16)
    s_barrier
    s_waitcnt lgkmcnt(4)
    v_mfma_f32_16x16x32_bf16 v[152:155], a[80:83], v[184:187], v[152:155]
    ds_read_b128 a[112:115], v5 offset:8192
    v_mfma_f32_16x16x32_bf16 v[156:159], a[80:83], v[188:191], v[156:159]
    s_add_u32 m0, s20, 73728
    v_mfma_f32_16x16x32_bf16 v[160:163], a[84:87], v[184:187], v[160:163]
    ds_read_b128 a[116:119], v5 offset:9216
    v_mfma_f32_16x16x32_bf16 v[164:167], a[84:87], v[188:191], v[164:167]
    buffer_load_dwordx4 v[92:95], v1, s[8:11], s55 offen
    v_mfma_f32_16x16x32_bf16 v[112:115], a[88:91], v[192:195], v[112:115]
    ds_read_b128 a[120:123], v5 offset:10240
    v_mfma_f32_16x16x32_bf16 v[116:119], a[88:91], v[196:199], v[116:119]
    buffer_load_dwordx4 v1, s[12:15], s24 offen offset:0 lds
    v_mfma_f32_16x16x32_bf16 v[120:123], a[92:95], v[192:195], v[120:123]
    ds_read_b128 a[124:127], v5 offset:11264
    v_mfma_f32_16x16x32_bf16 v[124:127], a[92:95], v[196:199], v[124:127]
    s_waitcnt lgkmcnt(4)
    v_mfma_f32_16x16x32_bf16 v[128:131], a[96:99], v[192:195], v[128:131]
    ds_read_b128 a[80:83], v5 offset:12288
    v_mfma_f32_16x16x32_bf16 v[132:135], a[96:99], v[196:199], v[132:135]
    buffer_load_dwordx4 v1, s[12:15], s24 offen offset:1024 lds
    s_add_u32 s55, s55, 18432
    v_mfma_f32_16x16x32_bf16 v[136:139], a[100:103], v[192:195], v[136:139]
    ds_read_b128 a[84:87], v5 offset:13312
    v_mfma_f32_16x16x32_bf16 v[140:143], a[100:103], v[196:199], v[140:143]
    v_mfma_f32_16x16x32_bf16 v[144:147], a[104:107], v[192:195], v[144:147]
    ds_read_b128 a[88:91], v5 offset:14336
    v_mfma_f32_16x16x32_bf16 v[148:151], a[104:107], v[196:199], v[148:151]
    buffer_load_dwordx4 v1, s[12:15], s24 offen offset:2048 lds
    v_mfma_f32_16x16x32_bf16 v[152:155], a[108:111], v[192:195], v[152:155]
    ds_read_b128 a[92:95], v5 offset:15360
    v_mfma_f32_16x16x32_bf16 v[156:159], a[108:111], v[196:199], v[156:159]
    buffer_load_dwordx4 v[96:99], v1, s[8:11], s55 offen
    s_waitcnt lgkmcnt(4)
    v_mfma_f32_16x16x32_bf16 v[160:163], a[112:115], v[192:195], v[160:163]
    ds_read_b128 a[96:99], v5 offset:16384
    v_mfma_f32_16x16x32_bf16 v[164:167], a[112:115], v[196:199], v[164:167]
    buffer_load_dwordx4 v1, s[12:15], s24 offen offset:3072 lds
    v_mfma_f32_16x16x32_bf16 v[112:115], a[116:119], v[200:203], v[112:115]
    ds_read_b128 a[100:103], v5 offset:17408
    v_mfma_f32_16x16x32_bf16 v[116:119], a[116:119], v[204:207], v[116:119]
    v_mfma_f32_16x16x32_bf16 v[120:123], a[120:123], v[200:203], v[120:123]
    ds_read_b128 a[104:107], v5 offset:18432
    v_mfma_f32_16x16x32_bf16 v[124:127], a[120:123], v[204:207], v[124:127]
    s_add_u32 m0, s20, 77824
    v_mfma_f32_16x16x32_bf16 v[128:131], a[124:127], v[200:203], v[128:131]
    ds_read_b128 a[108:111], v5 offset:19456
    buffer_load_dwordx2 v[100:101], v1, s[8:11], s57 offen
    v_mfma_f32_16x16x32_bf16 v[132:135], a[124:127], v[204:207], v[132:135]
    s_waitcnt lgkmcnt(4)
    v_mfma_f32_16x16x32_bf16 v[136:139], a[80:83], v[200:203], v[136:139]
    ds_read_b128 a[112:115], v5 offset:20480
    v_mfma_f32_16x16x32_bf16 v[140:143], a[80:83], v[204:207], v[140:143]
    buffer_load_dwordx4 v1, s[12:15], s25 offen offset:0 lds
    v_mfma_f32_16x16x32_bf16 v[144:147], a[84:87], v[200:203], v[144:147]
    ds_read_b128 a[116:119], v5 offset:21504
    v_mfma_f32_16x16x32_bf16 v[148:151], a[84:87], v[204:207], v[148:151]
    v_mfma_f32_16x16x32_bf16 v[152:155], a[88:91], v[200:203], v[152:155]
    ds_read_b128 a[120:123], v5 offset:22528
    s_add_u32 s57, s57, 18432
    v_mfma_f32_16x16x32_bf16 v[156:159], a[88:91], v[204:207], v[156:159]
    buffer_load_dwordx4 v1, s[12:15], s25 offen offset:1024 lds
    v_mfma_f32_16x16x32_bf16 v[160:163], a[92:95], v[200:203], v[160:163]
    ds_read_b128 a[124:127], v5 offset:23552
    v_mfma_f32_16x16x32_bf16 v[164:167], a[92:95], v[204:207], v[164:167]
    s_waitcnt lgkmcnt(4)
    v_mfma_f32_16x16x32_bf16 v[112:115], a[96:99], v[208:211], v[112:115]
    ds_read_b128 a[80:83], v5 offset:24576
    v_mfma_f32_16x16x32_bf16 v[116:119], a[96:99], v[212:215], v[116:119]
    buffer_load_dwordx4 v1, s[12:15], s25 offen offset:2048 lds
    v_mfma_f32_16x16x32_bf16 v[120:123], a[100:103], v[208:211], v[120:123]
    ds_read_b128 a[84:87], v5 offset:25600
    buffer_load_dwordx2 v[102:103], v1, s[8:11], s57 offen
    v_mfma_f32_16x16x32_bf16 v[124:127], a[100:103], v[212:215], v[124:127]
    v_mfma_f32_16x16x32_bf16 v[128:131], a[104:107], v[208:211], v[128:131]
    ds_read_b128 a[88:91], v5 offset:26624
    v_mfma_f32_16x16x32_bf16 v[132:135], a[104:107], v[212:215], v[132:135]
    buffer_load_dwordx4 v1, s[12:15], s25 offen offset:3072 lds
    v_mfma_f32_16x16x32_bf16 v[136:139], a[108:111], v[208:211], v[136:139]
    ds_read_b128 a[92:95], v5 offset:27648
    v_mfma_f32_16x16x32_bf16 v[140:143], a[108:111], v[212:215], v[140:143]
    s_waitcnt lgkmcnt(4)
    v_mfma_f32_16x16x32_bf16 v[144:147], a[112:115], v[208:211], v[144:147]
    ds_read_b128 a[96:99], v5 offset:28672
    v_mfma_f32_16x16x32_bf16 v[148:151], a[112:115], v[212:215], v[148:151]
    s_add_u32 m0, s20, 81920
    buffer_load_dwordx4 v[104:107], v26, s[8:11], s58 offen
    v_mfma_f32_16x16x32_bf16 v[152:155], a[116:119], v[208:211], v[152:155]
    ds_read_b128 a[100:103], v5 offset:29696
    v_mfma_f32_16x16x32_bf16 v[156:159], a[116:119], v[212:215], v[156:159]
    v_mfma_f32_16x16x32_bf16 v[160:163], a[120:123], v[208:211], v[160:163]
    ds_read_b128 a[104:107], v5 offset:30720
    v_mfma_f32_16x16x32_bf16 v[164:167], a[120:123], v[212:215], v[164:167]
    buffer_load_dwordx4 v1, s[12:15], s26 offen offset:0 lds
    v_mfma_f32_16x16x32_bf16 v[112:115], a[124:127], v[216:219], v[112:115]
    ds_read_b128 a[108:111], v5 offset:31744
    v_mfma_f32_16x16x32_bf16 v[116:119], a[124:127], v[220:223], v[116:119]
    buffer_load_dwordx4 v[108:111], v26, s[8:11], s58 offen offset:16
    s_waitcnt lgkmcnt(4)
    v_mfma_f32_16x16x32_bf16 v[120:123], a[80:83], v[216:219], v[120:123]
    ds_read_b128 a[112:115], v5 offset:32768
    v_mfma_f32_16x16x32_bf16 v[124:127], a[80:83], v[220:223], v[124:127]
    v_mfma_f32_16x16x32_bf16 v[128:131], a[84:87], v[216:219], v[128:131]
    ds_read_b128 a[116:119], v5 offset:33792
    v_mfma_f32_16x16x32_bf16 v[132:135], a[84:87], v[220:223], v[132:135]
    s_add_u32 s24, s24, 36864
    s_add_u32 s25, s25, 36864
    v_mfma_f32_16x16x32_bf16 v[136:139], a[88:91], v[216:219], v[136:139]
    ds_read_b128 a[120:123], v5 offset:34816
    s_add_u32 s26, s26, 36864
    v_mfma_f32_16x16x32_bf16 v[140:143], a[88:91], v[220:223], v[140:143]
    buffer_load_dwordx4 v[40:43], v26, s[8:11], s59 offen
    v_mfma_f32_16x16x32_bf16 v[144:147], a[92:95], v[216:219], v[144:147]
    ds_read_b128 a[124:127], v5 offset:35840
    v_mfma_f32_16x16x32_bf16 v[148:151], a[92:95], v[220:223], v[148:151]
    s_waitcnt lgkmcnt(4)
    v_mfma_f32_16x16x32_bf16 v[152:155], a[96:99], v[216:219], v[152:155]
    ds_read_b128 a[80:83], v6 offset:0
    v_mfma_f32_16x16x32_bf16 v[156:159], a[96:99], v[220:223], v[156:159]
    v_mfma_f32_16x16x32_bf16 v[160:163], a[100:103], v[216:219], v[160:163]
    ds_read_b128 a[84:87], v6 offset:7168
    v_mfma_f32_16x16x32_bf16 v[164:167], a[100:103], v[220:223], v[164:167]
    v_mfma_f32_16x16x32_bf16 v[112:115], a[104:107], v[224:227], v[112:115]
    ds_read_b128 a[88:91], v6 offset:14336
    v_mfma_f32_16x16x32_bf16 v[116:119], a[104:107], v[228:231], v[116:119]
    v_mfma_f32_16x16x32_bf16 v[120:123], a[108:111], v[224:227], v[120:123]
    ds_read_b128 a[92:95], v6 offset:21504
    v_mfma_f32_16x16x32_bf16 v[124:127], a[108:111], v[228:231], v[124:127]
    s_waitcnt lgkmcnt(4)
    v_mfma_f32_16x16x32_bf16 v[128:131], a[112:115], v[224:227], v[128:131]
    ds_read_b128 a[96:99], v6 offset:28672
    v_mfma_f32_16x16x32_bf16 v[132:135], a[112:115], v[228:231], v[132:135]
    v_mfma_f32_16x16x32_bf16 v[136:139], a[116:119], v[224:227], v[136:139]
    ds_read_b128 a[100:103], v6 offset:35840
    v_mfma_f32_16x16x32_bf16 v[140:143], a[116:119], v[228:231], v[140:143]
    v_mfma_f32_16x16x32_bf16 v[144:147], a[120:123], v[224:227], v[144:147]
    ds_read_b128 a[104:107], v6 offset:1024
    v_mfma_f32_16x16x32_bf16 v[148:151], a[120:123], v[228:231], v[148:151]
    v_mfma_f32_16x16x32_bf16 v[152:155], a[124:127], v[224:227], v[152:155]
    ds_read_b128 a[108:111], v6 offset:8192
    v_mfma_f32_16x16x32_bf16 v[156:159], a[124:127], v[228:231], v[156:159]
    s_waitcnt vmcnt(16)
    s_barrier
    s_waitcnt lgkmcnt(4)
    v_mfma_f32_16x16x32_bf16 v[160:163], a[80:83], v[224:227], v[160:163]
    ds_read_b128 a[112:115], v6 offset:15360
    v_mfma_f32_16x16x32_bf16 v[164:167], a[80:83], v[228:231], v[164:167]
    v_mfma_f32_16x16x32_bf16 v[160:163], a[84:87], v[232:235], v[160:163]
    ds_read_b128 a[116:119], v6 offset:22528
    v_mfma_f32_16x16x32_bf16 v[164:167], a[84:87], v[236:239], v[164:167]
    v_mfma_f32_16x16x32_bf16 v[160:163], a[88:91], v[240:243], v[160:163]
    ds_read_b128 a[120:123], v6 offset:29696
    v_mfma_f32_16x16x32_bf16 v[164:167], a[88:91], v[244:247], v[164:167]
    v_mfma_f32_16x16x32_bf16 v[160:163], a[92:95], v[248:251], v[160:163]
    ds_read_b128 a[124:127], v6 offset:2048
    v_mfma_f32_16x16x32_bf16 v[164:167], a[92:95], v[252:255], v[164:167]
    s_waitcnt lgkmcnt(4)
    v_mfma_f32_16x16x32_bf16 v[160:163], a[96:99], v[48:51], v[160:163]
    ds_read_b128 a[80:83], v6 offset:9216
    v_mfma_f32_16x16x32_bf16 v[164:167], a[96:99], v[52:55], v[164:167]
    v_mfma_f32_16x16x32_bf16 v[160:163], a[100:103], v[56:59], v[160:163]
    ds_read_b128 a[84:87], v6 offset:16384
    v_mfma_f32_16x16x32_bf16 v[164:167], a[100:103], v[60:63], v[164:167]
    v_mfma_f32_16x16x32_bf16 v[112:115], a[104:107], v[232:235], v[112:115]
    ds_read_b128 a[88:91], v6 offset:23552
    v_mfma_f32_16x16x32_bf16 v[116:119], a[104:107], v[236:239], v[116:119]
    v_mfma_f32_16x16x32_bf16 v[112:115], a[108:111], v[240:243], v[112:115]
    ds_read_b128 a[92:95], v6 offset:30720
    v_mfma_f32_16x16x32_bf16 v[116:119], a[108:111], v[244:247], v[116:119]
    s_waitcnt lgkmcnt(4)
    v_mfma_f32_16x16x32_bf16 v[112:115], a[112:115], v[248:251], v[112:115]
    ds_read_b128 a[96:99], v6 offset:3072
    v_mfma_f32_16x16x32_bf16 v[116:119], a[112:115], v[252:255], v[116:119]
    v_mfma_f32_16x16x32_bf16 v[112:115], a[116:119], v[48:51], v[112:115]
    ds_read_b128 a[100:103], v6 offset:10240
    v_cvt_pk_bf16_f32 v88, v160, v161
    v_mfma_f32_16x16x32_bf16 v[116:119], a[116:119], v[52:55], v[116:119]
    v_cvt_pk_bf16_f32 v89, v162, v163
    v_mfma_f32_16x16x32_bf16 v[112:115], a[120:123], v[56:59], v[112:115]
    ds_read_b128 a[104:107], v6 offset:17408
    v_mfma_f32_16x16x32_bf16 v[116:119], a[120:123], v[60:63], v[116:119]
    v_cvt_pk_bf16_f32 v90, v164, v165
    v_mfma_f32_16x16x32_bf16 v[120:123], a[124:127], v[232:235], v[120:123]
    ds_read_b128 a[108:111], v6 offset:24576
    v_cvt_pk_bf16_f32 v91, v166, v167
    v_mfma_f32_16x16x32_bf16 v[124:127], a[124:127], v[236:239], v[124:127]
    s_waitcnt lgkmcnt(4)
    v_mfma_f32_16x16x32_bf16 v[120:123], a[80:83], v[240:243], v[120:123]
    ds_read_b128 a[112:115], v6 offset:31744
    buffer_store_dwordx4 v[88:91], v1, s[8:11], s35 offen sc1
    v_mfma_f32_16x16x32_bf16 v[124:127], a[80:83], v[244:247], v[124:127]
    v_mfma_f32_16x16x32_bf16 v[120:123], a[84:87], v[248:251], v[120:123]
    ds_read_b128 a[116:119], v6 offset:4096
    v_mfma_f32_16x16x32_bf16 v[124:127], a[84:87], v[252:255], v[124:127]
    v_mfma_f32_16x16x32_bf16 v[120:123], a[88:91], v[48:51], v[120:123]
    ds_read_b128 a[120:123], v6 offset:11264
    v_mfma_f32_16x16x32_bf16 v[124:127], a[88:91], v[52:55], v[124:127]
    v_mfma_f32_16x16x32_bf16 v[120:123], a[92:95], v[56:59], v[120:123]
    ds_read_b128 a[124:127], v6 offset:18432
    v_mfma_f32_16x16x32_bf16 v[124:127], a[92:95], v[60:63], v[124:127]
    s_waitcnt lgkmcnt(4)
    v_mfma_f32_16x16x32_bf16 v[128:131], a[96:99], v[232:235], v[128:131]
    ds_read_b128 a[80:83], v6 offset:25600
    v_mfma_f32_16x16x32_bf16 v[132:135], a[96:99], v[236:239], v[132:135]
    v_mfma_f32_16x16x32_bf16 v[128:131], a[100:103], v[240:243], v[128:131]
    ds_read_b128 a[84:87], v6 offset:32768
    v_mfma_f32_16x16x32_bf16 v[132:135], a[100:103], v[244:247], v[132:135]
    v_mfma_f32_16x16x32_bf16 v[128:131], a[104:107], v[248:251], v[128:131]
    ds_read_b128 a[88:91], v6 offset:5120
    v_mfma_f32_16x16x32_bf16 v[132:135], a[104:107], v[252:255], v[132:135]
    v_mfma_f32_16x16x32_bf16 v[128:131], a[108:111], v[48:51], v[128:131]
    ds_read_b128 a[92:95], v6 offset:12288
    v_cvt_pk_bf16_f32 v64, v112, v113
    v_mfma_f32_16x16x32_bf16 v[132:135], a[108:111], v[52:55], v[132:135]
    v_cvt_pk_bf16_f32 v65, v114, v115
    s_waitcnt lgkmcnt(4)
    v_mfma_f32_16x16x32_bf16 v[128:131], a[112:115], v[56:59], v[128:131]
    ds_read_b128 a[96:99], v6 offset:19456
    v_cvt_pk_bf16_f32 v66, v120, v121
    v_mfma_f32_16x16x32_bf16 v[132:135], a[112:115], v[60:63], v[132:135]
    v_cvt_pk_bf16_f32 v67, v122, v123
    v_mfma_f32_16x16x32_bf16 v[136:139], a[116:119], v[232:235], v[136:139]
    ds_read_b128 a[100:103], v6 offset:26624
    buffer_store_dwordx4 v[64:67], v1, s[8:11], s32 offen offset:0 sc1
    v_mfma_f32_16x16x32_bf16 v[140:143], a[116:119], v[236:239], v[140:143]
    v_mfma_f32_16x16x32_bf16 v[136:139], a[120:123], v[240:243], v[136:139]
    ds_read_b128 a[104:107], v6 offset:33792
    v_cvt_pk_bf16_f32 v68, v116, v117
    v_mfma_f32_16x16x32_bf16 v[140:143], a[120:123], v[244:247], v[140:143]
    v_cvt_pk_bf16_f32 v69, v118, v119
    v_mfma_f32_16x16x32_bf16 v[136:139], a[124:127], v[248:251], v[136:139]
    ds_read_b128 a[108:111], v6 offset:6144
    v_cvt_pk_bf16_f32 v70, v124, v125
    v_mfma_f32_16x16x32_bf16 v[140:143], a[124:127], v[252:255], v[140:143]
    v_cvt_pk_bf16_f32 v71, v126, v127
    s_waitcnt lgkmcnt(4)
    v_mfma_f32_16x16x32_bf16 v[136:139], a[80:83], v[48:51], v[136:139]
    ds_read_b128 a[112:115], v6 offset:13312
    buffer_store_dwordx4 v[68:71], v1, s[8:11], s32 offen offset:1024 sc1
    v_mfma_f32_16x16x32_bf16 v[140:143], a[80:83], v[52:55], v[140:143]
    v_mfma_f32_16x16x32_bf16 v[136:139], a[84:87], v[56:59], v[136:139]
    ds_read_b128 a[116:119], v6 offset:20480
    v_mfma_f32_16x16x32_bf16 v[140:143], a[84:87], v[60:63], v[140:143]
    v_mfma_f32_16x16x32_bf16 v[144:147], a[88:91], v[232:235], v[144:147]
    ds_read_b128 a[120:123], v6 offset:27648
    v_mfma_f32_16x16x32_bf16 v[148:151], a[88:91], v[236:239], v[148:151]
    v_mfma_f32_16x16x32_bf16 v[144:147], a[92:95], v[240:243], v[144:147]
    ds_read_b128 a[124:127], v6 offset:34816
    v_mfma_f32_16x16x32_bf16 v[148:151], a[92:95], v[244:247], v[148:151]
    s_waitcnt lgkmcnt(4)
    v_mfma_f32_16x16x32_bf16 v[144:147], a[96:99], v[248:251], v[144:147]
    ds_read_b128 a[80:83], v7 offset:0
    v_mfma_f32_16x16x32_bf16 v[148:151], a[96:99], v[252:255], v[148:151]
    v_mfma_f32_16x16x32_bf16 v[144:147], a[100:103], v[48:51], v[144:147]
    ds_read_b128 a[84:87], v7 offset:1024
    v_cvt_pk_bf16_f32 v72, v128, v129
    v_mfma_f32_16x16x32_bf16 v[148:151], a[100:103], v[52:55], v[148:151]
    v_cvt_pk_bf16_f32 v73, v130, v131
    v_mfma_f32_16x16x32_bf16 v[144:147], a[104:107], v[56:59], v[144:147]
    ds_read_b128 a[88:91], v7 offset:2048
    v_cvt_pk_bf16_f32 v74, v136, v137
    v_mfma_f32_16x16x32_bf16 v[148:151], a[104:107], v[60:63], v[148:151]
    v_cvt_pk_bf16_f32 v75, v138, v139
    v_mfma_f32_16x16x32_bf16 v[152:155], a[108:111], v[232:235], v[152:155]
    ds_read_b128 a[92:95], v7 offset:3072
    buffer_store_dwordx4 v[72:75], v1, s[8:11], s33 offen offset:0 sc1
    v_mfma_f32_16x16x32_bf16 v[156:159], a[108:111], v[236:239], v[156:159]
    s_waitcnt lgkmcnt(4)
    v_mfma_f32_16x16x32_bf16 v[152:155], a[112:115], v[240:243], v[152:155]
    ds_read_b128 a[96:99], v7 offset:4096
    v_cvt_pk_bf16_f32 v76, v132, v133
    v_mfma_f32_16x16x32_bf16 v[156:159], a[112:115], v[244:247], v[156:159]
    v_cvt_pk_bf16_f32 v77, v134, v135
    v_mfma_f32_16x16x32_bf16 v[152:155], a[116:119], v[248:251], v[152:155]
    ds_read_b128 a[100:103], v7 offset:5120
    v_cvt_pk_bf16_f32 v78, v140, v141
    v_mfma_f32_16x16x32_bf16 v[156:159], a[116:119], v[252:255], v[156:159]
    v_cvt_pk_bf16_f32 v79, v142, v143
    v_mfma_f32_16x16x32_bf16 v[152:155], a[120:123], v[48:51], v[152:155]
    ds_read_b128 a[104:107], v7 offset:6144
    buffer_store_dwordx4 v[76:79], v1, s[8:11], s33 offen offset:1024 sc1
    v_mfma_f32_16x16x32_bf16 v[156:159], a[120:123], v[52:55], v[156:159]
    v_mfma_f32_16x16x32_bf16 v[152:155], a[124:127], v[56:59], v[152:155]
    ds_read_b128 a[108:111], v7 offset:7168
    v_mfma_f32_16x16x32_bf16 v[156:159], a[124:127], v[60:63], v[156:159]
    s_waitcnt vmcnt(5)
    s_barrier
    s_waitcnt lgkmcnt(4)
    v_mfma_f32_16x16x32_bf16 v[168:171], a[80:83], a[8:11], 0
    ds_read_b128 a[112:115], v7 offset:8192
    v_mfma_f32_16x16x32_bf16 v[172:175], a[80:83], a[12:15], 0
    v_mfma_f32_16x16x32_bf16 v[176:179], a[84:87], a[8:11], 0
    ds_read_b128 a[116:119], v7 offset:9216
    v_mfma_f32_16x16x32_bf16 v[180:183], a[84:87], a[12:15], 0
    v_mfma_f32_16x16x32_bf16 v[168:171], a[88:91], a[16:19], v[168:171]
    ds_read_b128 a[120:123], v7 offset:10240
    v_mfma_f32_16x16x32_bf16 v[172:175], a[88:91], a[20:23], v[172:175]
    v_cvt_pk_bf16_f32 v80, v144, v145
    v_cvt_pk_bf16_f32 v81, v146, v147
    v_mfma_f32_16x16x32_bf16 v[176:179], a[92:95], a[16:19], v[176:179]
    ds_read_b128 a[124:127], v7 offset:11264
    v_cvt_pk_bf16_f32 v82, v152, v153
    v_mfma_f32_16x16x32_bf16 v[180:183], a[92:95], a[20:23], v[180:183]
    v_cvt_pk_bf16_f32 v83, v154, v155
    s_waitcnt lgkmcnt(4)
    v_mfma_f32_16x16x32_bf16 v[168:171], a[96:99], a[24:27], v[168:171]
    ds_read_b128 a[80:83], v7 offset:12288
    buffer_store_dwordx4 v[80:83], v1, s[8:11], s34 offen offset:0 sc1
    v_mfma_f32_16x16x32_bf16 v[172:175], a[96:99], a[28:31], v[172:175]
    v_cvt_pk_bf16_f32 v84, v148, v149
    v_mfma_f32_16x16x32_bf16 v[176:179], a[100:103], a[24:27], v[176:179]
    ds_read_b128 a[84:87], v7 offset:13312
    v_cvt_pk_bf16_f32 v85, v150, v151
    v_mfma_f32_16x16x32_bf16 v[180:183], a[100:103], a[28:31], v[180:183]
    v_cvt_pk_bf16_f32 v86, v156, v157
    v_mfma_f32_16x16x32_bf16 v[168:171], a[104:107], a[32:35], v[168:171]
    ds_read_b128 a[88:91], v7 offset:14336
    v_cvt_pk_bf16_f32 v87, v158, v159
    v_mfma_f32_16x16x32_bf16 v[172:175], a[104:107], a[36:39], v[172:175]
    buffer_store_dwordx4 v[84:87], v1, s[8:11], s34 offen offset:1024 sc1
    v_mfma_f32_16x16x32_bf16 v[176:179], a[108:111], a[32:35], v[176:179]
    ds_read_b128 a[92:95], v7 offset:15360
    v_mfma_f32_16x16x32_bf16 v[180:183], a[108:111], a[36:39], v[180:183]
    s_waitcnt lgkmcnt(4)
    v_mfma_f32_16x16x32_bf16 v[168:171], a[112:115], a[40:43], v[168:171]
    ds_read_b128 a[96:99], v7 offset:16384
    v_mfma_f32_16x16x32_bf16 v[172:175], a[112:115], a[44:47], v[172:175]
    v_mfma_f32_16x16x32_bf16 v[176:179], a[116:119], a[40:43], v[176:179]
    ds_read_b128 a[100:103], v7 offset:17408
    v_mfma_f32_16x16x32_bf16 v[180:183], a[116:119], a[44:47], v[180:183]
    v_mfma_f32_16x16x32_bf16 v[168:171], a[120:123], a[48:51], v[168:171]
    ds_read_b128 a[104:107], v7 offset:18432
    v_mfma_f32_16x16x32_bf16 v[172:175], a[120:123], a[52:55], v[172:175]
    v_mfma_f32_16x16x32_bf16 v[176:179], a[124:127], a[48:51], v[176:179]
    ds_read_b128 a[108:111], v7 offset:19456
    v_mfma_f32_16x16x32_bf16 v[180:183], a[124:127], a[52:55], v[180:183]
    s_waitcnt lgkmcnt(4)
    v_mfma_f32_16x16x32_bf16 v[168:171], a[80:83], a[56:59], v[168:171]
    ds_read_b128 a[112:115], v7 offset:20480
    v_mfma_f32_16x16x32_bf16 v[172:175], a[80:83], a[60:63], v[172:175]
    v_mfma_f32_16x16x32_bf16 v[176:179], a[84:87], a[56:59], v[176:179]
    ds_read_b128 a[116:119], v7 offset:21504
    v_mfma_f32_16x16x32_bf16 v[180:183], a[84:87], a[60:63], v[180:183]
    v_mfma_f32_16x16x32_bf16 v[168:171], a[88:91], a[64:67], v[168:171]
    ds_read_b128 a[120:123], v7 offset:22528
    v_mfma_f32_16x16x32_bf16 v[172:175], a[88:91], a[68:71], v[172:175]
    v_mfma_f32_16x16x32_bf16 v[176:179], a[92:95], a[64:67], v[176:179]
    ds_read_b128 a[124:127], v7 offset:23552
    v_mfma_f32_16x16x32_bf16 v[180:183], a[92:95], a[68:71], v[180:183]
    s_waitcnt lgkmcnt(4)
    v_mfma_f32_16x16x32_bf16 v[168:171], a[96:99], a[72:75], v[168:171]
    ds_read_b128 a[80:83], v7 offset:24576
    v_mfma_f32_16x16x32_bf16 v[172:175], a[96:99], a[76:79], v[172:175]
    v_mfma_f32_16x16x32_bf16 v[176:179], a[100:103], a[72:75], v[176:179]
    ds_read_b128 a[84:87], v7 offset:25600
    v_mfma_f32_16x16x32_bf16 v[180:183], a[100:103], a[76:79], v[180:183]
    v_mfma_f32_16x16x32_bf16 v[168:171], a[104:107], a[128:131], v[168:171]
    ds_read_b128 a[88:91], v7 offset:26624
    v_mfma_f32_16x16x32_bf16 v[172:175], a[104:107], a[132:135], v[172:175]
    v_mfma_f32_16x16x32_bf16 v[176:179], a[108:111], a[128:131], v[176:179]
    ds_read_b128 a[92:95], v7 offset:27648
    v_mfma_f32_16x16x32_bf16 v[180:183], a[108:111], a[132:135], v[180:183]
    s_waitcnt lgkmcnt(4)
    v_mfma_f32_16x16x32_bf16 v[168:171], a[112:115], a[136:139], v[168:171]
    ds_read_b128 a[96:99], v7 offset:28672
    v_mfma_f32_16x16x32_bf16 v[172:175], a[112:115], a[140:143], v[172:175]
    v_mfma_f32_16x16x32_bf16 v[176:179], a[116:119], a[136:139], v[176:179]
    ds_read_b128 a[100:103], v7 offset:29696
    v_mfma_f32_16x16x32_bf16 v[180:183], a[116:119], a[140:143], v[180:183]
    v_mfma_f32_16x16x32_bf16 v[168:171], a[120:123], a[144:147], v[168:171]
    ds_read_b128 a[104:107], v7 offset:30720
    v_mfma_f32_16x16x32_bf16 v[172:175], a[120:123], a[148:151], v[172:175]
    v_mfma_f32_16x16x32_bf16 v[176:179], a[124:127], a[144:147], v[176:179]
    ds_read_b128 a[108:111], v7 offset:31744
    v_mfma_f32_16x16x32_bf16 v[180:183], a[124:127], a[148:151], v[180:183]
    s_waitcnt lgkmcnt(4)
    v_mfma_f32_16x16x32_bf16 v[168:171], a[80:83], a[152:155], v[168:171]
    ds_read_b128 a[112:115], v7 offset:32768
    v_mfma_f32_16x16x32_bf16 v[172:175], a[80:83], a[156:159], v[172:175]
    v_mfma_f32_16x16x32_bf16 v[176:179], a[84:87], a[152:155], v[176:179]
    ds_read_b128 a[116:119], v7 offset:33792
    v_mov_b32 v45, 1
    s_waitcnt vmcnt(0)
    buffer_store_dword v45, v18, s[8:11], s61 offen sc1
    v_mfma_f32_16x16x32_bf16 v[180:183], a[84:87], a[156:159], v[180:183]
    v_mfma_f32_16x16x32_bf16 v[168:171], a[88:91], a[160:163], v[168:171]
    ds_read_b128 a[120:123], v7 offset:34816
    v_mfma_f32_16x16x32_bf16 v[172:175], a[88:91], a[164:167], v[172:175]
    v_mfma_f32_16x16x32_bf16 v[176:179], a[92:95], a[160:163], v[176:179]
    ds_read_b128 a[124:127], v7 offset:35840
    v_mfma_f32_16x16x32_bf16 v[180:183], a[92:95], a[164:167], v[180:183]
    s_waitcnt lgkmcnt(4)
    v_mfma_f32_16x16x32_bf16 v[168:171], a[96:99], a[168:171], v[168:171]
    ds_read_b128 a[80:83], v4 offset:0
    v_mfma_f32_16x16x32_bf16 v[172:175], a[96:99], a[172:175], v[172:175]
    v_mfma_f32_16x16x32_bf16 v[176:179], a[100:103], a[168:171], v[176:179]
    ds_read_b128 a[84:87], v4 offset:1024
    v_mfma_f32_16x16x32_bf16 v[180:183], a[100:103], a[172:175], v[180:183]
    v_mfma_f32_16x16x32_bf16 v[168:171], a[104:107], a[176:179], v[168:171]
    ds_read_b128 a[88:91], v4 offset:2048
    v_mfma_f32_16x16x32_bf16 v[172:175], a[104:107], a[180:183], v[172:175]
    v_mfma_f32_16x16x32_bf16 v[176:179], a[108:111], a[176:179], v[176:179]
    ds_read_b128 a[92:95], v4 offset:3072
    v_mfma_f32_16x16x32_bf16 v[180:183], a[108:111], a[180:183], v[180:183]
    s_waitcnt lgkmcnt(4)
    v_mfma_f32_16x16x32_bf16 v[168:171], a[112:115], a[184:187], v[168:171]
    ds_read_b128 a[96:99], v4 offset:4096
    v_mfma_f32_16x16x32_bf16 v[172:175], a[112:115], a[188:191], v[172:175]
    v_mfma_f32_16x16x32_bf16 v[176:179], a[116:119], a[184:187], v[176:179]
    ds_read_b128 a[100:103], v4 offset:5120
    v_mfma_f32_16x16x32_bf16 v[180:183], a[116:119], a[188:191], v[180:183]
    v_mfma_f32_16x16x32_bf16 v[168:171], a[120:123], a[192:195], v[168:171]
    ds_read_b128 a[104:107], v4 offset:6144
    v_mfma_f32_16x16x32_bf16 v[172:175], a[120:123], a[196:199], v[172:175]
    v_mfma_f32_16x16x32_bf16 v[176:179], a[124:127], a[192:195], v[176:179]
    ds_read_b128 a[108:111], v4 offset:7168
    v_mfma_f32_16x16x32_bf16 v[180:183], a[124:127], a[196:199], v[180:183]
    s_waitcnt lgkmcnt(4)
    v_mfma_f32_16x16x32_bf16 v[168:171], a[80:83], a[200:203], v[168:171]
    ds_read_b128 a[112:115], v4 offset:8192
    buffer_load_dwordx4 v[20:23], v24, s[8:11], s60 offen sc1
    v_mfma_f32_16x16x32_bf16 v[172:175], a[80:83], a[204:207], v[172:175]
    v_mfma_f32_16x16x32_bf16 v[176:179], a[84:87], a[200:203], v[176:179]
    ds_read_b128 a[116:119], v4 offset:9216
    v_mfma_f32_16x16x32_bf16 v[180:183], a[84:87], a[204:207], v[180:183]
    v_mfma_f32_16x16x32_bf16 v[168:171], a[88:91], a[208:211], v[168:171]
    ds_read_b128 a[120:123], v4 offset:10240
    v_mfma_f32_16x16x32_bf16 v[172:175], a[88:91], a[212:215], v[172:175]
    v_mfma_f32_16x16x32_bf16 v[176:179], a[92:95], a[208:211], v[176:179]
    ds_read_b128 a[124:127], v4 offset:11264
    v_mfma_f32_16x16x32_bf16 v[180:183], a[92:95], a[212:215], v[180:183]
    s_waitcnt lgkmcnt(4)
    v_mfma_f32_16x16x32_bf16 v[168:171], a[96:99], a[216:219], v[168:171]
    ds_read_b128 a[80:83], v4 offset:12288
    v_mfma_f32_16x16x32_bf16 v[172:175], a[96:99], a[220:223], v[172:175]
    v_mfma_f32_16x16x32_bf16 v[176:179], a[100:103], a[216:219], v[176:179]
    ds_read_b128 a[84:87], v4 offset:13312
    v_mfma_f32_16x16x32_bf16 v[180:183], a[100:103], a[220:223], v[180:183]
    v_mfma_f32_16x16x32_bf16 v[168:171], a[104:107], a[224:227], v[168:171]
    ds_read_b128 a[88:91], v4 offset:14336
    v_mfma_f32_16x16x32_bf16 v[172:175], a[104:107], a[228:231], v[172:175]
    v_mfma_f32_16x16x32_bf16 v[176:179], a[108:111], a[224:227], v[176:179]
    ds_read_b128 a[92:95], v4 offset:15360
    v_mfma_f32_16x16x32_bf16 v[180:183], a[108:111], a[228:231], v[180:183]
    s_waitcnt lgkmcnt(4)
    v_mfma_f32_16x16x32_bf16 v[168:171], a[112:115], a[232:235], v[168:171]
    ds_read_b128 a[96:99], v4 offset:16384
    v_mfma_f32_16x16x32_bf16 v[172:175], a[112:115], a[236:239], v[172:175]
    v_mfma_f32_16x16x32_bf16 v[176:179], a[116:119], a[232:235], v[176:179]
    ds_read_b128 a[100:103], v4 offset:17408
    v_mfma_f32_16x16x32_bf16 v[180:183], a[116:119], a[236:239], v[180:183]
    v_mfma_f32_16x16x32_bf16 v[168:171], a[120:123], a[240:243], v[168:171]
    ds_read_b128 a[104:107], v4 offset:18432
    v_mfma_f32_16x16x32_bf16 v[172:175], a[120:123], a[244:247], v[172:175]
    v_mfma_f32_16x16x32_bf16 v[176:179], a[124:127], a[240:243], v[176:179]
    ds_read_b128 a[108:111], v4 offset:19456
    v_mfma_f32_16x16x32_bf16 v[180:183], a[124:127], a[244:247], v[180:183]
    s_waitcnt lgkmcnt(4)
    v_mfma_f32_16x16x32_bf16 v[168:171], a[80:83], a[248:251], v[168:171]
    ds_read_b128 a[112:115], v4 offset:20480
    v_mfma_f32_16x16x32_bf16 v[172:175], a[80:83], a[252:255], v[172:175]
    v_mfma_f32_16x16x32_bf16 v[176:179], a[84:87], a[248:251], v[176:179]
    ds_read_b128 a[116:119], v4 offset:21504
    v_mfma_f32_16x16x32_bf16 v[180:183], a[84:87], a[252:255], v[180:183]
    v_mfma_f32_16x16x32_bf16 v[168:171], a[88:91], v[184:187], v[168:171]
    ds_read_b128 a[120:123], v4 offset:22528
    v_mfma_f32_16x16x32_bf16 v[172:175], a[88:91], v[188:191], v[172:175]
    v_mfma_f32_16x16x32_bf16 v[176:179], a[92:95], v[184:187], v[176:179]
    ds_read_b128 a[124:127], v4 offset:23552
    v_mfma_f32_16x16x32_bf16 v[180:183], a[92:95], v[188:191], v[180:183]
    s_waitcnt lgkmcnt(4)
    v_mfma_f32_16x16x32_bf16 v[168:171], a[96:99], v[192:195], v[168:171]
    ds_read_b128 a[80:83], v4 offset:24576
    v_mfma_f32_16x16x32_bf16 v[172:175], a[96:99], v[196:199], v[172:175]
    v_mfma_f32_16x16x32_bf16 v[176:179], a[100:103], v[192:195], v[176:179]
    ds_read_b128 a[84:87], v4 offset:25600
    v_mfma_f32_16x16x32_bf16 v[180:183], a[100:103], v[196:199], v[180:183]
    v_mfma_f32_16x16x32_bf16 v[168:171], a[104:107], v[200:203], v[168:171]
    ds_read_b128 a[88:91], v4 offset:26624
    v_mfma_f32_16x16x32_bf16 v[172:175], a[104:107], v[204:207], v[172:175]
    v_mfma_f32_16x16x32_bf16 v[176:179], a[108:111], v[200:203], v[176:179]
    ds_read_b128 a[92:95], v4 offset:27648
    v_mfma_f32_16x16x32_bf16 v[180:183], a[108:111], v[204:207], v[180:183]
    s_waitcnt lgkmcnt(4)
    v_mfma_f32_16x16x32_bf16 v[168:171], a[112:115], v[208:211], v[168:171]
    ds_read_b128 a[96:99], v4 offset:28672
    v_mfma_f32_16x16x32_bf16 v[172:175], a[112:115], v[212:215], v[172:175]
    v_mfma_f32_16x16x32_bf16 v[176:179], a[116:119], v[208:211], v[176:179]
    ds_read_b128 a[100:103], v4 offset:29696
    v_mfma_f32_16x16x32_bf16 v[180:183], a[116:119], v[212:215], v[180:183]
    v_mfma_f32_16x16x32_bf16 v[168:171], a[120:123], v[216:219], v[168:171]
    ds_read_b128 a[104:107], v4 offset:30720
    v_mfma_f32_16x16x32_bf16 v[172:175], a[120:123], v[220:223], v[172:175]
    v_mfma_f32_16x16x32_bf16 v[176:179], a[124:127], v[216:219], v[176:179]
    ds_read_b128 a[108:111], v4 offset:31744
    v_mfma_f32_16x16x32_bf16 v[180:183], a[124:127], v[220:223], v[180:183]
    s_waitcnt lgkmcnt(4)
    v_mfma_f32_16x16x32_bf16 v[168:171], a[80:83], v[224:227], v[168:171]
    ds_read_b128 a[112:115], v4 offset:32768
    s_waitcnt vmcnt(0)
    v_min_i32 v25, v20, v21
    v_min3_i32 v25, v22, v23, v25
    v_cmp_gt_i32 vcc, 1, v25
    s_mov_b32 s31, 0
    s_cbranch_vccnz K5_eno
    s_mov_b32 s31, 1
    s_add_u32 s55, s56, 0x1000
    buffer_load_dwordx4 v[112:115], v1, s[8:11], s56 offen offset:0 sc1
    buffer_load_dwordx4 v[116:119], v1, s[8:11], s56 offen offset:1024 sc1
    buffer_load_dwordx4 v[120:123], v1, s[8:11], s56 offen offset:2048 sc1
    buffer_load_dwordx4 v[124:127], v1, s[8:11], s56 offen offset:3072 sc1
    buffer_load_dwordx4 v[128:131], v1, s[8:11], s55 offen offset:0 sc1
    buffer_load_dwordx4 v[132:135], v1, s[8:11], s55 offen offset:1024 sc1
    buffer_load_dwordx4 v[136:139], v1, s[8:11], s51 offen offset:0 sc1
    buffer_load_dwordx4 v[140:143], v1, s[8:11], s51 offen offset:1024 sc1
    buffer_load_dwordx4 v[144:147], v1, s[8:11], s51 offen offset:2048 sc1
    buffer_load_dwordx4 v[148:151], v1, s[8:11], s51 offen offset:3072 sc1
    s_branch K5_edone
K5_eno:
    buffer_load_dwordx4 v[20:23], v24, s[8:11], s60 offen sc1
K5_edone:
    v_mfma_f32_16x16x32_bf16 v[172:175], a[80:83], v[228:231], v[172:175]
    v_mfma_f32_16x16x32_bf16 v[176:179], a[84:87], v[224:227], v[176:179]
    ds_read_b128 a[116:119], v4 offset:33792
    v_mfma_f32_16x16x32_bf16 v[180:183], a[84:87], v[228:231], v[180:183]
    v_mfma_f32_16x16x32_bf16 v[168:171], a[88:91], v[232:235], v[168:171]
    ds_read_b128 a[120:123], v4 offset:34816
    v_mfma_f32_16x16x32_bf16 v[172:175], a[88:91], v[236:239], v[172:175]
    v_mfma_f32_16x16x32_bf16 v[176:179], a[92:95], v[232:235], v[176:179]
    ds_read_b128 a[124:127], v4 offset:35840
    v_mfma_f32_16x16x32_bf16 v[180:183], a[92:95], v[236:239], v[180:183]
    s_waitcnt lgkmcnt(4)
    v_mfma_f32_16x16x32_bf16 v[168:171], a[96:99], v[240:243], v[168:171]
    v_mfma_f32_16x16x32_bf16 v[172:175], a[96:99], v[244:247], v[172:175]
    v_mfma_f32_16x16x32_bf16 v[176:179], a[100:103], v[240:243], v[176:179]
    v_mfma_f32_16x16x32_bf16 v[180:183], a[100:103], v[244:247], v[180:183]
    v_mfma_f32_16x16x32_bf16 v[168:171], a[104:107], v[248:251], v[168:171]
    v_mfma_f32_16x16x32_bf16 v[172:175], a[104:107], v[252:255], v[172:175]
    v_mfma_f32_16x16x32_bf16 v[176:179], a[108:111], v[248:251], v[176:179]
    v_mfma_f32_16x16x32_bf16 v[180:183], a[108:111], v[252:255], v[180:183]
    s_waitcnt lgkmcnt(0)
    v_mfma_f32_16x16x32_bf16 v[168:171], a[112:115], v[48:51], v[168:171]
    v_mfma_f32_16x16x32_bf16 v[172:175], a[112:115], v[52:55], v[172:175]
    v_mfma_f32_16x16x32_bf16 v[176:179], a[116:119], v[48:51], v[176:179]
    v_mfma_f32_16x16x32_bf16 v[180:183], a[116:119], v[52:55], v[180:183]
    v_mfma_f32_16x16x32_bf16 v[168:171], a[120:123], v[56:59], v[168:171]
    v_mfma_f32_16x16x32_bf16 v[172:175], a[120:123], v[60:63], v[172:175]
    v_mfma_f32_16x16x32_bf16 v[176:179], a[124:127], v[56:59], v[176:179]
    v_mfma_f32_16x16x32_bf16 v[180:183], a[124:127], v[60:63], v[180:183]
    s_cmp_lg_u32 s31, 0
    s_cbranch_scc1 K5_rgot
K5_rpoll:
    buffer_load_dwordx4 v[28:31], v24, s[8:11], s60 offen sc1
    s_waitcnt vmcnt(1)
    v_min_i32 v25, v20, v21
    v_min3_i32 v25, v22, v23, v25
    v_cmp_gt_i32 vcc, 1, v25
    s_cbranch_vccz K5_rok
    buffer_load_dwordx4 v[20:23], v24, s[8:11], s60 offen sc1
    s_waitcnt vmcnt(1)
    v_min_i32 v25, v28, v29
    v_min3_i32 v25, v30, v31, v25
    v_cmp_gt_i32 vcc, 1, v25
    s_cbranch_vccz K5_rok
    s_branch K5_rpoll
K5_rok:
    s_add_u32 s55, s56, 0x1000
    buffer_load_dwordx4 v[112:115], v1, s[8:11], s56 offen offset:0 sc1
    buffer_load_dwordx4 v[116:119], v1, s[8:11], s56 offen offset:1024 sc1
    buffer_load_dwordx4 v[120:123], v1, s[8:11], s56 offen offset:2048 sc1
    buffer_load_dwordx4 v[124:127], v1, s[8:11], s56 offen offset:3072 sc1
    buffer_load_dwordx4 v[128:131], v1, s[8:11], s55 offen offset:0 sc1
    buffer_load_dwordx4 v[132:135], v1, s[8:11], s55 offen offset:1024 sc1
    buffer_load_dwordx4 v[136:139], v1, s[8:11], s51 offen offset:0 sc1
    buffer_load_dwordx4 v[140:143], v1, s[8:11], s51 offen offset:1024 sc1
    buffer_load_dwordx4 v[144:147], v1, s[8:11], s51 offen offset:2048 sc1
    buffer_load_dwordx4 v[148:151], v1, s[8:11], s51 offen offset:3072 sc1
K5_rgot:
    v_lshlrev_b32 v208, 16, v92
    v_and_b32 v209, s23, v92
    v_lshlrev_b32 v210, 16, v93
    v_and_b32 v211, s23, v93
    v_lshlrev_b32 v212, 16, v94
    v_and_b32 v213, s23, v94
    v_lshlrev_b32 v214, 16, v95
    v_and_b32 v215, s23, v95
    v_lshlrev_b32 v216, 16, v96
    v_and_b32 v217, s23, v96
    v_lshlrev_b32 v218, 16, v97
    v_and_b32 v219, s23, v97
    v_lshlrev_b32 v220, 16, v98
    v_and_b32 v221, s23, v98
    v_lshlrev_b32 v222, 16, v99
    v_and_b32 v223, s23, v99
    v_lshlrev_b32 v224, 16, v100
    v_and_b32 v225, s23, v100
    v_lshlrev_b32 v226, 16, v101
    v_and_b32 v227, s23, v101
    v_lshlrev_b32 v228, 16, v102
    v_and_b32 v229, s23, v102
    v_lshlrev_b32 v230, 16, v103
    v_and_b32 v231, s23, v103
    s_waitcnt vmcnt(8)
    v_lshlrev_b32 v184, 16, v112
    v_and_b32 v185, s23, v112
    v_lshlrev_b32 v186, 16, v113
    v_and_b32 v187, s23, v113
    v_lshlrev_b32 v188, 16, v114
    v_and_b32 v189, s23, v114
    v_lshlrev_b32 v190, 16, v115
    v_and_b32 v191, s23, v115
    v_pk_add_f32 v[168:169], v[168:169], v[184:185]
    v_pk_add_f32 v[170:171], v[170:171], v[186:187]
    v_pk_add_f32 v[176:177], v[176:177], v[188:189]
    v_pk_add_f32 v[178:179], v[178:179], v[190:191]
    v_lshlrev_b32 v184, 16, v116
    v_and_b32 v185, s23, v116
    v_lshlrev_b32 v186, 16, v117
    v_and_b32 v187, s23, v117
    v_lshlrev_b32 v188, 16, v118
    v_and_b32 v189, s23, v118
    v_lshlrev_b32 v190, 16, v119
    v_and_b32 v191, s23, v119
    v_pk_add_f32 v[172:173], v[172:173], v[184:185]
    v_pk_add_f32 v[174:175], v[174:175], v[186:187]
    v_pk_add_f32 v[180:181], v[180:181], v[188:189]
    v_pk_add_f32 v[182:183], v[182:183], v[190:191]
    s_waitcnt vmcnt(6)
    v_lshlrev_b32 v184, 16, v120
    v_and_b32 v185, s23, v120
    v_lshlrev_b32 v186, 16, v121
    v_and_b32 v187, s23, v121
    v_lshlrev_b32 v188, 16, v122
    v_and_b32 v189, s23, v122
    v_lshlrev_b32 v190, 16, v123
    v_and_b32 v191, s23, v123
    v_pk_add_f32 v[168:169], v[168:169], v[184:185]
    v_pk_add_f32 v[170:171], v[170:171], v[186:187]
    v_pk_add_f32 v[176:177], v[176:177], v[188:189]
    v_pk_add_f32 v[178:179], v[178:179], v[190:191]
    v_lshlrev_b32 v184, 16, v124
    v_and_b32 v185, s23, v124
    v_lshlrev_b32 v186, 16, v125
    v_and_b32 v187, s23, v125
    v_lshlrev_b32 v188, 16, v126
    v_and_b32 v189, s23, v126
    v_lshlrev_b32 v190, 16, v127
    v_and_b32 v191, s23, v127
    v_pk_add_f32 v[172:173], v[172:173], v[184:185]
    v_pk_add_f32 v[174:175], v[174:175], v[186:187]
    v_pk_add_f32 v[180:181], v[180:181], v[188:189]
    v_pk_add_f32 v[182:183], v[182:183], v[190:191]
    s_waitcnt vmcnt(4)
    v_lshlrev_b32 v184, 16, v128
    v_and_b32 v185, s23, v128
    v_lshlrev_b32 v186, 16, v129
    v_and_b32 v187, s23, v129
    v_lshlrev_b32 v188, 16, v130
    v_and_b32 v189, s23, v130
    v_lshlrev_b32 v190, 16, v131
    v_and_b32 v191, s23, v131
    v_pk_add_f32 v[168:169], v[168:169], v[184:185]
    v_pk_add_f32 v[170:171], v[170:171], v[186:187]
    v_pk_add_f32 v[176:177], v[176:177], v[188:189]
    v_pk_add_f32 v[178:179], v[178:179], v[190:191]
    v_lshlrev_b32 v184, 16, v132
    v_and_b32 v185, s23, v132
    v_lshlrev_b32 v186, 16, v133
    v_and_b32 v187, s23, v133
    v_lshlrev_b32 v188, 16, v134
    v_and_b32 v189, s23, v134
    v_lshlrev_b32 v190, 16, v135
    v_and_b32 v191, s23, v135
    v_pk_add_f32 v[172:173], v[172:173], v[184:185]
    v_pk_add_f32 v[174:175], v[174:175], v[186:187]
    v_pk_add_f32 v[180:181], v[180:181], v[188:189]
    v_pk_add_f32 v[182:183], v[182:183], v[190:191]
    v_pk_fma_f32 v[168:169], v[168:169], v[104:105], v[208:209]
    v_pk_fma_f32 v[170:171], v[170:171], v[106:107], v[210:211]
    v_pk_fma_f32 v[176:177], v[176:177], v[108:109], v[212:213]
    v_pk_fma_f32 v[178:179], v[178:179], v[110:111], v[214:215]
    v_cvt_pk_bf16_f32 v64, v168, v169
    v_cvt_pk_bf16_f32 v65, v170, v171
    v_cvt_pk_bf16_f32 v66, v176, v177
    v_cvt_pk_bf16_f32 v67, v178, v179
    buffer_store_dwordx4 v[64:67], v27, s[64:67], s62 offen
    s_add_u32 s62, s62, 18432
    v_pk_fma_f32 v[172:173], v[172:173], v[104:105], v[216:217]
    v_pk_fma_f32 v[174:175], v[174:175], v[106:107], v[218:219]
    v_pk_fma_f32 v[180:181], v[180:181], v[108:109], v[220:221]
    v_pk_fma_f32 v[182:183], v[182:183], v[110:111], v[222:223]
    v_cvt_pk_bf16_f32 v68, v172, v173
    v_cvt_pk_bf16_f32 v69, v174, v175
    v_cvt_pk_bf16_f32 v70, v180, v181
    v_cvt_pk_bf16_f32 v71, v182, v183
    buffer_store_dwordx4 v[68:71], v27, s[64:67], s62 offen
    s_cmp_lg_u32 s47, 3
    s_cbranch_scc1 K5_end
    s_waitcnt vmcnt(2)
    v_lshlrev_b32 v192, 16, v136
    v_and_b32 v193, s23, v136
    v_lshlrev_b32 v194, 16, v137
    v_and_b32 v195, s23, v137
    v_lshlrev_b32 v196, 16, v138
    v_and_b32 v197, s23, v138
    v_lshlrev_b32 v198, 16, v139
    v_and_b32 v199, s23, v139
    v_lshlrev_b32 v184, 16, v140
    v_and_b32 v185, s23, v140
    v_lshlrev_b32 v186, 16, v141
    v_and_b32 v187, s23, v141
    v_lshlrev_b32 v188, 16, v142
    v_and_b32 v189, s23, v142
    v_lshlrev_b32 v190, 16, v143
    v_and_b32 v191, s23, v143
    v_pk_add_f32 v[192:193], v[192:193], v[184:185]
    v_pk_add_f32 v[194:195], v[194:195], v[186:187]
    v_pk_add_f32 v[196:197], v[196:197], v[188:189]
    v_pk_add_f32 v[198:199], v[198:199], v[190:191]
    v_lshlrev_b32 v184, 16, v144
    v_and_b32 v185, s23, v144
    v_lshlrev_b32 v186, 16, v145
    v_and_b32 v187, s23, v145
    v_lshlrev_b32 v188, 16, v146
    v_and_b32 v189, s23, v146
    v_lshlrev_b32 v190, 16, v147
    v_and_b32 v191, s23, v147
    v_pk_add_f32 v[192:193], v[192:193], v[184:185]
    v_pk_add_f32 v[194:195], v[194:195], v[186:187]
    v_pk_add_f32 v[196:197], v[196:197], v[188:189]
    v_pk_add_f32 v[198:199], v[198:199], v[190:191]
    v_lshlrev_b32 v184, 16, v148
    v_and_b32 v185, s23, v148
    v_lshlrev_b32 v186, 16, v149
    v_and_b32 v187, s23, v149
    v_lshlrev_b32 v188, 16, v150
    v_and_b32 v189, s23, v150
    v_lshlrev_b32 v190, 16, v151
    v_and_b32 v191, s23, v151
    v_pk_add_f32 v[192:193], v[192:193], v[184:185]
    v_pk_add_f32 v[194:195], v[194:195], v[186:187]
    v_pk_add_f32 v[196:197], v[196:197], v[188:189]
    v_pk_add_f32 v[198:199], v[198:199], v[190:191]
    v_pk_fma_f32 v[192:193], v[192:193], v[40:41], v[224:225]
    v_pk_fma_f32 v[194:195], v[194:195], v[42:43], v[226:227]
    v_pk_fma_f32 v[196:197], v[196:197], v[40:41], v[228:229]
    v_pk_fma_f32 v[198:199], v[198:199], v[42:43], v[230:231]
    v_cvt_pk_bf16_f32 v72, v192, v193
    v_cvt_pk_bf16_f32 v73, v194, v195
    v_cvt_pk_bf16_f32 v74, v196, v197
    v_cvt_pk_bf16_f32 v75, v198, v199
    buffer_store_dwordx2 v[72:73], v27, s[64:67], s63 offen
    s_add_u32 s63, s63, 18432
    buffer_store_dwordx2 v[74:75], v27, s[64:67], s63 offen
K5_end:
    s_endpgm
CODE_END:
    s_endpgm
.section .rodata,"a"
.p2align 6
.amdhsa_kernel k1_prep_kernel
  .amdhsa_next_free_vgpr 101
  .amdhsa_next_free_sgpr 32
  .amdhsa_accum_offset 104
  .amdhsa_group_segment_fixed_size 0
  .amdhsa_kernarg_size 112
  .amdhsa_user_sgpr_count 2
  .amdhsa_user_sgpr_kernarg_segment_ptr 1
  .amdhsa_system_sgpr_workgroup_id_x 1
.end_amdhsa_kernel
.p2align 6
.amdhsa_kernel k2_qkv_kernel
  .amdhsa_next_free_vgpr 128
  .amdhsa_next_free_sgpr 32
  .amdhsa_accum_offset 128
  .amdhsa_group_segment_fixed_size 0
  .amdhsa_kernarg_size 112
  .amdhsa_user_sgpr_count 2
  .amdhsa_user_sgpr_kernarg_segment_ptr 1
  .amdhsa_system_sgpr_workgroup_id_x 1
.end_amdhsa_kernel
.p2align 6
.amdhsa_kernel k3_attn_kernel
  .amdhsa_next_free_vgpr 256
  .amdhsa_next_free_sgpr 64
  .amdhsa_accum_offset 256
  .amdhsa_group_segment_fixed_size 0
  .amdhsa_kernarg_size 112
  .amdhsa_user_sgpr_count 2
  .amdhsa_user_sgpr_kernarg_segment_ptr 1
  .amdhsa_system_sgpr_workgroup_id_x 1
.end_amdhsa_kernel
.p2align 6
.amdhsa_kernel k5_ffn_kernel
  .amdhsa_next_free_vgpr 512
  .amdhsa_next_free_sgpr 72
  .amdhsa_accum_offset 256
  .amdhsa_group_segment_fixed_size 0
  .amdhsa_kernarg_size 112
  .amdhsa_user_sgpr_count 2
  .amdhsa_user_sgpr_kernarg_segment_ptr 1
  .amdhsa_system_sgpr_workgroup_id_x 1
.end_amdhsa_kernel
```
